```python
import torch

def _softmax(x, axis=-1):
    return torch.softmax(x, dim=axis)
def _gelu(x):
    return torch.nn.functional.gelu(x, approximate="tanh")
def _silu(x):
    return torch.nn.functional.silu(x)
def _sigmoid(x):
    return torch.sigmoid(x)
def _layernorm(x, axis=-1, eps=1e-5):
    m = x.mean(dim=axis, keepdim=True)
    v = x.var(dim=axis, keepdim=True, unbiased=False)
    return (x - m) / torch.sqrt(v + eps)
def _scatter_add(tgt, idx, src, axis=0):
    return tgt.clone().index_add_(axis, idx, src)
def _segment_sum(src, seg, n):
    out = torch.zeros((n,) + src.shape[1:], dtype=src.dtype)
    return out.index_add_(0, seg, src)
def _pad(x, pw):
    flat = tuple(v for pair in reversed(pw) for v in pair)
    return torch.nn.functional.pad(x, flat)

kernel_name = 'interleave_layers__linear_attn_block__glu_gated_glu__prompt'

def setup_inputs():

    _w = (lambda a: (lambda t: t.to(torch.bfloat16) if t.is_floating_point() else t)(torch.as_tensor(a)))
    def _A_setup():
        B, S, D = 1, 2048, 640
        return {
            "x": _w((lambda *s: torch.randn(*s, dtype=torch.bfloat16) * 0.05)(B, S, D)),
            "wqkv": _w((lambda *s: torch.randn(*s, dtype=torch.bfloat16) * 0.05)(D, 3 * D)),
            "wo": _w((lambda *s: torch.randn(*s, dtype=torch.bfloat16) * 0.05)(D, D)),
        }
    _A_in = _A_setup()

    def _B_setup():
        B, S, D, F = 1, 2048, 640, 1728
        return {
            "x": _w((lambda *s: torch.randn(*s, dtype=torch.bfloat16) * 0.05)(B, S, D)),
            "w_gate": _w((lambda *s: torch.randn(*s, dtype=torch.bfloat16) * 0.05)(D, F)),
            "w_up": _w((lambda *s: torch.randn(*s, dtype=torch.bfloat16) * 0.05)(D, F)),
            "w_down": _w((lambda *s: torch.randn(*s, dtype=torch.bfloat16) * 0.05)(F, D)),
        }
    _B_in = _B_setup()

    return {
        "A_x": _A_in["x"],
        "A_wqkv": _A_in["wqkv"],
        "A_wo": _A_in["wo"],
        "B_x": _B_in["x"],
        "B_w_gate": _B_in["w_gate"],
        "B_w_up": _B_in["w_up"],
        "B_w_down": _B_in["w_down"],
    }

def reference(A_x, A_wqkv, A_wo, B_x, B_w_gate, B_w_up, B_w_down):
    def _A_ref(x, wqkv, wo):
        B, S, D = x.shape
        H = 32; Dh = D // H
        qkv = (lambda x, *d: x.permute(*d))((x @ wqkv).reshape(B, S, 3, H, Dh), 2, 0, 3, 1, 4)
        q, k, v = qkv[0], qkv[1], qkv[2]
        phi = lambda t: torch.where(t > 0, t + 1, torch.exp(t)) + 1e-6
        pq, pk = phi(q), phi(k)
        kv = torch.einsum("bhsd,bhse->bhde", pk, v)
        z = torch.einsum("bhsd->bhd", pk)
        num = torch.einsum("bhqd,bhde->bhqe", pq, kv)
        den = torch.einsum("bhqd,bhd->bhq", pq, z)[..., None] + 1e-6
        o = num / den
        return (lambda x, *d: x.permute(*d))(o, 0, 2, 1, 3).reshape(B, S, D) @ wo

    def _B_ref(x, w_gate, w_up, w_down):
        g = torch.einsum("bsd,df->bsf", x, w_gate)
        u = torch.einsum("bsd,df->bsf", x, w_up)
        h = _sigmoid(g) * u
        return torch.einsum("bsf,fd->bsd", h, w_down)

    x = A_x
    x = x + _A_ref(_layernorm(x, axis=-1), A_wqkv, A_wo)
    x = x + _B_ref(_layernorm(x, axis=-1), B_w_gate, B_w_up, B_w_down)
    x = x + _A_ref(_layernorm(x, axis=-1), A_wqkv, A_wo)
    x = x + _B_ref(_layernorm(x, axis=-1), B_w_gate, B_w_up, B_w_down)
    return x
```

```asm
; @launch grid=(256,1,1) block=(256,1,1) lds=163840
.amdgcn_target "amdgcn-amd-amdhsa--gfx950"
.text
.globl interleave_layers__linear_attn_block__glu_gated_glu__prompt_kernel
.p2align 8
.type interleave_layers__linear_attn_block__glu_gated_glu__prompt_kernel,@function
interleave_layers__linear_attn_block__glu_gated_glu__prompt_kernel:
  s_cmp_ge_u32 s2, 256
  s_cbranch_scc1 L_exit
  s_load_dwordx2 s[4:5], s[0:1], 72
  v_lshrrev_b32 v7, 6, v0
  v_and_b32 v1, 63, v0
  v_readfirstlane_b32 s12, v7
  v_lshlrev_b32 v2, 4, v1
  v_lshrrev_b32 v5, 4, v1
  v_and_b32 v6, 15, v1
  s_mov_b32 s6, 41963520
  s_mov_b32 s7, 0x20000
  s_getpc_b64 s[40:41]
L_pc:
  s_lshr_b32 s42, s2, 3
  s_and_b32 s43, s42, 1
  s_cmp_lt_u32 s42, 13
  s_cselect_b32 s42, s42, s43
  s_lshl_b32 s42, s42, 12
  s_min_u32 s42, s42, L_exit-L_pc-4096
  v_lshl_add_u32 v90, v0, 4, s42
  global_load_dwordx4 v[92:95], v90, s[40:41]
  s_load_dwordx4 s[52:55], s[0:1], 0
  s_load_dwordx2 s[56:57], s[0:1], 16
  s_load_dwordx4 s[60:63], s[0:1], 32
  s_load_dwordx2 s[58:59], s[0:1], 48
  s_load_dwordx4 s[44:47], s[0:1], 56
  s_mov_b32 s11, 0x20000
  v_lshrrev_b32 v7, 2, v6
  v_and_b32 v8, 3, v6
  v_and_b32 v9, 1, v5
  v_lshl_add_u32 v9, v9, 2, v7
  v_lshlrev_b32 v9, 1, v9
  v_lshl_add_u32 v10, v5, 3, v7
  v_lshlrev_b32 v10, 8, v10
  s_lshr_b32 s17, s12, 1
  s_lshl_b32 s17, s17, 3
  v_lshl_add_u32 v11, v5, 1, s17
  v_xor_b32 v11, v11, v6
  s_waitcnt lgkmcnt(0)
  s_and_b32 s5, s5, 0xffff
  s_mov_b32 s37, 0
  s_cmp_lt_u32 s2, 60
  s_cbranch_scc1 L_k0_A
  s_sub_u32 s13, s2, 60
  s_cmp_lt_u32 s2, 64
  s_cbranch_scc1 L_k0_B
  s_cmp_lt_u32 s2, 128
  s_cbranch_scc1 L_k0_C
  s_sub_u32 s13, s2, 236
  s_cmp_ge_u32 s2, 240
  s_cbranch_scc1 L_k0_B
L_k0_A:
  s_cmp_lt_u32 s2, 60
  s_cbranch_scc0 L_k0_A3
  s_lshr_b32 s14, s2, 2
  s_and_b32 s15, s2, 3
  s_mov_b32 s8, s54
  s_and_b32 s9, s55, 0xffff
  s_mov_b32 s10, 2457600
  s_mov_b32 s20, 3840
  v_lshlrev_b32 v12, 4, v11
  s_lshl_b32 s21, s14, 8
  s_branch L_k0_Ac
L_k0_A3:
  s_sub_u32 s16, s2, 128
  s_and_b32 s18, s16, 1
  s_lshr_b32 s15, s16, 1
  s_and_b32 s15, s15, 3
  s_lshr_b32 s14, s16, 3
  s_cmp_eq_u32 s18, 0
  s_cselect_b32 s8, s60, s62
  s_cselect_b32 s9, s61, s63
  s_and_b32 s9, s9, 0xffff
  s_mov_b32 s10, 2211840
  s_mov_b32 s20, 3456
  s_lshl_b32 s21, s14, 8
  s_cmp_lt_u32 s14, 13
  s_cselect_b32 s17, 16, 8
  v_lshlrev_b32 v12, 4, v11
  v_mov_b32 v19, 1073741824
  v_cmp_gt_u32 vcc, s17, v11
  s_nop 1
  v_cndmask_b32 v12, v19, v12, vcc
L_k0_Ac:
  s_lshl_b32 s17, s12, 2
  v_add_u32 v13, s17, v5
  v_mul_lo_u32 v13, v13, s20
  v_add_u32 v12, v12, v13
  s_mul_i32 s31, s15, 160
  s_mul_i32 s31, s31, s20
  s_add_u32 s31, s31, s21
  s_lshl_b32 s32, s20, 4
  s_lshl_b32 s33, s12, 10
  s_add_u32 m0, s33, 0
  s_nop 0
  buffer_load_dwordx4 v12, s[8:11], s31 offen lds
  s_add_u32 m0, s33, 4096
  s_add_u32 s31, s31, s32
  buffer_load_dwordx4 v12, s[8:11], s31 offen lds
  s_add_u32 m0, s33, 8192
  s_add_u32 s31, s31, s32
  buffer_load_dwordx4 v12, s[8:11], s31 offen lds
  s_add_u32 m0, s33, 12288
  s_add_u32 s31, s31, s32
  buffer_load_dwordx4 v12, s[8:11], s31 offen lds
  s_add_u32 m0, s33, 16384
  s_add_u32 s31, s31, s32
  buffer_load_dwordx4 v12, s[8:11], s31 offen lds
  s_add_u32 m0, s33, 20480
  s_add_u32 s31, s31, s32
  buffer_load_dwordx4 v12, s[8:11], s31 offen lds
  s_add_u32 m0, s33, 24576
  s_add_u32 s31, s31, s32
  buffer_load_dwordx4 v12, s[8:11], s31 offen lds
  s_add_u32 m0, s33, 28672
  s_add_u32 s31, s31, s32
  buffer_load_dwordx4 v12, s[8:11], s31 offen lds
  s_add_u32 m0, s33, 32768
  s_add_u32 s31, s31, s32
  buffer_load_dwordx4 v12, s[8:11], s31 offen lds
  s_add_u32 m0, s33, 36864
  s_add_u32 s31, s31, s32
  buffer_load_dwordx4 v12, s[8:11], s31 offen lds
  s_cmp_lt_u32 s2, 172
  s_cbranch_scc1 L_k0_An
  s_sub_u32 s50, s2, 132
  s_mov_b32 s37, 1
  s_and_b32 s49, s50, 1
  s_lshr_b32 s50, s50, 1
  s_cmp_lt_u32 s50, 20
  s_cbranch_scc1 L_k0_B2a
  s_sub_u32 s50, s50, 20
  s_mov_b32 s8, s58
  s_and_b32 s9, s59, 0xffff
  s_mov_b32 s10, 2211840
  s_mov_b32 s51, 276480
  s_mov_b32 s39, 8404992
  s_lshr_b32 s42, s50, 1
  s_and_b32 s43, s50, 1
  s_lshl_b32 s43, s43, 5
  s_mov_b32 s48, 16
  s_sub_u32 s17, s50, 32
  s_cmp_ge_u32 s50, 32
  s_cselect_b32 s42, s17, s42
  s_cselect_b32 s43, 64, s43
  s_sub_u32 s17, s50, 48
  s_lshl_b32 s17, s17, 1
  s_cmp_ge_u32 s50, 48
  s_cselect_b32 s42, s17, s42
  s_cselect_b32 s43, 96, s43
  s_cselect_b32 s48, 112, s48
  s_mul_i32 s17, s42, 112
  s_mul_i32 s18, s42, 96
  s_add_u32 s18, s18, 192
  s_min_u32 s17, s17, s18
  s_add_u32 s17, s17, s43
  s_lshl_b32 s18, s12, 2
  s_add_u32 s17, s17, s18
  s_mul_i32 s18, s48, s49
  s_add_u32 s17, s17, s18
  v_add_u32 v12, s17, v5
  s_branch L_k0_Bca
L_k0_B2a:
  s_mov_b32 s8, s56
  s_and_b32 s9, s57, 0xffff
  s_mov_b32 s10, 819200
  s_mov_b32 s51, 102400
  s_mov_b32 s39, 2768896
  s_lshl_b32 s18, s12, 2
  v_add_u32 v14, s18, v5
  v_and_b32 v15, 7, v14
  v_lshrrev_b32 v14, 3, v14
  s_lshl_b32 s17, s50, 3
  v_add_u32 v15, s17, v15
  v_mul_u32_u24 v16, 205, v15
  v_lshrrev_b32 v16, 10, v16
  v_mul_u32_u24 v17, 5, v16
  v_sub_u32 v17, v15, v17
  v_mul_u32_u24 v16, 20, v16
  v_cmp_gt_u32 vcc, 4, v17
  s_lshl_b32 s17, s49, 1
  v_add_u32 v14, s17, v14
  v_lshl_add_u32 v18, v14, 2, v17
  v_add_u32 v19, 16, v14
  v_cndmask_b32 v18, v19, v18, vcc
  v_add_u32 v12, v16, v18
L_k0_Bca:
  v_mul_u32_u24 v12, 1280, v12
  v_lshl_add_u32 v12, v11, 4, v12
  s_lshl_b32 s33, s12, 10
  s_add_u32 m0, s33, 40960
  s_mov_b32 s31, 0
  buffer_load_dwordx4 v12, s[8:11], s31 offen lds
  s_add_u32 m0, s33, 45056
  s_mov_b32 s31, 256
  buffer_load_dwordx4 v12, s[8:11], s31 offen lds
  s_add_u32 m0, s33, 49152
  s_mov_b32 s31, 512
  buffer_load_dwordx4 v12, s[8:11], s31 offen lds
  s_add_u32 m0, s33, 53248
  s_mov_b32 s31, 768
  buffer_load_dwordx4 v12, s[8:11], s31 offen lds
  s_add_u32 m0, s33, 57344
  s_mov_b32 s31, 1024
  buffer_load_dwordx4 v12, s[8:11], s31 offen lds
L_k0_An:
  s_cmp_ge_u32 s2, 128
  s_cbranch_scc1 L_k0_D3
  s_mul_i32 s17, s14, 52
  s_lshr_b32 s38, s17, 8
  s_mul_i32 s17, s38, 5
  s_sub_u32 s17, s14, s17
  s_lshl_b32 s17, s17, 7
  s_lshl_b32 s18, s12, 4
  s_add_u32 s17, s17, s18
  s_cmp_eq_u32 s38, 2
  s_cselect_b32 s39, 40, 0
  s_cmp_eq_u32 s38, 0
  s_mov_b32 s30, 5120
  s_cselect_b32 s30, 3072, s30
  v_mov_b32 v84, s30
  v_mov_b32 v85, s30
  s_mov_b32 s28, 16384
  s_cselect_b64 s[48:49], -1, 0
  v_add_u32 v13, s17, v6
  v_add_u32 v13, 0, v13
  v_mul_u32_u24 v14, 1639, v13
  v_lshrrev_b32 v14, 16, v14
  v_mul_u32_u24 v15, 40, v14
  v_sub_u32 v13, v13, v15
  v_mul_u32_u24 v14, 172032, v14
  v_lshl_add_u32 v14, v5, 8, v14
  v_add_u32 v15, s39, v13
  v_lshrrev_b32 v16, 4, v15
  v_and_b32 v15, 15, v15
  v_lshlrev_b32 v15, 4, v15
  v_lshl_add_u32 v15, v16, 10, v15
  v_bfe_u32 v16, v13, 2, 1
  v_lshrrev_b32 v17, 3, v13
  v_and_b32 v18, 3, v13
  v_lshl_add_u32 v17, v17, 2, v18
  v_lshlrev_b32 v17, 4, v17
  v_lshl_add_u32 v16, v16, 10, v17
  v_lshlrev_b32 v17, 4, v13
  v_add_u32 v17, 1536, v17
  v_cmp_gt_u32 vcc, 32, v13
  s_nop 1
  v_cndmask_b32 v16, v17, v16, vcc
  v_add_u32 v16, 107520, v16
  v_cndmask_b32 v15, v15, v16, s[48:49]
  v_add_u32 v80, v14, v15
  v_add_u32 v14, 128, v80
  v_mov_b32 v15, 1073741824
  v_cndmask_b32 v82, v14, v15, vcc
  v_add_u32 v13, s17, v6
  v_add_u32 v13, 64, v13
  v_mul_u32_u24 v14, 1639, v13
  v_lshrrev_b32 v14, 16, v14
  v_mul_u32_u24 v15, 40, v14
  v_sub_u32 v13, v13, v15
  v_mul_u32_u24 v14, 172032, v14
  v_lshl_add_u32 v14, v5, 8, v14
  v_add_u32 v15, s39, v13
  v_lshrrev_b32 v16, 4, v15
  v_and_b32 v15, 15, v15
  v_lshlrev_b32 v15, 4, v15
  v_lshl_add_u32 v15, v16, 10, v15
  v_bfe_u32 v16, v13, 2, 1
  v_lshrrev_b32 v17, 3, v13
  v_and_b32 v18, 3, v13
  v_lshl_add_u32 v17, v17, 2, v18
  v_lshlrev_b32 v17, 4, v17
  v_lshl_add_u32 v16, v16, 10, v17
  v_lshlrev_b32 v17, 4, v13
  v_add_u32 v17, 1536, v17
  v_cmp_gt_u32 vcc, 32, v13
  s_nop 1
  v_cndmask_b32 v16, v17, v16, vcc
  v_add_u32 v16, 107520, v16
  v_cndmask_b32 v15, v15, v16, s[48:49]
  v_add_u32 v81, v14, v15
  v_add_u32 v14, 128, v81
  v_mov_b32 v15, 1073741824
  v_cndmask_b32 v83, v14, v15, vcc
  s_branch L_k0_Dc
L_k0_D3:
  s_and_b32 s18, s2, 1
  v_mov_b32 v19, 1073741824
  s_lshl_b32 s28, s18, 10
  s_add_u32 s28, s28, 3588096
  s_mov_b32 s30, 2048
  s_cmp_lt_u32 s14, 10
  s_cselect_b32 s38, 1, 0
  s_lshl_b32 s17, s14, 7
  s_lshl_b32 s18, s12, 4
  s_add_u32 s17, s17, s18
  v_add_u32 v13, s17, v6
  v_add_u32 v13, 0, v13
  v_lshrrev_b32 v14, 4, v13
  v_mul_u32_u24 v14, 9363, v14
  v_max_u32 v15, 192, v13
  v_subrev_u32 v15, 192, v15
  v_mul_u32_u24 v15, 683, v15
  v_max_u32 v14, v14, v15
  v_lshrrev_b32 v14, 16, v14
  v_mul_u32_u24 v15, 112, v14
  v_mul_u32_u24 v16, 96, v14
  v_add_u32 v16, 192, v16
  v_min_u32 v15, v15, v16
  v_sub_u32 v15, v13, v15
  v_lshrrev_b32 v16, 5, v15
  v_bfe_u32 v17, v15, 2, 1
  v_lshl_add_u32 v16, v16, 1, v17
  v_bfe_u32 v17, v15, 3, 2
  v_and_b32 v18, 3, v15
  v_lshl_add_u32 v17, v17, 2, v18
  v_cmp_gt_u32 vcc, 96, v15
  v_subrev_u32 v15, 96, v15
  s_nop 0
  v_cndmask_b32 v16, 6, v16, vcc
  v_cndmask_b32 v17, v15, v17, vcc
  v_mul_u32_u24 v15, 301056, v14
  v_lshl_add_u32 v15, v5, 8, v15
  v_lshl_add_u32 v15, v17, 4, v15
  v_cmp_gt_u32 vcc, 1728, v13
  s_nop 1
  v_cndmask_b32 v15, v19, v15, vcc
  v_add_u32 v17, 258048, v15
  v_cmp_lt_u32 vcc, 11, v14
  s_nop 1
  v_cndmask_b32 v17, v19, v17, vcc
  v_cmp_eq_u32 vcc, 4, v16
  s_nop 1
  v_cndmask_b32 v82, v19, v17, vcc
  v_lshl_add_u32 v15, v16, 11, v15
  v_mov_b32 v84, 6144
  v_mov_b32 v13, 2048
  v_mov_b32 v14, 4096
  v_cmp_lt_u32 vcc, 2, v16
  v_add_u32 v17, 122880, v15
  s_nop 0
  v_cndmask_b32 v15, v15, v17, vcc
  v_cndmask_b32 v84, v84, v13, vcc
  v_cmp_lt_u32 vcc, 3, v16
  v_add_u32 v17, 40960, v15
  s_nop 0
  v_cndmask_b32 v15, v15, v17, vcc
  v_cndmask_b32 v84, v84, v14, vcc
  v_cmp_lt_u32 vcc, 5, v16
  v_add_u32 v17, 81920, v15
  s_nop 0
  v_cndmask_b32 v15, v15, v17, vcc
  v_cndmask_b32 v84, v84, v13, vcc
  v_mov_b32 v80, v15
  v_add_u32 v13, s17, v6
  v_add_u32 v13, 64, v13
  v_lshrrev_b32 v14, 4, v13
  v_mul_u32_u24 v14, 9363, v14
  v_max_u32 v15, 192, v13
  v_subrev_u32 v15, 192, v15
  v_mul_u32_u24 v15, 683, v15
  v_max_u32 v14, v14, v15
  v_lshrrev_b32 v14, 16, v14
  v_mul_u32_u24 v15, 112, v14
  v_mul_u32_u24 v16, 96, v14
  v_add_u32 v16, 192, v16
  v_min_u32 v15, v15, v16
  v_sub_u32 v15, v13, v15
  v_lshrrev_b32 v16, 5, v15
  v_bfe_u32 v17, v15, 2, 1
  v_lshl_add_u32 v16, v16, 1, v17
  v_bfe_u32 v17, v15, 3, 2
  v_and_b32 v18, 3, v15
  v_lshl_add_u32 v17, v17, 2, v18
  v_cmp_gt_u32 vcc, 96, v15
  v_subrev_u32 v15, 96, v15
  s_nop 0
  v_cndmask_b32 v16, 6, v16, vcc
  v_cndmask_b32 v17, v15, v17, vcc
  v_mul_u32_u24 v15, 301056, v14
  v_lshl_add_u32 v15, v5, 8, v15
  v_lshl_add_u32 v15, v17, 4, v15
  v_cmp_gt_u32 vcc, 1728, v13
  s_nop 1
  v_cndmask_b32 v15, v19, v15, vcc
  v_add_u32 v17, 258048, v15
  v_cmp_lt_u32 vcc, 11, v14
  s_nop 1
  v_cndmask_b32 v17, v19, v17, vcc
  v_cmp_eq_u32 vcc, 4, v16
  s_nop 1
  v_cndmask_b32 v83, v19, v17, vcc
  v_lshl_add_u32 v15, v16, 11, v15
  v_mov_b32 v85, 6144
  v_mov_b32 v13, 2048
  v_mov_b32 v14, 4096
  v_cmp_lt_u32 vcc, 2, v16
  v_add_u32 v17, 122880, v15
  s_nop 0
  v_cndmask_b32 v15, v15, v17, vcc
  v_cndmask_b32 v85, v85, v13, vcc
  v_cmp_lt_u32 vcc, 3, v16
  v_add_u32 v17, 40960, v15
  s_nop 0
  v_cndmask_b32 v15, v15, v17, vcc
  v_cndmask_b32 v85, v85, v14, vcc
  v_cmp_lt_u32 vcc, 5, v16
  v_add_u32 v17, 81920, v15
  s_nop 0
  v_cndmask_b32 v15, v15, v17, vcc
  v_cndmask_b32 v85, v85, v13, vcc
  v_mov_b32 v81, v15
L_k0_Dc:
  s_lshl_b32 s22, s12, 5
  s_mul_i32 s18, s15, 5
  s_add_u32 s17, s18, 0
  v_mad_u32_u24 v96, v84, s17, v80
  s_add_u32 s17, s18, 1
  v_mad_u32_u24 v97, v84, s17, v80
  s_add_u32 s17, s18, 2
  v_mad_u32_u24 v98, v84, s17, v80
  s_add_u32 s17, s18, 3
  v_mad_u32_u24 v99, v84, s17, v80
  s_add_u32 s17, s18, 4
  v_mad_u32_u24 v100, v84, s17, v80
  v_mad_u32_u24 v80, v84, 20, v80
  v_lshl_add_u32 v14, v8, 3, s22
  v_add_u32 v14, 0, v14
  v_lshrrev_b32 v16, 4, v14
  v_xor_b32 v16, v16, v9
  v_and_b32 v14, 8, v14
  v_lshl_add_u32 v14, v16, 4, v14
  v_add_u32 v14, v14, v10
  s_add_u32 s17, s18, 0
  v_mad_u32_u24 v101, v85, s17, v81
  s_add_u32 s17, s18, 1
  v_mad_u32_u24 v102, v85, s17, v81
  s_add_u32 s17, s18, 2
  v_mad_u32_u24 v103, v85, s17, v81
  s_add_u32 s17, s18, 3
  v_mad_u32_u24 v104, v85, s17, v81
  s_add_u32 s17, s18, 4
  v_mad_u32_u24 v105, v85, s17, v81
  v_mad_u32_u24 v81, v85, 20, v81
  v_lshl_add_u32 v15, v8, 3, s22
  v_add_u32 v15, 128, v15
  v_lshrrev_b32 v16, 4, v15
  v_xor_b32 v16, v16, v9
  v_and_b32 v15, 8, v15
  v_lshl_add_u32 v15, v16, 4, v15
  v_add_u32 v15, v15, v10
  v_mov_b32 v20, 0x3f803f80
  v_mov_b32 v21, 0x3f803f80
  v_mov_b32 v22, 0x3f803f80
  v_mov_b32 v23, 0x3f803f80
  s_mul_i32 s17, s18, s30
  s_add_u32 s34, s28, s17
  s_lshl_b32 s18, s15, 8
  s_add_u32 s29, s28, s18
  s_mul_i32 s17, s30, 20
  s_add_u32 s35, s29, s17
  s_waitcnt vmcnt(5)
  s_cmp_lg_u32 s37, 0
  s_cbranch_scc1 L_k0_Aw
  s_waitcnt vmcnt(0)
L_k0_Aw:
  s_barrier
  ds_read_b64_tr_b16 v[32:33], v14 offset:0
  ds_read_b64_tr_b16 v[34:35], v14 offset:1024
  ds_read_b64_tr_b16 v[36:37], v14 offset:8192
  ds_read_b64_tr_b16 v[38:39], v14 offset:9216
  ds_read_b64_tr_b16 v[40:41], v14 offset:16384
  ds_read_b64_tr_b16 v[42:43], v14 offset:17408
  ds_read_b64_tr_b16 v[44:45], v14 offset:24576
  ds_read_b64_tr_b16 v[46:47], v14 offset:25600
  ds_read_b64_tr_b16 v[48:49], v14 offset:32768
  ds_read_b64_tr_b16 v[50:51], v14 offset:33792
  ds_read_b64_tr_b16 v[52:53], v15 offset:0
  ds_read_b64_tr_b16 v[54:55], v15 offset:1024
  ds_read_b64_tr_b16 v[56:57], v15 offset:8192
  ds_read_b64_tr_b16 v[58:59], v15 offset:9216
  s_waitcnt lgkmcnt(4)
  ds_read_b64_tr_b16 v[60:61], v15 offset:16384
  ds_read_b64_tr_b16 v[62:63], v15 offset:17408
  ds_read_b64_tr_b16 v[64:65], v15 offset:24576
  ds_read_b64_tr_b16 v[66:67], v15 offset:25600
  ds_read_b64_tr_b16 v[68:69], v15 offset:32768
  ds_read_b64_tr_b16 v[70:71], v15 offset:33792
  buffer_store_dwordx4 v[32:35], v96, s[4:7], s28 offen sc1
  v_mfma_f32_16x16x32_bf16 v[24:27], v[20:23], v[32:35], 0
  buffer_store_dwordx4 v[36:39], v97, s[4:7], s28 offen sc1
  v_mfma_f32_16x16x32_bf16 v[24:27], v[20:23], v[36:39], v[24:27]
  buffer_store_dwordx4 v[40:43], v98, s[4:7], s28 offen sc1
  v_mfma_f32_16x16x32_bf16 v[24:27], v[20:23], v[40:43], v[24:27]
  buffer_store_dwordx4 v[44:47], v99, s[4:7], s28 offen sc1
  v_mfma_f32_16x16x32_bf16 v[24:27], v[20:23], v[44:47], v[24:27]
  buffer_store_dwordx4 v[48:51], v100, s[4:7], s28 offen sc1
  v_mfma_f32_16x16x32_bf16 v[24:27], v[20:23], v[48:51], v[24:27]
  s_waitcnt lgkmcnt(8)
  buffer_store_dwordx4 v[52:55], v101, s[4:7], s28 offen sc1
  v_mfma_f32_16x16x32_bf16 v[28:31], v[20:23], v[52:55], 0
  s_waitcnt lgkmcnt(6)
  buffer_store_dwordx4 v[56:59], v102, s[4:7], s28 offen sc1
  v_mfma_f32_16x16x32_bf16 v[28:31], v[20:23], v[56:59], v[28:31]
  s_waitcnt lgkmcnt(4)
  buffer_store_dwordx4 v[60:63], v103, s[4:7], s28 offen sc1
  v_mfma_f32_16x16x32_bf16 v[28:31], v[20:23], v[60:63], v[28:31]
  s_waitcnt lgkmcnt(2)
  buffer_store_dwordx4 v[64:67], v104, s[4:7], s28 offen sc1
  v_mfma_f32_16x16x32_bf16 v[28:31], v[20:23], v[64:67], v[28:31]
  s_waitcnt lgkmcnt(0)
  buffer_store_dwordx4 v[68:71], v105, s[4:7], s28 offen sc1
  v_mfma_f32_16x16x32_bf16 v[28:31], v[20:23], v[68:71], v[28:31]
  s_mov_b32 exec_lo, 0x0000ffff
  s_mov_b32 exec_hi, 0x00000000
  v_cvt_pk_bf16_f32 v72, v24, v24
  v_and_b32 v16, 0xffff0000, v72
  v_sub_f32 v17, v24, v16
  v_cvt_pk_bf16_f32 v73, v17, v17
  v_and_b32 v16, 0xffff0000, v73
  v_sub_f32 v17, v17, v16
  v_cvt_pk_bf16_f32 v74, v17, v24
  v_mov_b32 v75, 0
  buffer_store_dwordx4 v[72:75], v80, s[4:7], s29 offen sc1
  v_cvt_pk_bf16_f32 v76, v28, v28
  v_and_b32 v16, 0xffff0000, v76
  v_sub_f32 v17, v28, v16
  v_cvt_pk_bf16_f32 v77, v17, v17
  v_and_b32 v16, 0xffff0000, v77
  v_sub_f32 v17, v17, v16
  v_cvt_pk_bf16_f32 v78, v17, v28
  v_mov_b32 v79, 0
  buffer_store_dwordx4 v[76:79], v81, s[4:7], s29 offen sc1
  s_cmp_lg_u32 s38, 0
  s_cbranch_scc1 L_k0_Ae
  buffer_store_dwordx4 v[72:75], v82, s[4:7], s35 offen sc1
  buffer_store_dwordx4 v[76:79], v83, s[4:7], s35 offen sc1
  s_mov_b64 exec, -1
  buffer_store_dwordx4 v[32:35], v82, s[4:7], s34 offen sc1
  buffer_store_dwordx4 v[52:55], v83, s[4:7], s34 offen sc1
  s_add_u32 s34, s34, s30
  buffer_store_dwordx4 v[36:39], v82, s[4:7], s34 offen sc1
  buffer_store_dwordx4 v[56:59], v83, s[4:7], s34 offen sc1
  s_add_u32 s34, s34, s30
  buffer_store_dwordx4 v[40:43], v82, s[4:7], s34 offen sc1
  buffer_store_dwordx4 v[60:63], v83, s[4:7], s34 offen sc1
  s_add_u32 s34, s34, s30
  buffer_store_dwordx4 v[44:47], v82, s[4:7], s34 offen sc1
  buffer_store_dwordx4 v[64:67], v83, s[4:7], s34 offen sc1
  s_add_u32 s34, s34, s30
  buffer_store_dwordx4 v[48:51], v82, s[4:7], s34 offen sc1
  buffer_store_dwordx4 v[68:71], v83, s[4:7], s34 offen sc1
  s_add_u32 s34, s34, s30
L_k0_Ae:
  s_mov_b64 exec, -1
  s_cmp_lt_u32 s2, 128
  s_cbranch_scc1 L_arrive
  s_cmp_eq_u32 s37, 0
  s_cbranch_scc1 L_join
  s_waitcnt vmcnt(12)
  s_barrier
  s_branch L_k0_Bp
L_k0_B:
  s_mov_b32 s37, 2
  s_lshl_b32 s50, s13, 1
  s_add_u32 s50, s50, 108
L_k0_Bs:
  s_and_b32 s49, s50, 1
  s_lshr_b32 s50, s50, 1
  s_cmp_lt_u32 s50, 20
  s_cbranch_scc1 L_k0_B2s
  s_sub_u32 s50, s50, 20
  s_mov_b32 s8, s58
  s_and_b32 s9, s59, 0xffff
  s_mov_b32 s10, 2211840
  s_mov_b32 s51, 276480
  s_mov_b32 s39, 8404992
  s_lshr_b32 s42, s50, 1
  s_and_b32 s43, s50, 1
  s_lshl_b32 s43, s43, 5
  s_mov_b32 s48, 16
  s_sub_u32 s17, s50, 32
  s_cmp_ge_u32 s50, 32
  s_cselect_b32 s42, s17, s42
  s_cselect_b32 s43, 64, s43
  s_sub_u32 s17, s50, 48
  s_lshl_b32 s17, s17, 1
  s_cmp_ge_u32 s50, 48
  s_cselect_b32 s42, s17, s42
  s_cselect_b32 s43, 96, s43
  s_cselect_b32 s48, 112, s48
  s_mul_i32 s17, s42, 112
  s_mul_i32 s18, s42, 96
  s_add_u32 s18, s18, 192
  s_min_u32 s17, s17, s18
  s_add_u32 s17, s17, s43
  s_lshl_b32 s18, s12, 2
  s_add_u32 s17, s17, s18
  s_mul_i32 s18, s48, s49
  s_add_u32 s17, s17, s18
  v_add_u32 v12, s17, v5
  s_branch L_k0_Bcs
L_k0_B2s:
  s_mov_b32 s8, s56
  s_and_b32 s9, s57, 0xffff
  s_mov_b32 s10, 819200
  s_mov_b32 s51, 102400
  s_mov_b32 s39, 2768896
  s_lshl_b32 s18, s12, 2
  v_add_u32 v14, s18, v5
  v_and_b32 v15, 7, v14
  v_lshrrev_b32 v14, 3, v14
  s_lshl_b32 s17, s50, 3
  v_add_u32 v15, s17, v15
  v_mul_u32_u24 v16, 205, v15
  v_lshrrev_b32 v16, 10, v16
  v_mul_u32_u24 v17, 5, v16
  v_sub_u32 v17, v15, v17
  v_mul_u32_u24 v16, 20, v16
  v_cmp_gt_u32 vcc, 4, v17
  s_lshl_b32 s17, s49, 1
  v_add_u32 v14, s17, v14
  v_lshl_add_u32 v18, v14, 2, v17
  v_add_u32 v19, 16, v14
  v_cndmask_b32 v18, v19, v18, vcc
  v_add_u32 v12, v16, v18
L_k0_Bcs:
  v_mul_u32_u24 v12, 1280, v12
  v_lshl_add_u32 v12, v11, 4, v12
  s_lshl_b32 s33, s12, 10
  s_add_u32 m0, s33, 40960
  s_mov_b32 s31, 0
  buffer_load_dwordx4 v12, s[8:11], s31 offen lds
  s_add_u32 m0, s33, 45056
  s_mov_b32 s31, 256
  buffer_load_dwordx4 v12, s[8:11], s31 offen lds
  s_add_u32 m0, s33, 49152
  s_mov_b32 s31, 512
  buffer_load_dwordx4 v12, s[8:11], s31 offen lds
  s_add_u32 m0, s33, 53248
  s_mov_b32 s31, 768
  buffer_load_dwordx4 v12, s[8:11], s31 offen lds
  s_add_u32 m0, s33, 57344
  s_mov_b32 s31, 1024
  buffer_load_dwordx4 v12, s[8:11], s31 offen lds
  s_waitcnt vmcnt(0)
  s_barrier
L_k0_Bp:
  s_mul_i32 s22, s12, 320
  v_lshrrev_b32 v19, 1, v5
  v_mul_u32_u24 v15, 160, v19
  v_add_u32 v15, s22, v15
  v_lshl_add_u32 v14, v8, 4, v15
  v_lshl_add_u32 v15, v8, 3, v15
  v_and_b32 v13, 0xfff, v10
  v_add_u32 v16, 0, v14
  v_bfe_u32 v17, v16, 4, 4
  v_xor_b32 v17, v17, v9
  v_lshrrev_b32 v18, 8, v16
  v_and_b32 v16, 8, v16
  v_lshl_add_u32 v16, v17, 4, v16
  v_lshl_add_u32 v16, v18, 12, v16
  v_add_u32 v20, v16, v13
  v_add_u32 v16, 8, v14
  v_bfe_u32 v17, v16, 4, 4
  v_xor_b32 v17, v17, v9
  v_lshrrev_b32 v18, 8, v16
  v_and_b32 v16, 8, v16
  v_lshl_add_u32 v16, v17, 4, v16
  v_lshl_add_u32 v16, v18, 12, v16
  v_add_u32 v21, v16, v13
  v_add_u32 v16, 64, v14
  v_bfe_u32 v17, v16, 4, 4
  v_xor_b32 v17, v17, v9
  v_lshrrev_b32 v18, 8, v16
  v_and_b32 v16, 8, v16
  v_lshl_add_u32 v16, v17, 4, v16
  v_lshl_add_u32 v16, v18, 12, v16
  v_add_u32 v22, v16, v13
  v_add_u32 v16, 72, v14
  v_bfe_u32 v17, v16, 4, 4
  v_xor_b32 v17, v17, v9
  v_lshrrev_b32 v18, 8, v16
  v_and_b32 v16, 8, v16
  v_lshl_add_u32 v16, v17, 4, v16
  v_lshl_add_u32 v16, v18, 12, v16
  v_add_u32 v23, v16, v13
  v_add_u32 v16, 128, v15
  v_bfe_u32 v17, v16, 4, 4
  v_xor_b32 v17, v17, v9
  v_lshrrev_b32 v18, 8, v16
  v_and_b32 v16, 8, v16
  v_lshl_add_u32 v16, v17, 4, v16
  v_lshl_add_u32 v16, v18, 12, v16
  v_add_u32 v24, v16, v13
  ds_read_b64_tr_b16 v[32:33], v20 offset:40960
  ds_read_b64_tr_b16 v[34:35], v20 offset:41984
  ds_read_b64_tr_b16 v[36:37], v21 offset:40960
  ds_read_b64_tr_b16 v[38:39], v21 offset:41984
  ds_read_b64_tr_b16 v[40:41], v22 offset:40960
  ds_read_b64_tr_b16 v[42:43], v22 offset:41984
  ds_read_b64_tr_b16 v[44:45], v23 offset:40960
  ds_read_b64_tr_b16 v[46:47], v23 offset:41984
  ds_read_b64_tr_b16 v[48:49], v24 offset:40960
  ds_read_b64_tr_b16 v[50:51], v24 offset:41984
  s_lshl_b32 s17, s12, 1
  s_mul_i32 s17, s17, s51
  s_add_u32 s39, s39, s17
  s_mul_i32 s17, s50, 5120
  s_add_u32 s39, s39, s17
  s_lshl_b32 s17, s49, 9
  s_add_u32 s39, s39, s17
  s_add_u32 s17, s39, 4096
  v_mul_lo_u32 v19, v19, s51
  v_and_b32 v18, 0x1ff, v2
  v_add_u32 v19, v19, v18
  s_waitcnt lgkmcnt(8)
  buffer_store_dwordx4 v[32:35], v19, s[4:7], s39 offen offset:0 sc1
  s_waitcnt lgkmcnt(6)
  buffer_store_dwordx4 v[36:39], v19, s[4:7], s39 offen offset:1024 sc1
  s_waitcnt lgkmcnt(4)
  buffer_store_dwordx4 v[40:43], v19, s[4:7], s39 offen offset:2048 sc1
  s_waitcnt lgkmcnt(2)
  buffer_store_dwordx4 v[44:47], v19, s[4:7], s39 offen offset:3072 sc1
  s_waitcnt lgkmcnt(0)
  buffer_store_dwordx4 v[48:51], v19, s[4:7], s17 offen offset:0 sc1
  s_cmp_lg_u32 s37, 2
  s_cbranch_scc1 L_join
  s_mov_b32 s37, 0
  s_barrier
  s_lshl_b32 s50, s13, 1
  s_add_u32 s50, s50, 109
  s_branch L_k0_Bs
L_k0_C:
  s_sub_u32 s16, s2, 64
  s_mov_b32 s8, s52
  s_and_b32 s9, s53, 0xffff
  s_mov_b32 s10, 2621440
  s_lshl_b32 s17, s12, 2
  v_add_u32 v12, s17, v5
  v_xor_b32 v13, v12, v6
  v_mul_u32_u24 v12, 1280, v12
  v_lshl_add_u32 v12, v13, 4, v12
  s_mul_i32 s20, s16, 40960
  s_lshl_b32 s33, s12, 10
  s_add_u32 m0, s33, 0
  s_add_u32 s31, s20, 0
  buffer_load_dwordx4 v12, s[8:11], s31 offen lds
  s_add_u32 m0, s33, 4096
  s_add_u32 s31, s20, 256
  buffer_load_dwordx4 v12, s[8:11], s31 offen lds
  s_add_u32 m0, s33, 8192
  s_add_u32 s31, s20, 512
  buffer_load_dwordx4 v12, s[8:11], s31 offen lds
  s_add_u32 m0, s33, 12288
  s_add_u32 s31, s20, 768
  buffer_load_dwordx4 v12, s[8:11], s31 offen lds
  s_add_u32 m0, s33, 16384
  s_add_u32 s31, s20, 1024
  buffer_load_dwordx4 v12, s[8:11], s31 offen lds
  s_add_u32 m0, s33, 20480
  s_add_u32 s31, s20, 20480
  buffer_load_dwordx4 v12, s[8:11], s31 offen lds
  s_add_u32 m0, s33, 24576
  s_add_u32 s31, s20, 20736
  buffer_load_dwordx4 v12, s[8:11], s31 offen lds
  s_add_u32 m0, s33, 28672
  s_add_u32 s31, s20, 20992
  buffer_load_dwordx4 v12, s[8:11], s31 offen lds
  s_add_u32 m0, s33, 32768
  s_add_u32 s31, s20, 21248
  buffer_load_dwordx4 v12, s[8:11], s31 offen lds
  s_add_u32 m0, s33, 36864
  s_add_u32 s31, s20, 21504
  buffer_load_dwordx4 v12, s[8:11], s31 offen lds
  s_mov_b32 s50, s16
  s_cmp_lt_u32 s16, 40
  s_cselect_b32 s37, 1, 0
  v_mov_b32 v20, 0
  v_mov_b32 v21, 0
  v_mov_b32 v22, 0
  v_mov_b32 v23, 0
  s_and_b32 s17, s16, 31
  s_mul_i32 s17, s17, 6400
  s_lshr_b32 s18, s16, 5
  s_mul_i32 s18, s18, 15409152
  s_add_u32 s17, s17, s18
  s_add_u32 s17, s17, 25825280
  v_lshlrev_b32 v14, 4, v0
  buffer_store_dwordx4 v[20:23], v14, s[4:7], s17 offen sc1
  v_cmp_gt_u32 vcc, 144, v0
  v_mov_b32 v15, 0x40000000
  s_nop 0
  v_cndmask_b32 v14, v15, v14, vcc
  s_add_u32 s17, s17, 4096
  buffer_store_dwordx4 v[20:23], v14, s[4:7], s17 offen sc1
  s_lshr_b32 s22, s12, 1
  s_and_b32 s23, s12, 1
  s_mul_i32 s24, s22, 20480
  s_mul_i32 s25, s23, 40
  v_add_u32 v14, s25, v5
  v_lshlrev_b32 v15, 8, v6
  v_add_u32 v15, s24, v15
  v_add_u32 v16, 0, v14
  v_lshrrev_b32 v17, 4, v16
  v_xor_b32 v16, v16, v6
  v_and_b32 v16, 15, v16
  v_lshl_add_u32 v16, v16, 4, v15
  v_lshl_add_u32 v72, v17, 12, v16
  v_add_u32 v16, 4, v14
  v_lshrrev_b32 v17, 4, v16
  v_xor_b32 v16, v16, v6
  v_and_b32 v16, 15, v16
  v_lshl_add_u32 v16, v16, 4, v15
  v_lshl_add_u32 v73, v17, 12, v16
  v_add_u32 v16, 8, v14
  v_lshrrev_b32 v17, 4, v16
  v_xor_b32 v16, v16, v6
  v_and_b32 v16, 15, v16
  v_lshl_add_u32 v16, v16, 4, v15
  v_lshl_add_u32 v74, v17, 12, v16
  v_add_u32 v16, 12, v14
  v_lshrrev_b32 v17, 4, v16
  v_xor_b32 v16, v16, v6
  v_and_b32 v16, 15, v16
  v_lshl_add_u32 v16, v16, 4, v15
  v_lshl_add_u32 v75, v17, 12, v16
  v_add_u32 v16, 16, v14
  v_lshrrev_b32 v17, 4, v16
  v_xor_b32 v16, v16, v6
  v_and_b32 v16, 15, v16
  v_lshl_add_u32 v16, v16, 4, v15
  v_lshl_add_u32 v76, v17, 12, v16
  v_add_u32 v16, 20, v14
  v_lshrrev_b32 v17, 4, v16
  v_xor_b32 v16, v16, v6
  v_and_b32 v16, 15, v16
  v_lshl_add_u32 v16, v16, 4, v15
  v_lshl_add_u32 v77, v17, 12, v16
  v_add_u32 v16, 24, v14
  v_lshrrev_b32 v17, 4, v16
  v_xor_b32 v16, v16, v6
  v_and_b32 v16, 15, v16
  v_lshl_add_u32 v16, v16, 4, v15
  v_lshl_add_u32 v78, v17, 12, v16
  v_add_u32 v16, 28, v14
  v_lshrrev_b32 v17, 4, v16
  v_xor_b32 v16, v16, v6
  v_and_b32 v16, 15, v16
  v_lshl_add_u32 v16, v16, 4, v15
  v_lshl_add_u32 v79, v17, 12, v16
  v_add_u32 v16, 32, v14
  v_lshrrev_b32 v17, 4, v16
  v_xor_b32 v16, v16, v6
  v_and_b32 v16, 15, v16
  v_lshl_add_u32 v16, v16, 4, v15
  v_lshl_add_u32 v80, v17, 12, v16
  v_add_u32 v16, 36, v14
  v_lshrrev_b32 v17, 4, v16
  v_xor_b32 v16, v16, v6
  v_and_b32 v16, 15, v16
  v_lshl_add_u32 v16, v16, 4, v15
  v_lshl_add_u32 v81, v17, 12, v16
  s_add_u32 s26, s20, s24
  s_mul_i32 s17, s23, 10240
  s_add_u32 s26, s26, s17
  s_add_u32 s26, s26, 10620928
  v_mov_b32 v24, 0
  v_mov_b32 v25, 0
  v_mov_b32 v26, 0x3f803f80
  s_waitcnt vmcnt(2)
  s_barrier
  ds_read_b128 v[32:35], v72
  ds_read_b128 v[36:39], v73
  ds_read_b128 v[40:43], v74
  ds_read_b128 v[44:47], v75
  ds_read_b128 v[48:51], v76
  ds_read_b128 v[52:55], v77
  ds_read_b128 v[56:59], v78
  ds_read_b128 v[60:63], v79
  ds_read_b128 v[64:67], v80
  ds_read_b128 v[68:71], v81
  s_waitcnt lgkmcnt(9)
  buffer_store_dwordx4 v[32:35], v2, s[4:7], s26 offen offset:0 sc1
  v_dot2_f32_bf16 v24, v32, v26, v24
  v_dot2_f32_bf16 v25, v32, v32, v25
  v_dot2_f32_bf16 v24, v33, v26, v24
  v_dot2_f32_bf16 v25, v33, v33, v25
  v_dot2_f32_bf16 v24, v34, v26, v24
  v_dot2_f32_bf16 v25, v34, v34, v25
  v_dot2_f32_bf16 v24, v35, v26, v24
  v_dot2_f32_bf16 v25, v35, v35, v25
  s_waitcnt lgkmcnt(8)
  buffer_store_dwordx4 v[36:39], v2, s[4:7], s26 offen offset:1024 sc1
  v_dot2_f32_bf16 v24, v36, v26, v24
  v_dot2_f32_bf16 v25, v36, v36, v25
  v_dot2_f32_bf16 v24, v37, v26, v24
  v_dot2_f32_bf16 v25, v37, v37, v25
  v_dot2_f32_bf16 v24, v38, v26, v24
  v_dot2_f32_bf16 v25, v38, v38, v25
  v_dot2_f32_bf16 v24, v39, v26, v24
  v_dot2_f32_bf16 v25, v39, v39, v25
  s_waitcnt lgkmcnt(7)
  buffer_store_dwordx4 v[40:43], v2, s[4:7], s26 offen offset:2048 sc1
  v_dot2_f32_bf16 v24, v40, v26, v24
  v_dot2_f32_bf16 v25, v40, v40, v25
  v_dot2_f32_bf16 v24, v41, v26, v24
  v_dot2_f32_bf16 v25, v41, v41, v25
  v_dot2_f32_bf16 v24, v42, v26, v24
  v_dot2_f32_bf16 v25, v42, v42, v25
  v_dot2_f32_bf16 v24, v43, v26, v24
  v_dot2_f32_bf16 v25, v43, v43, v25
  s_waitcnt lgkmcnt(6)
  buffer_store_dwordx4 v[44:47], v2, s[4:7], s26 offen offset:3072 sc1
  v_dot2_f32_bf16 v24, v44, v26, v24
  v_dot2_f32_bf16 v25, v44, v44, v25
  v_dot2_f32_bf16 v24, v45, v26, v24
  v_dot2_f32_bf16 v25, v45, v45, v25
  v_dot2_f32_bf16 v24, v46, v26, v24
  v_dot2_f32_bf16 v25, v46, v46, v25
  v_dot2_f32_bf16 v24, v47, v26, v24
  v_dot2_f32_bf16 v25, v47, v47, v25
  s_add_u32 s26, s26, 4096
  s_waitcnt lgkmcnt(5)
  buffer_store_dwordx4 v[48:51], v2, s[4:7], s26 offen offset:0 sc1
  v_dot2_f32_bf16 v24, v48, v26, v24
  v_dot2_f32_bf16 v25, v48, v48, v25
  v_dot2_f32_bf16 v24, v49, v26, v24
  v_dot2_f32_bf16 v25, v49, v49, v25
  v_dot2_f32_bf16 v24, v50, v26, v24
  v_dot2_f32_bf16 v25, v50, v50, v25
  v_dot2_f32_bf16 v24, v51, v26, v24
  v_dot2_f32_bf16 v25, v51, v51, v25
  s_waitcnt lgkmcnt(4)
  buffer_store_dwordx4 v[52:55], v2, s[4:7], s26 offen offset:1024 sc1
  v_dot2_f32_bf16 v24, v52, v26, v24
  v_dot2_f32_bf16 v25, v52, v52, v25
  v_dot2_f32_bf16 v24, v53, v26, v24
  v_dot2_f32_bf16 v25, v53, v53, v25
  v_dot2_f32_bf16 v24, v54, v26, v24
  v_dot2_f32_bf16 v25, v54, v54, v25
  v_dot2_f32_bf16 v24, v55, v26, v24
  v_dot2_f32_bf16 v25, v55, v55, v25
  s_waitcnt lgkmcnt(3)
  buffer_store_dwordx4 v[56:59], v2, s[4:7], s26 offen offset:2048 sc1
  v_dot2_f32_bf16 v24, v56, v26, v24
  v_dot2_f32_bf16 v25, v56, v56, v25
  v_dot2_f32_bf16 v24, v57, v26, v24
  v_dot2_f32_bf16 v25, v57, v57, v25
  v_dot2_f32_bf16 v24, v58, v26, v24
  v_dot2_f32_bf16 v25, v58, v58, v25
  v_dot2_f32_bf16 v24, v59, v26, v24
  v_dot2_f32_bf16 v25, v59, v59, v25
  s_waitcnt lgkmcnt(2)
  buffer_store_dwordx4 v[60:63], v2, s[4:7], s26 offen offset:3072 sc1
  v_dot2_f32_bf16 v24, v60, v26, v24
  v_dot2_f32_bf16 v25, v60, v60, v25
  v_dot2_f32_bf16 v24, v61, v26, v24
  v_dot2_f32_bf16 v25, v61, v61, v25
  v_dot2_f32_bf16 v24, v62, v26, v24
  v_dot2_f32_bf16 v25, v62, v62, v25
  v_dot2_f32_bf16 v24, v63, v26, v24
  v_dot2_f32_bf16 v25, v63, v63, v25
  s_add_u32 s26, s26, 4096
  s_waitcnt lgkmcnt(1)
  buffer_store_dwordx4 v[64:67], v2, s[4:7], s26 offen offset:0 sc1
  v_dot2_f32_bf16 v24, v64, v26, v24
  v_dot2_f32_bf16 v25, v64, v64, v25
  v_dot2_f32_bf16 v24, v65, v26, v24
  v_dot2_f32_bf16 v25, v65, v65, v25
  v_dot2_f32_bf16 v24, v66, v26, v24
  v_dot2_f32_bf16 v25, v66, v66, v25
  v_dot2_f32_bf16 v24, v67, v26, v24
  v_dot2_f32_bf16 v25, v67, v67, v25
  s_waitcnt lgkmcnt(0)
  buffer_store_dwordx4 v[68:71], v2, s[4:7], s26 offen offset:1024 sc1
  v_dot2_f32_bf16 v24, v68, v26, v24
  v_dot2_f32_bf16 v25, v68, v68, v25
  v_dot2_f32_bf16 v24, v69, v26, v24
  v_dot2_f32_bf16 v25, v69, v69, v25
  v_dot2_f32_bf16 v24, v70, v26, v24
  v_dot2_f32_bf16 v25, v70, v70, v25
  v_dot2_f32_bf16 v24, v71, v26, v24
  v_dot2_f32_bf16 v25, v71, v71, v25
  s_nop 1
  v_mov_b32 v27, v24
  s_nop 1
  v_permlane32_swap_b32 v24, v27
  v_add_f32 v24, v24, v27
  v_mov_b32 v27, v24
  s_nop 1
  v_permlane16_swap_b32 v24, v27
  v_add_f32 v24, v24, v27
  v_mov_b32 v28, v25
  s_nop 1
  v_permlane32_swap_b32 v25, v28
  v_add_f32 v25, v25, v28
  v_mov_b32 v28, v25
  s_nop 1
  v_permlane16_swap_b32 v25, v28
  v_add_f32 v25, v25, v28
  v_cmp_eq_u32 vcc, 0, v5
  s_nop 1
  v_cndmask_b32 v24, 0, v24, vcc
  v_cndmask_b32 v25, 0, v25, vcc
  s_lshl_b32 s17, s16, 1
  s_add_u32 s17, s17, s22
  s_lshl_b32 s17, s17, 10
  s_lshl_b32 s18, s23, 7
  s_add_u32 s17, s17, s18
  s_add_u32 s17, s17, 25563136
  v_lshlrev_b32 v14, 8, v5
  v_lshl_add_u32 v14, v6, 3, v14
  buffer_store_dwordx2 v[24:25], v14, s[4:7], s17 offen sc1
L_arrive:
  s_cmp_eq_u32 s12, 0
  s_cbranch_scc1 L_arr0
  s_waitcnt vmcnt(0)
  s_barrier
  s_branch L_arr1
L_arr0:
  s_waitcnt vmcnt(0)
  s_barrier
  v_mov_b32 v84, 0
  v_mov_b32 v85, 1
  s_mov_b64 exec, 1
  global_atomic_add v86, v84, v85, s[46:47] sc0
  s_waitcnt vmcnt(0)
  v_readfirstlane_b32 s17, v86
  s_mov_b64 exec, -1
  s_nop 0
  s_cmp_lg_u32 s17, 123
  s_cbranch_scc1 L_arr1
  s_mov_b64 exec, 1
  global_store_dword v84, v85, s[46:47] offset:128 sc1
  s_mov_b64 exec, -1
L_arr1:
  s_cmp_lg_u32 s37, 0
  s_cbranch_scc1 L_k0_Bs
L_join:
  s_mov_b32 s8, s44
  s_and_b32 s9, s45, 0xffff
  s_mov_b32 s10, 2621440
  s_mov_b64 s[18:19], s[46:47]
  s_and_b32 s34, s2, 7
  s_lshr_b32 s35, s2, 3
  s_and_b32 s36, s35, 3
  s_lshr_b32 s17, s35, 2
  s_lshr_b32 s13, s34, 1
  s_lshl_b32 s13, s13, 2
  s_add_u32 s13, s13, s36
  s_and_b32 s14, s34, 1
  s_lshl_b32 s14, s14, 3
  s_add_u32 s14, s14, s17
  s_mul_i32 s21, s12, 5120
  s_mul_i32 s22, s14, 172032
  s_add_u32 s22, s22, s21
  s_add_u32 s22, s22, 16384
  s_lshl_b32 s34, s34, 2
  s_add_u32 s34, s34, s36
  s_lshl_b32 s16, s34, 2
  s_add_u32 s16, s16, s12
  s_lshl_b32 s27, s34, 3
  s_add_u32 s27, s27, s17
  s_lshl_b32 s26, s13, 4
  s_add_u32 s26, s26, s14
  s_lshl_b32 s15, s13, 3
  s_lshl_b32 s35, s12, 1
  s_add_u32 s15, s15, s35
  s_and_b32 s28, s2, 15
  s_lshl_b32 s28, s28, 10
  s_mov_b32 s29, 0x358637bd
  s_mov_b32 s20, 0
  s_mul_i32 s23, s17, 102400
  s_add_u32 s23, s23, 2768896
  s_add_u32 s23, s23, s21
  s_mul_i32 s24, s14, 301056
  s_add_u32 s24, s24, 3588096
  s_add_u32 s24, s24, s21
  s_mul_i32 s25, s17, 276480
  s_add_u32 s25, s25, 8404992
  s_add_u32 s25, s25, s21
  v_add_u32 v3, 0x10000, v2
  v_add_u32 v4, 0x20000, v2
  v_mov_b32 v31, 1073741824
  v_lshlrev_b32 v7, 8, v5
  v_lshl_add_u32 v7, v6, 3, v7
  v_lshrrev_b32 v8, 1, v5
  v_lshlrev_b32 v8, 8, v8
  v_lshl_add_u32 v8, v6, 4, v8
  v_and_b32 v9, 1, v5
  v_lshl_add_u32 v8, v9, 3, v8
  v_cmp_gt_u32 vcc, 32, v1
  s_nop 1
  v_cndmask_b32 v9, v31, v8, vcc
  v_cmp_gt_u32 vcc, 16, v1
  v_lshlrev_b32 v10, 3, v6
  s_nop 0
  v_cndmask_b32 v10, v31, v10, vcc
  v_cmp_gt_u32 vcc, 16, v0
  v_lshlrev_b32 v22, 7, v1
  s_nop 0
  v_cndmask_b32 v22, v31, v22, vcc
  v_lshlrev_b32 v23, 10, v1
  v_cndmask_b32 v23, v31, v23, vcc
  v_lshlrev_b32 v24, 2, v6
  v_mov_b32 v25, 1
  v_cmp_gt_u32 vcc, 48, v1
  s_nop 1
  v_cndmask_b32 v21, v31, v2, vcc
  s_cmp_lt_u32 s14, 12
  s_cselect_b32 s35, 0, 1073741824
  v_add_u32 v28, s35, v8
  v_mul_u32_u24 v30, 1280, v6
  v_lshl_add_u32 v29, v5, 4, v30
  v_lshl_add_u32 v30, v5, 3, v30
  s_mul_i32 s35, s12, 3360
  s_add_u32 s35, s35, 142720
  v_mul_u32_u24 v11, 336, v5
  v_lshl_add_u32 v11, v6, 4, v11
  v_add_u32 v11, s35, v11
  v_min_u32 v12, 1, v5
  v_mul_u32_u24 v12, 320, v12
  v_sub_u32 v12, v11, v12
  v_lshlrev_b32 v14, 2, v0
  v_add_u32 v13, 143360, v14
  v_cmp_gt_u32 vcc, 72, v0
  s_nop 1
  v_cndmask_b32 v15, v31, v14, vcc
  s_lshl_b32 s35, s12, 7
  s_add_u32 s35, s35, 156800
  v_lshl_add_u32 v26, v6, 2, s35
  v_lshl_add_u32 v27, v5, 4, s35
  s_mov_b32 s38, 0x00ff00ff
  s_mov_b32 s39, 0x00ff00ff
  s_mov_b32 s40, 0xff00ff00
  s_mov_b32 s41, 0xff00ff00
  s_mov_b32 s42, 0x0fff0fff
  s_mov_b32 s43, 0x0fff0fff
  s_mov_b32 s44, 0x0000ff00
  s_mov_b32 s45, 0x00000000
  s_mov_b32 s46, 0xf0000fff
  s_mov_b32 s47, 0xf000f000
  s_mov_b32 s48, 0xffff0000
  s_mov_b32 s49, 0xffffffff
  s_mov_b32 s50, 0xf000f000
  s_mov_b32 s51, 0x00000000
  s_mov_b32 s52, 0xffffffff
  s_mov_b32 s53, 0x00000000
  s_mov_b32 s54, 0x00010001
  s_mov_b32 s55, 0x00010001
  s_mov_b32 s56, 0x00010001
  s_mov_b32 s57, 0x00010001
  s_mov_b32 s58, 0x00010001
  s_mov_b32 s59, 0x00000000
  s_lshr_b32 s34, s12, 1
  s_and_b32 s35, s12, 1
  s_lshl_b32 s35, s35, 6
  v_add_u32 v50, s35, v1
  v_mul_u32_u24 v51, 3121, v50
  v_lshrrev_b32 v51, 16, v51
  v_mul_u32_u24 v52, 21, v51
  v_sub_u32 v52, v50, v52
  s_mul_i32 s35, s34, 1680
  v_lshl_add_u32 v16, v50, 4, s35
  v_add_u32 v51, s34, v51
  v_lshrrev_b32 v53, 1, v51
  v_and_b32 v51, 1, v51
  v_lshlrev_b32 v54, 8, v53
  v_lshlrev_b32 v53, 7, v53
  v_add_u32 v53, 512, v53
  v_cmp_gt_u32 vcc, 16, v52
  s_nop 1
  v_cndmask_b32 v53, v53, v54, vcc
  v_lshl_add_u32 v53, v52, 4, v53
  v_lshl_add_u32 v53, v51, 3, v53
  v_cmp_gt_u32 vcc, 105, v50
  v_mov_b32 v54, 1152
  s_nop 0
  v_cndmask_b32 v53, v54, v53, vcc
  v_cndmask_b32 v16, v31, v16, vcc
  s_mul_i32 s35, s34, 1280
  s_add_u32 s35, s35, 122880
  v_add_u32 v17, s35, v53
  v_lshlrev_b32 v20, 4, v0
  v_add_u32 v20, 122880, v20
  v_and_b32 v52, 7, v6
  v_lshlrev_b32 v52, 4, v52
  v_add_u32 v52, 1152, v52
  v_and_b32 v51, 3, v6
  v_lshrrev_b32 v53, 2, v6
  v_cmp_eq_u32 vcc, 0, v51
  s_nop 1
  v_cndmask_b32 v51, 4, v53, vcc
  v_lshlrev_b32 v51, 4, v51
  v_lshl_add_u32 v51, v5, 7, v51
  v_add_u32 v51, 768, v51
  v_cmp_eq_u32 vcc, 3, v5
  s_nop 1
  v_cndmask_b32 v51, v51, v52, vcc
  v_add_u32 v19, 122880, v51
  v_cndmask_b32 v51, v2, v52, vcc
  v_add_u32 v18, 122880, v51
  v_mov_b32 v42, 0
  v_mov_b32 v43, s29
  v_mov_b32 v44, 0
  v_mov_b32 v45, 0
  v_mov_b32 v46, 0x3f803f80
  v_mov_b32 v47, 0x3f803f80
  v_mov_b32 v48, 0x3f803f80
  v_mov_b32 v49, 0x3f803f80
  v_mov_b32 v31, 0
  s_mul_i32 s30, s15, 20480
  s_add_u32 s30, s30, s20
  s_add_u32 s30, s30, 10620928
  s_add_u32 s31, s30, 20480
  s_lshl_b32 s36, s15, 10
  s_add_u32 s36, s36, s20
  s_add_u32 s36, s36, 25563136
  s_mul_i32 s61, s16, 20480
  s_mul_i32 s35, s17, 2560
  s_add_u32 s61, s61, s35
  s_add_u32 s61, s61, 10620928
  s_lshl_b32 s34, s26, 2
  s_add_u32 s34, s34, 25882624
  s_and_b32 s60, s28, 0
  s_add_u32 s60, s60, 25882624
  v_cmp_gt_u32 vcc, 1, v0
  v_mov_b32 v251, 1073741824
  s_nop 0
  v_cndmask_b32 v251, v251, v23, vcc
  s_cmp_lg_u32 s12, 0
  s_cbranch_scc1 L_pd0
  s_mov_b32 s37, 200000
L_pl0:
  global_load_dword v252, v31, s[18:19] offset:128 sc1
  s_waitcnt vmcnt(0)
  v_cmp_eq_u32 vcc, 0, v252
  s_nop 1
  s_cbranch_vccz L_pd0
  s_sub_u32 s37, s37, 1
  s_cmp_lg_u32 s37, 0
  s_cbranch_scc1 L_pl0
L_pd0:
  s_waitcnt vmcnt(0)
  s_barrier
  s_add_u32 m0, s21, 122880
  s_add_u32 s33, s22, 0
  buffer_load_dwordx4 v2, s[4:7], s33 offen offset:0 lds
  buffer_load_dwordx4 v2, s[4:7], s33 offen offset:1024 lds
  buffer_load_dwordx4 v2, s[4:7], s33 offen offset:2048 lds
  buffer_load_dwordx4 v2, s[4:7], s33 offen offset:3072 lds
  s_add_u32 m0, s21, 126976
  s_add_u32 s33, s22, 4096
  buffer_load_dwordx4 v2, s[4:7], s33 offen offset:0 lds
  buffer_load_dwordx4 a[0:3], v2, s[4:7], s30 offen offset:0 sc1
  buffer_load_dwordx4 a[4:7], v2, s[4:7], s30 offen offset:1024 sc1
  buffer_load_dwordx4 a[80:83], v2, s[4:7], s31 offen offset:0 sc1
  buffer_load_dwordx4 a[84:87], v2, s[4:7], s31 offen offset:1024 sc1
  buffer_load_dwordx4 a[8:11], v2, s[4:7], s30 offen offset:2048 sc1
  buffer_load_dwordx4 a[12:15], v2, s[4:7], s30 offen offset:3072 sc1
  buffer_load_dwordx4 a[88:91], v2, s[4:7], s31 offen offset:2048 sc1
  buffer_load_dwordx4 a[92:95], v2, s[4:7], s31 offen offset:3072 sc1
  s_add_u32 m0, s21, 143360
  s_add_u32 s33, s22, 20480
  buffer_load_dwordx4 v2, s[4:7], s33 offen offset:0 lds
  buffer_load_dwordx4 v2, s[4:7], s33 offen offset:1024 lds
  buffer_load_dwordx4 v2, s[4:7], s33 offen offset:2048 lds
  buffer_load_dwordx4 v2, s[4:7], s33 offen offset:3072 lds
  s_add_u32 m0, s21, 147456
  s_add_u32 s33, s22, 24576
  buffer_load_dwordx4 v2, s[4:7], s33 offen offset:0 lds
  s_add_u32 s32, s30, 4096
  buffer_load_dwordx4 a[16:19], v2, s[4:7], s32 offen offset:0 sc1
  buffer_load_dwordx4 a[20:23], v2, s[4:7], s32 offen offset:1024 sc1
  s_add_u32 s32, s31, 4096
  buffer_load_dwordx4 a[96:99], v2, s[4:7], s32 offen offset:0 sc1
  buffer_load_dwordx4 a[100:103], v2, s[4:7], s32 offen offset:1024 sc1
  s_add_u32 s32, s30, 4096
  buffer_load_dwordx4 a[24:27], v2, s[4:7], s32 offen offset:2048 sc1
  buffer_load_dwordx4 a[28:31], v2, s[4:7], s32 offen offset:3072 sc1
  s_waitcnt vmcnt(19)
  s_barrier
  ds_read_b128 a[224:227], v3 offset:57344
  ds_read_b128 a[228:231], v3 offset:58368
  ds_read_b128 a[232:235], v3 offset:59392
  ds_read_b128 a[236:239], v3 offset:60416
  ds_read_b128 a[240:243], v3 offset:61440
  ds_read_b128 a[244:247], v3 offset:62464
  s_waitcnt vmcnt(15) lgkmcnt(5)
  v_mfma_f32_16x16x32_bf16 v[50:53], a[0:3], a[224:227], 0
  s_add_u32 s32, s31, 4096
  buffer_load_dwordx4 a[104:107], v2, s[4:7], s32 offen offset:2048 sc1
  v_mfma_f32_16x16x32_bf16 v[70:73], a[80:83], a[224:227], 0
  s_waitcnt lgkmcnt(4)
  ds_read_b128 a[248:251], v3 offset:63488
  v_mfma_f32_16x16x32_bf16 v[54:57], a[0:3], a[228:231], 0
  buffer_load_dwordx4 a[108:111], v2, s[4:7], s32 offen offset:3072 sc1
  v_mfma_f32_16x16x32_bf16 v[74:77], a[80:83], a[228:231], 0
  s_waitcnt lgkmcnt(4)
  ds_read_b128 a[252:255], v3 offset:64512
  v_mfma_f32_16x16x32_bf16 v[58:61], a[0:3], a[232:235], 0
  s_add_u32 m0, s21, 0
  v_mfma_f32_16x16x32_bf16 v[78:81], a[80:83], a[232:235], 0
  s_waitcnt lgkmcnt(4)
  ds_read_b128 a[224:227], v4 offset:0
  v_mfma_f32_16x16x32_bf16 v[62:65], a[0:3], a[236:239], 0
  s_add_u32 s33, s22, 40960
  buffer_load_dwordx4 v2, s[4:7], s33 offen offset:0 lds
  v_mfma_f32_16x16x32_bf16 v[82:85], a[80:83], a[236:239], 0
  s_waitcnt lgkmcnt(4)
  ds_read_b128 a[228:231], v4 offset:1024
  v_mfma_f32_16x16x32_bf16 v[66:69], a[0:3], a[240:243], 0
  buffer_load_dwordx4 v2, s[4:7], s33 offen offset:1024 lds
  v_mfma_f32_16x16x32_bf16 v[86:89], a[80:83], a[240:243], 0
  s_waitcnt lgkmcnt(4)
  ds_read_b128 a[232:235], v4 offset:2048
  v_mfma_f32_16x16x32_bf16 v[50:53], a[4:7], a[244:247], v[50:53]
  buffer_load_dwordx4 v2, s[4:7], s33 offen offset:2048 lds
  v_mfma_f32_16x16x32_bf16 v[70:73], a[84:87], a[244:247], v[70:73]
  s_waitcnt lgkmcnt(4)
  ds_read_b128 a[236:239], v4 offset:3072
  v_mfma_f32_16x16x32_bf16 v[54:57], a[4:7], a[248:251], v[54:57]
  buffer_load_dwordx4 v2, s[4:7], s33 offen offset:3072 lds
  v_mfma_f32_16x16x32_bf16 v[74:77], a[84:87], a[248:251], v[74:77]
  s_waitcnt lgkmcnt(4)
  ds_read_b128 a[240:243], v4 offset:4096
  v_mfma_f32_16x16x32_bf16 v[58:61], a[4:7], a[252:255], v[58:61]
  s_add_u32 m0, s21, 4096
  v_mfma_f32_16x16x32_bf16 v[78:81], a[84:87], a[252:255], v[78:81]
  s_waitcnt lgkmcnt(4)
  ds_read_b128 a[244:247], v4 offset:5120
  v_mfma_f32_16x16x32_bf16 v[62:65], a[4:7], a[224:227], v[62:65]
  s_add_u32 s33, s22, 45056
  buffer_load_dwordx4 v2, s[4:7], s33 offen offset:0 lds
  v_mfma_f32_16x16x32_bf16 v[82:85], a[84:87], a[224:227], v[82:85]
  s_waitcnt lgkmcnt(4)
  ds_read_b128 a[248:251], v4 offset:6144
  v_mfma_f32_16x16x32_bf16 v[66:69], a[4:7], a[228:231], v[66:69]
  buffer_load_dwordx2 v[114:115], v7, s[4:7], s36 offen offset:0 sc1
  v_mfma_f32_16x16x32_bf16 v[86:89], a[84:87], a[228:231], v[86:89]
  s_waitcnt vmcnt(19) lgkmcnt(4)
  ds_read_b128 a[252:255], v4 offset:7168
  v_mfma_f32_16x16x32_bf16 v[50:53], a[8:11], a[232:235], v[50:53]
  buffer_load_dwordx2 v[116:117], v7, s[4:7], s36 offen offset:128 sc1
  v_mfma_f32_16x16x32_bf16 v[70:73], a[88:91], a[232:235], v[70:73]
  s_waitcnt lgkmcnt(4)
  ds_read_b128 a[224:227], v4 offset:8192
  v_mfma_f32_16x16x32_bf16 v[54:57], a[8:11], a[236:239], v[54:57]
  buffer_load_dwordx2 v[118:119], v7, s[4:7], s36 offen offset:1024 sc1
  v_mfma_f32_16x16x32_bf16 v[74:77], a[88:91], a[236:239], v[74:77]
  s_waitcnt lgkmcnt(4)
  ds_read_b128 a[228:231], v4 offset:9216
  v_mfma_f32_16x16x32_bf16 v[58:61], a[8:11], a[240:243], v[58:61]
  buffer_load_dwordx2 v[120:121], v7, s[4:7], s36 offen offset:1152 sc1
  v_mfma_f32_16x16x32_bf16 v[78:81], a[88:91], a[240:243], v[78:81]
  s_waitcnt lgkmcnt(4)
  ds_read_b128 a[232:235], v4 offset:10240
  v_mfma_f32_16x16x32_bf16 v[62:65], a[8:11], a[244:247], v[62:65]
  s_add_u32 s32, s30, 8192
  buffer_load_dwordx4 a[32:35], v2, s[4:7], s32 offen offset:0 sc1
  v_mfma_f32_16x16x32_bf16 v[82:85], a[88:91], a[244:247], v[82:85]
  s_waitcnt lgkmcnt(4)
  ds_read_b128 a[236:239], v4 offset:11264
  v_mfma_f32_16x16x32_bf16 v[66:69], a[8:11], a[248:251], v[66:69]
  s_waitcnt vmcnt(18)
  s_barrier
  buffer_load_dwordx4 a[36:39], v2, s[4:7], s32 offen offset:1024 sc1
  v_mfma_f32_16x16x32_bf16 v[86:89], a[88:91], a[248:251], v[86:89]
  s_waitcnt lgkmcnt(4)
  ds_read_b128 a[240:243], v4 offset:12288
  v_mfma_f32_16x16x32_bf16 v[50:53], a[12:15], a[252:255], v[50:53]
  s_add_u32 s32, s31, 8192
  buffer_load_dwordx4 a[112:115], v2, s[4:7], s32 offen offset:0 sc1
  v_mfma_f32_16x16x32_bf16 v[70:73], a[92:95], a[252:255], v[70:73]
  s_waitcnt lgkmcnt(4)
  ds_read_b128 a[244:247], v4 offset:13312
  v_mfma_f32_16x16x32_bf16 v[54:57], a[12:15], a[224:227], v[54:57]
  buffer_load_dwordx4 a[116:119], v2, s[4:7], s32 offen offset:1024 sc1
  v_mfma_f32_16x16x32_bf16 v[74:77], a[92:95], a[224:227], v[74:77]
  s_waitcnt lgkmcnt(4)
  ds_read_b128 a[248:251], v4 offset:14336
  v_mfma_f32_16x16x32_bf16 v[58:61], a[12:15], a[228:231], v[58:61]
  s_add_u32 s32, s30, 8192
  buffer_load_dwordx4 a[40:43], v2, s[4:7], s32 offen offset:2048 sc1
  v_mfma_f32_16x16x32_bf16 v[78:81], a[92:95], a[228:231], v[78:81]
  s_waitcnt lgkmcnt(4)
  ds_read_b128 a[252:255], v4 offset:15360
  v_mfma_f32_16x16x32_bf16 v[62:65], a[12:15], a[232:235], v[62:65]
  buffer_load_dwordx4 a[44:47], v2, s[4:7], s32 offen offset:3072 sc1
  v_mfma_f32_16x16x32_bf16 v[82:85], a[92:95], a[232:235], v[82:85]
  s_waitcnt lgkmcnt(4)
  ds_read_b128 a[224:227], v4 offset:16384
  v_mfma_f32_16x16x32_bf16 v[66:69], a[12:15], a[236:239], v[66:69]
  s_add_u32 s32, s31, 8192
  buffer_load_dwordx4 a[120:123], v2, s[4:7], s32 offen offset:2048 sc1
  v_mfma_f32_16x16x32_bf16 v[86:89], a[92:95], a[236:239], v[86:89]
  s_waitcnt vmcnt(20) lgkmcnt(4)
  ds_read_b128 a[228:231], v4 offset:17408
  v_mfma_f32_16x16x32_bf16 v[50:53], a[16:19], a[240:243], v[50:53]
  buffer_load_dwordx4 a[124:127], v2, s[4:7], s32 offen offset:3072 sc1
  v_mfma_f32_16x16x32_bf16 v[70:73], a[96:99], a[240:243], v[70:73]
  s_waitcnt lgkmcnt(4)
  ds_read_b128 a[232:235], v4 offset:18432
  v_mfma_f32_16x16x32_bf16 v[54:57], a[16:19], a[244:247], v[54:57]
  s_add_u32 m0, s21, 20480
  v_mfma_f32_16x16x32_bf16 v[74:77], a[96:99], a[244:247], v[74:77]
  s_waitcnt lgkmcnt(4)
  ds_read_b128 a[236:239], v4 offset:19456
  v_mfma_f32_16x16x32_bf16 v[58:61], a[16:19], a[248:251], v[58:61]
  s_add_u32 s33, s22, 61440
  buffer_load_dwordx4 v2, s[4:7], s33 offen offset:0 lds
  v_mfma_f32_16x16x32_bf16 v[78:81], a[96:99], a[248:251], v[78:81]
  s_waitcnt lgkmcnt(4)
  ds_read_b128 a[240:243], v4 offset:20480
  v_mfma_f32_16x16x32_bf16 v[62:65], a[16:19], a[252:255], v[62:65]
  buffer_load_dwordx4 v2, s[4:7], s33 offen offset:1024 lds
  v_mfma_f32_16x16x32_bf16 v[82:85], a[96:99], a[252:255], v[82:85]
  s_waitcnt lgkmcnt(4)
  ds_read_b128 a[244:247], v4 offset:21504
  v_mfma_f32_16x16x32_bf16 v[66:69], a[16:19], a[224:227], v[66:69]
  buffer_load_dwordx4 v2, s[4:7], s33 offen offset:2048 lds
  v_mfma_f32_16x16x32_bf16 v[86:89], a[96:99], a[224:227], v[86:89]
  s_waitcnt lgkmcnt(4)
  ds_read_b128 a[248:251], v4 offset:22528
  v_mfma_f32_16x16x32_bf16 v[50:53], a[20:23], a[228:231], v[50:53]
  buffer_load_dwordx4 v2, s[4:7], s33 offen offset:3072 lds
  v_mfma_f32_16x16x32_bf16 v[70:73], a[100:103], a[228:231], v[70:73]
  s_waitcnt lgkmcnt(4)
  ds_read_b128 a[252:255], v4 offset:23552
  v_mfma_f32_16x16x32_bf16 v[54:57], a[20:23], a[232:235], v[54:57]
  s_add_u32 m0, s21, 24576
  v_mfma_f32_16x16x32_bf16 v[74:77], a[100:103], a[232:235], v[74:77]
  s_waitcnt lgkmcnt(4)
  ds_read_b128 a[224:227], v4 offset:24576
  v_mfma_f32_16x16x32_bf16 v[58:61], a[20:23], a[236:239], v[58:61]
  s_add_u32 s33, s22, 65536
  buffer_load_dwordx4 v2, s[4:7], s33 offen offset:0 lds
  v_mfma_f32_16x16x32_bf16 v[78:81], a[100:103], a[236:239], v[78:81]
  s_waitcnt lgkmcnt(4)
  ds_read_b128 a[228:231], v4 offset:25600
  v_mfma_f32_16x16x32_bf16 v[62:65], a[20:23], a[240:243], v[62:65]
  s_add_u32 s32, s30, 12288
  buffer_load_dwordx4 a[48:51], v2, s[4:7], s32 offen offset:0 sc1
  v_mfma_f32_16x16x32_bf16 v[82:85], a[100:103], a[240:243], v[82:85]
  s_waitcnt lgkmcnt(4)
  ds_read_b128 a[232:235], v4 offset:26624
  v_mfma_f32_16x16x32_bf16 v[66:69], a[20:23], a[244:247], v[66:69]
  buffer_load_dwordx4 a[52:55], v2, s[4:7], s32 offen offset:1024 sc1
  v_mfma_f32_16x16x32_bf16 v[86:89], a[100:103], a[244:247], v[86:89]
  s_waitcnt vmcnt(24) lgkmcnt(4)
  ds_read_b128 a[236:239], v4 offset:27648
  v_mfma_f32_16x16x32_bf16 v[50:53], a[24:27], a[248:251], v[50:53]
  s_add_u32 s32, s31, 12288
  buffer_load_dwordx4 a[128:131], v2, s[4:7], s32 offen offset:0 sc1
  v_mfma_f32_16x16x32_bf16 v[70:73], a[104:107], a[248:251], v[70:73]
  s_waitcnt lgkmcnt(4)
  ds_read_b128 a[240:243], v4 offset:28672
  v_mfma_f32_16x16x32_bf16 v[54:57], a[24:27], a[252:255], v[54:57]
  buffer_load_dwordx4 a[132:135], v2, s[4:7], s32 offen offset:1024 sc1
  v_mfma_f32_16x16x32_bf16 v[74:77], a[104:107], a[252:255], v[74:77]
  s_waitcnt lgkmcnt(4)
  ds_read_b128 a[244:247], v4 offset:29696
  v_mfma_f32_16x16x32_bf16 v[58:61], a[24:27], a[224:227], v[58:61]
  s_add_u32 s32, s30, 12288
  buffer_load_dwordx4 a[56:59], v2, s[4:7], s32 offen offset:2048 sc1
  v_mfma_f32_16x16x32_bf16 v[78:81], a[104:107], a[224:227], v[78:81]
  s_waitcnt lgkmcnt(4)
  ds_read_b128 a[248:251], v4 offset:30720
  v_mfma_f32_16x16x32_bf16 v[62:65], a[24:27], a[228:231], v[62:65]
  buffer_load_dwordx4 a[60:63], v2, s[4:7], s32 offen offset:3072 sc1
  v_mfma_f32_16x16x32_bf16 v[82:85], a[104:107], a[228:231], v[82:85]
  s_waitcnt lgkmcnt(4)
  ds_read_b128 a[252:255], v4 offset:31744
  v_mfma_f32_16x16x32_bf16 v[66:69], a[24:27], a[232:235], v[66:69]
  s_waitcnt vmcnt(23)
  s_barrier
  v_mfma_f32_16x16x32_bf16 v[86:89], a[104:107], a[232:235], v[86:89]
  s_waitcnt lgkmcnt(4)
  ds_read_b128 a[224:227], v2 offset:0
  v_mfma_f32_16x16x32_bf16 v[50:53], a[28:31], a[236:239], v[50:53]
  s_add_u32 s32, s31, 12288
  buffer_load_dwordx4 a[136:139], v2, s[4:7], s32 offen offset:2048 sc1
  v_mfma_f32_16x16x32_bf16 v[70:73], a[108:111], a[236:239], v[70:73]
  s_waitcnt lgkmcnt(4)
  ds_read_b128 a[228:231], v2 offset:1024
  v_mfma_f32_16x16x32_bf16 v[54:57], a[28:31], a[240:243], v[54:57]
  buffer_load_dwordx4 a[140:143], v2, s[4:7], s32 offen offset:3072 sc1
  v_mfma_f32_16x16x32_bf16 v[74:77], a[108:111], a[240:243], v[74:77]
  s_waitcnt lgkmcnt(4)
  ds_read_b128 a[232:235], v2 offset:2048
  v_mfma_f32_16x16x32_bf16 v[58:61], a[28:31], a[244:247], v[58:61]
  s_add_u32 m0, s21, 40960
  v_mfma_f32_16x16x32_bf16 v[78:81], a[108:111], a[244:247], v[78:81]
  s_waitcnt lgkmcnt(4)
  ds_read_b128 a[236:239], v2 offset:3072
  v_mfma_f32_16x16x32_bf16 v[62:65], a[28:31], a[248:251], v[62:65]
  s_add_u32 s33, s22, 81920
  buffer_load_dwordx4 v2, s[4:7], s33 offen offset:0 lds
  v_mfma_f32_16x16x32_bf16 v[82:85], a[108:111], a[248:251], v[82:85]
  s_waitcnt lgkmcnt(4)
  ds_read_b128 a[240:243], v2 offset:4096
  v_mfma_f32_16x16x32_bf16 v[66:69], a[28:31], a[252:255], v[66:69]
  buffer_load_dwordx4 v2, s[4:7], s33 offen offset:1024 lds
  v_mfma_f32_16x16x32_bf16 v[86:89], a[108:111], a[252:255], v[86:89]
  s_waitcnt vmcnt(19) lgkmcnt(4)
  ds_read_b128 a[244:247], v2 offset:5120
  v_mfma_f32_16x16x32_bf16 v[50:53], a[32:35], a[224:227], v[50:53]
  buffer_load_dwordx4 v2, s[4:7], s33 offen offset:2048 lds
  v_mfma_f32_16x16x32_bf16 v[70:73], a[112:115], a[224:227], v[70:73]
  s_waitcnt lgkmcnt(4)
  ds_read_b128 a[248:251], v2 offset:6144
  v_mfma_f32_16x16x32_bf16 v[54:57], a[32:35], a[228:231], v[54:57]
  buffer_load_dwordx4 v2, s[4:7], s33 offen offset:3072 lds
  v_mfma_f32_16x16x32_bf16 v[74:77], a[112:115], a[228:231], v[74:77]
  s_waitcnt lgkmcnt(4)
  ds_read_b128 a[252:255], v2 offset:7168
  v_mfma_f32_16x16x32_bf16 v[58:61], a[32:35], a[232:235], v[58:61]
  s_add_u32 m0, s21, 45056
  v_mfma_f32_16x16x32_bf16 v[78:81], a[112:115], a[232:235], v[78:81]
  s_waitcnt lgkmcnt(4)
  ds_read_b128 a[224:227], v2 offset:8192
  v_mfma_f32_16x16x32_bf16 v[62:65], a[32:35], a[236:239], v[62:65]
  s_add_u32 s33, s22, 86016
  buffer_load_dwordx4 v2, s[4:7], s33 offen offset:0 lds
  v_mfma_f32_16x16x32_bf16 v[82:85], a[112:115], a[236:239], v[82:85]
  s_waitcnt lgkmcnt(4)
  ds_read_b128 a[228:231], v2 offset:9216
  v_mfma_f32_16x16x32_bf16 v[66:69], a[32:35], a[240:243], v[66:69]
  s_add_u32 s32, s30, 16384
  buffer_load_dwordx4 a[64:67], v2, s[4:7], s32 offen offset:0 sc1
  v_mfma_f32_16x16x32_bf16 v[86:89], a[112:115], a[240:243], v[86:89]
  s_waitcnt lgkmcnt(4)
  ds_read_b128 a[232:235], v2 offset:10240
  v_mfma_f32_16x16x32_bf16 v[50:53], a[36:39], a[244:247], v[50:53]
  buffer_load_dwordx4 a[68:71], v2, s[4:7], s32 offen offset:1024 sc1
  v_mfma_f32_16x16x32_bf16 v[70:73], a[116:119], a[244:247], v[70:73]
  s_waitcnt lgkmcnt(4)
  ds_read_b128 a[236:239], v2 offset:11264
  v_mfma_f32_16x16x32_bf16 v[54:57], a[36:39], a[248:251], v[54:57]
  s_add_u32 s32, s31, 16384
  buffer_load_dwordx4 a[144:147], v2, s[4:7], s32 offen offset:0 sc1
  v_mfma_f32_16x16x32_bf16 v[74:77], a[116:119], a[248:251], v[74:77]
  s_waitcnt lgkmcnt(4)
  ds_read_b128 a[240:243], v2 offset:12288
  v_mfma_f32_16x16x32_bf16 v[58:61], a[36:39], a[252:255], v[58:61]
  buffer_load_dwordx4 a[148:151], v2, s[4:7], s32 offen offset:1024 sc1
  v_mfma_f32_16x16x32_bf16 v[78:81], a[116:119], a[252:255], v[78:81]
  s_waitcnt lgkmcnt(4)
  ds_read_b128 a[244:247], v2 offset:13312
  v_mfma_f32_16x16x32_bf16 v[62:65], a[36:39], a[224:227], v[62:65]
  s_add_u32 s32, s30, 16384
  buffer_load_dwordx4 a[72:75], v2, s[4:7], s32 offen offset:2048 sc1
  v_mfma_f32_16x16x32_bf16 v[82:85], a[116:119], a[224:227], v[82:85]
  s_waitcnt lgkmcnt(4)
  ds_read_b128 a[248:251], v2 offset:14336
  buffer_store_dword v25, v251, s[4:7], s34 offen sc1
  v_mfma_f32_16x16x32_bf16 v[66:69], a[36:39], a[228:231], v[66:69]
  buffer_load_dwordx4 a[76:79], v2, s[4:7], s32 offen offset:3072 sc1
  v_mfma_f32_16x16x32_bf16 v[86:89], a[116:119], a[228:231], v[86:89]
  s_waitcnt vmcnt(25) lgkmcnt(4)
  ds_read_b128 a[252:255], v2 offset:15360
  v_mfma_f32_16x16x32_bf16 v[50:53], a[40:43], a[232:235], v[50:53]
  s_add_u32 s32, s31, 16384
  buffer_load_dwordx4 a[152:155], v2, s[4:7], s32 offen offset:2048 sc1
  v_mfma_f32_16x16x32_bf16 v[70:73], a[120:123], a[232:235], v[70:73]
  s_waitcnt lgkmcnt(4)
  ds_read_b128 a[224:227], v2 offset:16384
  v_mfma_f32_16x16x32_bf16 v[54:57], a[40:43], a[236:239], v[54:57]
  buffer_load_dwordx4 a[156:159], v2, s[4:7], s32 offen offset:3072 sc1
  v_mfma_f32_16x16x32_bf16 v[74:77], a[120:123], a[236:239], v[74:77]
  s_waitcnt lgkmcnt(4)
  ds_read_b128 a[228:231], v2 offset:17408
  v_mfma_f32_16x16x32_bf16 v[58:61], a[40:43], a[240:243], v[58:61]
  s_add_u32 m0, s21, 61440
  v_mfma_f32_16x16x32_bf16 v[78:81], a[120:123], a[240:243], v[78:81]
  s_waitcnt lgkmcnt(4)
  ds_read_b128 a[232:235], v2 offset:18432
  v_mfma_f32_16x16x32_bf16 v[62:65], a[40:43], a[244:247], v[62:65]
  s_add_u32 s33, s22, 102400
  buffer_load_dwordx4 v2, s[4:7], s33 offen offset:0 lds
  v_mfma_f32_16x16x32_bf16 v[82:85], a[120:123], a[244:247], v[82:85]
  s_waitcnt lgkmcnt(4)
  ds_read_b128 a[236:239], v2 offset:19456
  v_mfma_f32_16x16x32_bf16 v[66:69], a[40:43], a[248:251], v[66:69]
  s_waitcnt vmcnt(23)
  s_barrier
  buffer_load_dwordx4 v2, s[4:7], s33 offen offset:1024 lds
  v_mfma_f32_16x16x32_bf16 v[86:89], a[120:123], a[248:251], v[86:89]
  s_waitcnt lgkmcnt(4)
  ds_read_b128 a[240:243], v2 offset:20480
  v_mfma_f32_16x16x32_bf16 v[50:53], a[44:47], a[252:255], v[50:53]
  buffer_load_dwordx4 v2, s[4:7], s33 offen offset:2048 lds
  v_mfma_f32_16x16x32_bf16 v[70:73], a[124:127], a[252:255], v[70:73]
  s_waitcnt lgkmcnt(4)
  ds_read_b128 a[244:247], v2 offset:21504
  v_add_f32 v114, v114, v116
  v_mfma_f32_16x16x32_bf16 v[54:57], a[44:47], a[224:227], v[54:57]
  buffer_load_dwordx4 v2, s[4:7], s33 offen offset:3072 lds
  v_mfma_f32_16x16x32_bf16 v[74:77], a[124:127], a[224:227], v[74:77]
  s_waitcnt lgkmcnt(4)
  ds_read_b128 a[248:251], v2 offset:22528
  v_add_f32 v115, v115, v117
  v_mfma_f32_16x16x32_bf16 v[58:61], a[44:47], a[228:231], v[58:61]
  s_add_u32 m0, s21, 65536
  v_mov_b32 v152, v114
  s_nop 1
  v_permlane32_swap_b32 v114, v152
  v_mfma_f32_16x16x32_bf16 v[78:81], a[124:127], a[228:231], v[78:81]
  s_waitcnt lgkmcnt(4)
  ds_read_b128 a[252:255], v2 offset:23552
  v_add_f32 v114, v114, v152
  v_mfma_f32_16x16x32_bf16 v[62:65], a[44:47], a[232:235], v[62:65]
  s_add_u32 s33, s22, 106496
  buffer_load_dwordx4 v2, s[4:7], s33 offen offset:0 lds
  v_mfma_f32_16x16x32_bf16 v[82:85], a[124:127], a[232:235], v[82:85]
  s_waitcnt lgkmcnt(4)
  ds_read_b128 a[224:227], v2 offset:24576
  v_mov_b32 v152, v114
  v_mfma_f32_16x16x32_bf16 v[66:69], a[44:47], a[236:239], v[66:69]
  s_add_u32 m0, s21, 81920
  v_permlane16_swap_b32 v114, v152
  v_add_f32 v114, v114, v152
  v_mfma_f32_16x16x32_bf16 v[86:89], a[124:127], a[236:239], v[86:89]
  s_waitcnt vmcnt(23) lgkmcnt(4)
  ds_read_b128 a[228:231], v2 offset:25600
  v_mov_b32 v153, v115
  v_mfma_f32_16x16x32_bf16 v[50:53], a[48:51], a[240:243], v[50:53]
  s_add_u32 s33, s22, 122880
  buffer_load_dwordx4 v2, s[4:7], s33 offen offset:0 lds
  v_mfma_f32_16x16x32_bf16 v[70:73], a[128:131], a[240:243], v[70:73]
  s_waitcnt lgkmcnt(4)
  ds_read_b128 a[232:235], v2 offset:26624
  v_permlane32_swap_b32 v115, v153
  v_mfma_f32_16x16x32_bf16 v[54:57], a[48:51], a[244:247], v[54:57]
  buffer_load_dwordx4 v2, s[4:7], s33 offen offset:1024 lds
  v_mfma_f32_16x16x32_bf16 v[74:77], a[128:131], a[244:247], v[74:77]
  s_waitcnt lgkmcnt(4)
  ds_read_b128 a[236:239], v2 offset:27648
  v_add_f32 v115, v115, v153
  v_mfma_f32_16x16x32_bf16 v[58:61], a[48:51], a[248:251], v[58:61]
  buffer_load_dwordx4 v2, s[4:7], s33 offen offset:2048 lds
  v_mfma_f32_16x16x32_bf16 v[78:81], a[128:131], a[248:251], v[78:81]
  s_waitcnt lgkmcnt(4)
  ds_read_b128 a[240:243], v2 offset:28672
  v_mov_b32 v153, v115
  v_mfma_f32_16x16x32_bf16 v[62:65], a[48:51], a[252:255], v[62:65]
  buffer_load_dwordx4 v2, s[4:7], s33 offen offset:3072 lds
  v_mfma_f32_16x16x32_bf16 v[82:85], a[128:131], a[252:255], v[82:85]
  s_waitcnt lgkmcnt(4)
  ds_read_b128 a[244:247], v2 offset:29696
  v_permlane16_swap_b32 v115, v153
  v_mfma_f32_16x16x32_bf16 v[66:69], a[48:51], a[224:227], v[66:69]
  s_add_u32 m0, s21, 86016
  v_add_f32 v115, v115, v153
  v_mul_f32 v114, 0xbacccccd, v114
  v_mfma_f32_16x16x32_bf16 v[86:89], a[128:131], a[224:227], v[86:89]
  s_waitcnt lgkmcnt(4)
  ds_read_b128 a[248:251], v2 offset:30720
  v_mul_f32 v115, 0x3acccccd, v115
  v_mfma_f32_16x16x32_bf16 v[50:53], a[52:55], a[228:231], v[50:53]
  s_add_u32 s33, s22, 126976
  buffer_load_dwordx4 v2, s[4:7], s33 offen offset:0 lds
  v_mfma_f32_16x16x32_bf16 v[70:73], a[132:135], a[228:231], v[70:73]
  s_waitcnt lgkmcnt(4)
  ds_read_b128 a[252:255], v2 offset:31744
  v_fma_f32 v115, -v114, v114, v115
  v_mfma_f32_16x16x32_bf16 v[54:57], a[52:55], a[232:235], v[54:57]
  s_add_u32 m0, s21, 102400
  v_max_f32 v115, 0, v115
  v_add_f32 v115, 0x3727c5ac, v115
  v_mfma_f32_16x16x32_bf16 v[74:77], a[132:135], a[232:235], v[74:77]
  s_waitcnt lgkmcnt(4)
  ds_read_b128 a[224:227], v2 offset:32768
  v_cvt_pk_bf16_f32 v152, v114, v114
  v_mfma_f32_16x16x32_bf16 v[58:61], a[52:55], a[236:239], v[58:61]
  s_add_u32 s33, s22, 143360
  buffer_load_dwordx4 v2, s[4:7], s33 offen offset:0 lds
  v_mfma_f32_16x16x32_bf16 v[78:81], a[132:135], a[236:239], v[78:81]
  s_waitcnt lgkmcnt(4)
  ds_read_b128 a[228:231], v2 offset:33792
  v_and_b32 v152, 0xffff0000, v152
  v_mfma_f32_16x16x32_bf16 v[62:65], a[52:55], a[240:243], v[62:65]
  buffer_load_dwordx4 v2, s[4:7], s33 offen offset:1024 lds
  v_mfma_f32_16x16x32_bf16 v[82:85], a[132:135], a[240:243], v[82:85]
  s_waitcnt lgkmcnt(4)
  ds_read_b128 a[232:235], v2 offset:34816
  v_sub_f32 v116, v114, v152
  v_mfma_f32_16x16x32_bf16 v[66:69], a[52:55], a[244:247], v[66:69]
  buffer_load_dwordx4 v2, s[4:7], s33 offen offset:2048 lds
  v_mfma_f32_16x16x32_bf16 v[86:89], a[132:135], a[244:247], v[86:89]
  s_waitcnt vmcnt(27) lgkmcnt(4)
  ds_read_b128 a[236:239], v2 offset:35840
  v_cvt_pk_bf16_f32 v128, v114, v116
  v_mfma_f32_16x16x32_bf16 v[50:53], a[56:59], a[248:251], v[50:53]
  buffer_load_dwordx4 v2, s[4:7], s33 offen offset:3072 lds
  v_mfma_f32_16x16x32_bf16 v[70:73], a[136:139], a[248:251], v[70:73]
  s_waitcnt lgkmcnt(4)
  ds_read_b128 a[240:243], v2 offset:36864
  v_and_b32 v152, 0xffff0000, v128
  v_mfma_f32_16x16x32_bf16 v[54:57], a[56:59], a[252:255], v[54:57]
  s_add_u32 m0, s21, 106496
  v_rsq_f32 v122, v115
  v_mfma_f32_16x16x32_bf16 v[74:77], a[136:139], a[252:255], v[74:77]
  s_waitcnt lgkmcnt(4)
  ds_read_b128 a[244:247], v2 offset:37888
  v_mul_f32 v124, v115, v122
  v_mfma_f32_16x16x32_bf16 v[58:61], a[56:59], a[224:227], v[58:61]
  s_add_u32 s33, s22, 147456
  buffer_load_dwordx4 v2, s[4:7], s33 offen offset:0 lds
  v_mfma_f32_16x16x32_bf16 v[78:81], a[136:139], a[224:227], v[78:81]
  s_waitcnt lgkmcnt(4)
  ds_read_b128 a[248:251], v2 offset:38912
  v_sub_f32 v117, v116, v152
  v_mfma_f32_16x16x32_bf16 v[62:65], a[56:59], a[228:231], v[62:65]
  s_mul_i32 s33, s12, 2048
  v_mov_b32 v129, v128
  v_cvt_pk_bf16_f32 v130, v114, v117
  v_mfma_f32_16x16x32_bf16 v[82:85], a[136:139], a[228:231], v[82:85]
  s_waitcnt lgkmcnt(4)
  ds_read_b128 a[252:255], v2 offset:39936
  v_mov_b32 v131, 0
  v_mfma_f32_16x16x32_bf16 v[66:69], a[56:59], a[232:235], v[66:69]
  s_waitcnt vmcnt(24)
  s_barrier
  v_mul_f32 v126, 0x3fb8aa3b, v122
  v_mfma_f32_16x16x32_bf16 v[86:89], a[136:139], a[232:235], v[86:89]
  s_waitcnt lgkmcnt(4)
  ds_read_b128 a[224:227], v2 offset:40960
  v_add_f32 v118, v118, v120
  v_mfma_f32_16x16x32_bf16 v[50:53], a[60:63], a[236:239], v[50:53]
  s_add_u32 m0, s33, 122880
  v_add_f32 v119, v119, v121
  v_mov_b32 v152, v118
  v_mfma_f32_16x16x32_bf16 v[70:73], a[140:143], a[236:239], v[70:73]
  s_waitcnt lgkmcnt(4)
  ds_read_b128 a[228:231], v2 offset:41984
  v_permlane32_swap_b32 v118, v152
  v_mfma_f32_16x16x32_bf16 v[54:57], a[60:63], a[240:243], v[54:57]
  s_sub_u32 s33, s33, s21
  v_add_f32 v118, v118, v152
  v_mov_b32 v152, v118
  v_mfma_f32_16x16x32_bf16 v[74:77], a[140:143], a[240:243], v[74:77]
  s_waitcnt lgkmcnt(4)
  ds_read_b128 a[232:235], v2 offset:43008
  v_permlane16_swap_b32 v118, v152
  v_mfma_f32_16x16x32_bf16 v[58:61], a[60:63], a[244:247], v[58:61]
  s_add_u32 s33, s33, s22
  v_add_f32 v118, v118, v152
  v_mov_b32 v153, v119
  v_mfma_f32_16x16x32_bf16 v[78:81], a[140:143], a[244:247], v[78:81]
  s_waitcnt lgkmcnt(4)
  ds_read_b128 a[236:239], v2 offset:44032
  v_permlane32_swap_b32 v119, v153
  v_mfma_f32_16x16x32_bf16 v[62:65], a[60:63], a[248:251], v[62:65]
  s_add_u32 s33, s33, 163840
  buffer_load_dwordx4 v2, s[4:7], s33 offen offset:0 lds
  v_mfma_f32_16x16x32_bf16 v[82:85], a[140:143], a[248:251], v[82:85]
  s_waitcnt lgkmcnt(4)
  ds_read_b128 a[240:243], v2 offset:45056
  v_add_f32 v119, v119, v153
  v_mfma_f32_16x16x32_bf16 v[66:69], a[60:63], a[252:255], v[66:69]
  buffer_load_dwordx4 v2, s[4:7], s33 offen offset:1024 lds
  v_mfma_f32_16x16x32_bf16 v[86:89], a[140:143], a[252:255], v[86:89]
  s_waitcnt vmcnt(22) lgkmcnt(4)
  ds_read_b128 a[244:247], v2 offset:46080
  v_mov_b32 v153, v119
  v_mfma_f32_16x16x32_bf16 v[50:53], a[64:67], a[224:227], v[50:53]
  buffer_load_dwordx4 v[32:35], v2, s[4:7], s61 offen offset:0 sc1
  v_mfma_f32_16x16x32_bf16 v[70:73], a[144:147], a[224:227], v[70:73]
  s_waitcnt lgkmcnt(4)
  ds_read_b128 a[248:251], v2 offset:47104
  v_permlane16_swap_b32 v119, v153
  v_mfma_f32_16x16x32_bf16 v[54:57], a[64:67], a[228:231], v[54:57]
  buffer_load_dwordx4 v[36:39], v2, s[4:7], s61 offen offset:1024 sc1
  v_mfma_f32_16x16x32_bf16 v[74:77], a[144:147], a[228:231], v[74:77]
  s_waitcnt lgkmcnt(4)
  ds_read_b128 a[252:255], v2 offset:48128
  v_add_f32 v119, v119, v153
  v_mfma_f32_16x16x32_bf16 v[58:61], a[64:67], a[232:235], v[58:61]
  buffer_load_dwordx2 v[40:41], v8, s[4:7], s61 offen offset:2048 sc1
  v_mfma_f32_16x16x32_bf16 v[78:81], a[144:147], a[232:235], v[78:81]
  s_waitcnt lgkmcnt(4)
  ds_read_b128 a[224:227], v2 offset:49152
  v_mul_f32 v118, 0xbacccccd, v118
  v_mfma_f32_16x16x32_bf16 v[62:65], a[64:67], a[236:239], v[62:65]
  v_mul_f32 v119, 0x3acccccd, v119
  v_fma_f32 v119, -v118, v118, v119
  v_mfma_f32_16x16x32_bf16 v[82:85], a[144:147], a[236:239], v[82:85]
  s_waitcnt lgkmcnt(4)
  ds_read_b128 a[228:231], v2 offset:50176
  v_max_f32 v119, 0, v119
  v_mfma_f32_16x16x32_bf16 v[66:69], a[64:67], a[240:243], v[66:69]
  v_add_f32 v119, 0x3727c5ac, v119
  v_cvt_pk_bf16_f32 v152, v118, v118
  v_mfma_f32_16x16x32_bf16 v[86:89], a[144:147], a[240:243], v[86:89]
  s_waitcnt lgkmcnt(4)
  ds_read_b128 a[232:235], v2 offset:51200
  v_and_b32 v152, 0xffff0000, v152
  v_mfma_f32_16x16x32_bf16 v[50:53], a[68:71], a[244:247], v[50:53]
  v_rsq_f32 v123, v119
  v_mfma_f32_16x16x32_bf16 v[70:73], a[148:151], a[244:247], v[70:73]
  s_waitcnt lgkmcnt(4)
  ds_read_b128 a[236:239], v2 offset:52224
  v_mul_f32 v125, v119, v123
  v_mfma_f32_16x16x32_bf16 v[54:57], a[68:71], a[248:251], v[54:57]
  v_sub_f32 v120, v118, v152
  v_cvt_pk_bf16_f32 v132, v118, v120
  v_mfma_f32_16x16x32_bf16 v[74:77], a[148:151], a[248:251], v[74:77]
  s_waitcnt lgkmcnt(4)
  ds_read_b128 a[240:243], v2 offset:53248
  v_and_b32 v152, 0xffff0000, v132
  v_mfma_f32_16x16x32_bf16 v[58:61], a[68:71], a[252:255], v[58:61]
  v_sub_f32 v121, v120, v152
  v_mov_b32 v133, v132
  v_mfma_f32_16x16x32_bf16 v[78:81], a[148:151], a[252:255], v[78:81]
  s_waitcnt lgkmcnt(4)
  ds_read_b128 a[244:247], v2 offset:54272
  v_cvt_pk_bf16_f32 v134, v118, v121
  v_mfma_f32_16x16x32_bf16 v[62:65], a[68:71], a[224:227], v[62:65]
  v_mov_b32 v135, 0
  v_mul_f32 v127, 0x3fb8aa3b, v123
  v_mfma_f32_16x16x32_bf16 v[82:85], a[148:151], a[224:227], v[82:85]
  s_waitcnt lgkmcnt(4)
  ds_read_b128 a[248:251], v2 offset:55296
  ds_write_b32 v26, v122 offset:0
  v_mfma_f32_16x16x32_bf16 v[66:69], a[68:71], a[228:231], v[66:69]
  ds_write_b32 v26, v123 offset:64
  buffer_load_dwordx4 v[252:255], v2, s[4:7], s60 offen sc1
  v_mfma_f32_16x16x32_bf16 v[86:89], a[148:151], a[228:231], v[86:89]
  s_waitcnt vmcnt(21) lgkmcnt(6)
  ds_read_b128 a[252:255], v2 offset:56320
  v_mfma_f32_16x16x32_bf16 v[50:53], a[72:75], a[232:235], v[50:53]
  s_waitcnt lgkmcnt(1)
  ds_read_b128 v[136:139], v27 offset:0
  ds_read_b128 v[140:143], v27 offset:64
  v_mfma_f32_16x16x32_bf16 v[70:73], a[152:155], a[232:235], v[70:73]
  ds_read_b128 a[224:227], v2 offset:57344
  v_mfma_f32_16x16x32_bf16 v[54:57], a[72:75], a[236:239], v[54:57]
  v_mfma_f32_16x16x32_bf16 v[74:77], a[152:155], a[236:239], v[74:77]
  ds_read_b128 a[228:231], v2 offset:58368
  v_mfma_f32_16x16x32_bf16 v[58:61], a[72:75], a[240:243], v[58:61]
  v_mfma_f32_16x16x32_bf16 v[78:81], a[152:155], a[240:243], v[78:81]
  ds_read_b128 a[232:235], v2 offset:59392
  v_mfma_f32_16x16x32_bf16 v[62:65], a[72:75], a[244:247], v[62:65]
  v_mfma_f32_16x16x32_bf16 v[82:85], a[152:155], a[244:247], v[82:85]
  ds_read_b128 a[236:239], v2 offset:60416
  v_mfma_f32_16x16x32_bf16 v[66:69], a[72:75], a[248:251], v[66:69]
  s_waitcnt vmcnt(16)
  s_barrier
  v_mfma_f32_16x16x32_bf16 v[86:89], a[152:155], a[248:251], v[86:89]
  s_waitcnt lgkmcnt(6)
  ds_read_b128 a[240:243], v2 offset:61440
  v_mfma_f32_16x16x32_bf16 v[50:53], a[76:79], a[252:255], v[50:53]
  s_waitcnt lgkmcnt(5)
  v_mul_f32 v144, 0x3fb8aa3b, v136
  v_mul_f32 v145, 0x3fb8aa3b, v137
  v_mfma_f32_16x16x32_bf16 v[70:73], a[156:159], a[252:255], v[70:73]
  s_waitcnt lgkmcnt(4)
  ds_read_b128 a[244:247], v2 offset:62464
  v_mul_f32 v146, 0x3fb8aa3b, v138
  v_mfma_f32_16x16x32_bf16 v[54:57], a[76:79], a[224:227], v[54:57]
  v_mul_f32 v147, 0x3fb8aa3b, v139
  v_mul_f32 v148, 0x3fb8aa3b, v140
  v_mfma_f32_16x16x32_bf16 v[74:77], a[156:159], a[224:227], v[74:77]
  s_waitcnt lgkmcnt(4)
  ds_read_b128 a[248:251], v2 offset:63488
  v_mul_f32 v149, 0x3fb8aa3b, v141
  v_mfma_f32_16x16x32_bf16 v[58:61], a[76:79], a[228:231], v[58:61]
  v_mul_f32 v150, 0x3fb8aa3b, v142
  v_mul_f32 v151, 0x3fb8aa3b, v143
  v_mfma_f32_16x16x32_bf16 v[78:81], a[156:159], a[228:231], v[78:81]
  s_waitcnt lgkmcnt(4)
  ds_read_b128 a[252:255], v2 offset:64512
  v_mfma_f32_16x16x32_bf16 v[62:65], a[76:79], a[232:235], v[62:65]
  s_waitcnt vmcnt(0)
  v_min_u32 v253, v252, v253
  v_min3_u32 v253, v253, v254, v255
  v_cmp_eq_u32 vcc, 0, v253
  s_nop 1
  s_cbranch_vccz L_ok0
  s_mov_b32 s37, 200000
L_sp0:
  buffer_load_dwordx4 v[252:255], v2, s[4:7], s60 offen sc1
  s_waitcnt vmcnt(0)
  v_min_u32 v253, v252, v253
  v_min3_u32 v253, v253, v254, v255
  v_cmp_eq_u32 vcc, 0, v253
  s_nop 1
  s_cbranch_vccz L_ok0
  s_sub_u32 s37, s37, 1
  s_cmp_lg_u32 s37, 0
  s_cbranch_scc1 L_sp0
L_ok0:
  v_mfma_f32_16x16x32_bf16 v[82:85], a[156:159], a[232:235], v[82:85]
  s_waitcnt lgkmcnt(4)
  ds_read_b128 a[224:227], v3 offset:0
  v_mfma_f32_16x16x32_bf16 v[66:69], a[76:79], a[236:239], v[66:69]
  v_mfma_f32_16x16x32_bf16 v[86:89], a[156:159], a[236:239], v[86:89]
  s_waitcnt lgkmcnt(4)
  ds_read_b128 a[228:231], v3 offset:1024
  v_mfma_f32_16x16x32_bf16 v[50:53], v[128:131], a[240:243], v[50:53]
  v_mfma_f32_16x16x32_bf16 v[70:73], v[132:135], a[240:243], v[70:73]
  s_waitcnt lgkmcnt(4)
  ds_read_b128 a[232:235], v3 offset:2048
  v_mfma_f32_16x16x32_bf16 v[54:57], v[128:131], a[244:247], v[54:57]
  v_mfma_f32_16x16x32_bf16 v[74:77], v[132:135], a[244:247], v[74:77]
  s_waitcnt lgkmcnt(4)
  ds_read_b128 a[236:239], v3 offset:3072
  v_mfma_f32_16x16x32_bf16 v[58:61], v[128:131], a[248:251], v[58:61]
  v_mfma_f32_16x16x32_bf16 v[78:81], v[132:135], a[248:251], v[78:81]
  s_waitcnt lgkmcnt(4)
  ds_read_b128 a[240:243], v3 offset:4096
  v_mfma_f32_16x16x32_bf16 v[62:65], v[128:131], a[252:255], v[62:65]
  v_mfma_f32_16x16x32_bf16 v[82:85], v[132:135], a[252:255], v[82:85]
  s_waitcnt lgkmcnt(4)
  ds_read_b128 a[244:247], v3 offset:5120
  v_mfma_f32_16x16x32_bf16 v[66:69], v[128:131], a[224:227], v[66:69]
  v_mfma_f32_16x16x32_bf16 v[86:89], v[132:135], a[224:227], v[86:89]
  s_waitcnt lgkmcnt(4)
  ds_read_b128 a[248:251], v3 offset:6144
  v_mfma_f32_16x16x32_bf16 v[90:93], a[228:231], a[0:3], 0
  s_add_u32 m0, s21, 20480
  v_mfma_f32_16x16x32_bf16 v[102:105], a[228:231], a[80:83], 0
  s_waitcnt lgkmcnt(4)
  ds_read_b128 a[252:255], v3 offset:7168
  v_mfma_f32_16x16x32_bf16 v[94:97], a[232:235], a[0:3], 0
  s_add_u32 s33, s23, 0
  buffer_load_dwordx4 v2, s[4:7], s33 offen offset:0 lds
  v_mul_f32 v152, v50, v144
  v_mul_f32 v153, v51, v145
  v_exp_f32 v152, v152 clamp
  v_exp_f32 v153, v153 clamp
  v_mfma_f32_16x16x32_bf16 v[106:109], a[232:235], a[80:83], 0
  s_waitcnt lgkmcnt(4)
  ds_read_b128 a[224:227], v3 offset:8192
  v_mul_f32 v154, v52, v146
  v_mul_f32 v155, v53, v147
  v_exp_f32 v154, v154 clamp
  v_exp_f32 v155, v155 clamp
  v_fma_f32 v50, v50, v136, s29
  v_mfma_f32_16x16x32_bf16 v[98:101], a[236:239], a[0:3], 0
  buffer_load_dwordx4 v2, s[4:7], s33 offen offset:1024 lds
  v_fma_f32 v51, v51, v137, s29
  v_fma_f32 v52, v52, v138, s29
  v_fma_f32 v53, v53, v139, s29
  v_max_f32 v50, s29, v50
  v_max_f32 v51, s29, v51
  v_max_f32 v52, s29, v52
  v_mfma_f32_16x16x32_bf16 v[110:113], a[236:239], a[80:83], 0
  s_waitcnt lgkmcnt(4)
  ds_read_b128 a[228:231], v3 offset:9216
  v_max_f32 v53, s29, v53
  v_add_f32 v50, v50, v152
  v_add_f32 v51, v51, v153
  v_add_f32 v52, v52, v154
  v_add_f32 v53, v53, v155
  v_cvt_pk_bf16_f32 v176, v50, v51
  v_cvt_pk_bf16_f32 v177, v52, v53
  v_mfma_f32_16x16x32_bf16 v[90:93], a[240:243], a[4:7], v[90:93]
  buffer_load_dwordx4 v2, s[4:7], s33 offen offset:2048 lds
  v_mul_f32 v156, v70, v148
  v_mul_f32 v157, v71, v149
  v_exp_f32 v156, v156 clamp
  v_exp_f32 v157, v157 clamp
  v_mfma_f32_16x16x32_bf16 v[102:105], a[240:243], a[84:87], v[102:105]
  s_waitcnt lgkmcnt(4)
  ds_read_b128 a[232:235], v3 offset:10240
  v_mul_f32 v158, v72, v150
  v_mul_f32 v159, v73, v151
  v_exp_f32 v158, v158 clamp
  v_exp_f32 v159, v159 clamp
  v_fma_f32 v70, v70, v140, s29
  v_mfma_f32_16x16x32_bf16 v[94:97], a[244:247], a[4:7], v[94:97]
  buffer_load_dwordx4 v2, s[4:7], s33 offen offset:3072 lds
  v_fma_f32 v71, v71, v141, s29
  v_fma_f32 v72, v72, v142, s29
  v_fma_f32 v73, v73, v143, s29
  v_max_f32 v70, s29, v70
  v_max_f32 v71, s29, v71
  v_max_f32 v72, s29, v72
  v_mfma_f32_16x16x32_bf16 v[106:109], a[244:247], a[84:87], v[106:109]
  s_waitcnt lgkmcnt(4)
  ds_read_b128 a[236:239], v3 offset:11264
  v_max_f32 v73, s29, v73
  v_add_f32 v70, v70, v156
  v_add_f32 v71, v71, v157
  v_add_f32 v72, v72, v158
  v_add_f32 v73, v73, v159
  v_cvt_pk_bf16_f32 v178, v70, v71
  v_cvt_pk_bf16_f32 v179, v72, v73
  v_mfma_f32_16x16x32_bf16 v[98:101], a[248:251], a[4:7], v[98:101]
  s_add_u32 m0, s21, 24576
  v_mul_f32 v152, v54, v144
  v_mul_f32 v153, v55, v145
  v_exp_f32 v152, v152 clamp
  v_exp_f32 v153, v153 clamp
  v_mul_f32 v154, v56, v146
  v_mul_f32 v155, v57, v147
  v_mfma_f32_16x16x32_bf16 v[110:113], a[248:251], a[84:87], v[110:113]
  s_waitcnt lgkmcnt(4)
  ds_read_b128 a[240:243], v3 offset:12288
  v_exp_f32 v154, v154 clamp
  v_exp_f32 v155, v155 clamp
  v_fma_f32 v54, v54, v136, s29
  v_fma_f32 v55, v55, v137, s29
  v_fma_f32 v56, v56, v138, s29
  v_mfma_f32_16x16x32_bf16 v[90:93], a[252:255], a[8:11], v[90:93]
  s_add_u32 s33, s23, 4096
  buffer_load_dwordx4 v2, s[4:7], s33 offen offset:0 lds
  v_fma_f32 v57, v57, v139, s29
  v_max_f32 v54, s29, v54
  v_max_f32 v55, s29, v55
  v_max_f32 v56, s29, v56
  v_max_f32 v57, s29, v57
  v_add_f32 v54, v54, v152
  v_mfma_f32_16x16x32_bf16 v[102:105], a[252:255], a[88:91], v[102:105]
  s_waitcnt lgkmcnt(4)
  ds_read_b128 a[244:247], v3 offset:13312
  v_add_f32 v55, v55, v153
  v_add_f32 v56, v56, v154
  v_add_f32 v57, v57, v155
  v_cvt_pk_bf16_f32 v180, v54, v55
  v_cvt_pk_bf16_f32 v181, v56, v57
  v_mul_f32 v156, v74, v148
  v_mul_f32 v157, v75, v149
  v_mfma_f32_16x16x32_bf16 v[94:97], a[224:227], a[8:11], v[94:97]
  s_add_u32 m0, s21, 0
  v_exp_f32 v156, v156 clamp
  v_exp_f32 v157, v157 clamp
  v_mul_f32 v158, v76, v150
  v_mul_f32 v159, v77, v151
  v_exp_f32 v158, v158 clamp
  v_mfma_f32_16x16x32_bf16 v[106:109], a[224:227], a[88:91], v[106:109]
  s_waitcnt lgkmcnt(4)
  ds_read_b128 a[248:251], v3 offset:14336
  v_exp_f32 v159, v159 clamp
  v_fma_f32 v74, v74, v140, s29
  v_fma_f32 v75, v75, v141, s29
  v_fma_f32 v76, v76, v142, s29
  v_fma_f32 v77, v77, v143, s29
  v_max_f32 v74, s29, v74
  v_mfma_f32_16x16x32_bf16 v[98:101], a[228:231], a[8:11], v[98:101]
  s_add_u32 s33, s24, 0
  buffer_load_dwordx4 v2, s[4:7], s33 offen offset:0 lds
  v_max_f32 v75, s29, v75
  v_max_f32 v76, s29, v76
  v_max_f32 v77, s29, v77
  v_add_f32 v74, v74, v156
  v_add_f32 v75, v75, v157
  v_add_f32 v76, v76, v158
  v_mfma_f32_16x16x32_bf16 v[110:113], a[228:231], a[88:91], v[110:113]
  s_waitcnt lgkmcnt(4)
  ds_read_b128 a[252:255], v3 offset:15360
  v_add_f32 v77, v77, v159
  v_cvt_pk_bf16_f32 v182, v74, v75
  v_cvt_pk_bf16_f32 v183, v76, v77
  v_mul_f32 v152, v58, v144
  v_mul_f32 v153, v59, v145
  v_exp_f32 v152, v152 clamp
  v_mfma_f32_16x16x32_bf16 v[90:93], a[232:235], a[12:15], v[90:93]
  s_barrier
  v_exp_f32 v153, v153 clamp
  v_mul_f32 v154, v60, v146
  v_mul_f32 v155, v61, v147
  v_exp_f32 v154, v154 clamp
  v_fma_f32 v160, v58, v136, s29
  v_mfma_f32_16x16x32_bf16 v[102:105], a[232:235], a[92:95], v[102:105]
  s_waitcnt lgkmcnt(4)
  ds_read_b128 a[224:227], v3 offset:16384
  v_exp_f32 v155, v155 clamp
  v_fma_f32 v161, v59, v137, s29
  v_fma_f32 v162, v60, v138, s29
  v_fma_f32 v163, v61, v139, s29
  v_max_f32 v160, s29, v160
  v_max_f32 v161, s29, v161
  v_mfma_f32_16x16x32_bf16 v[94:97], a[236:239], a[12:15], v[94:97]
  s_add_u32 m0, s21, 40960
  v_max_f32 v162, s29, v162
  v_max_f32 v163, s29, v163
  v_add_f32 v160, v160, v152
  v_add_f32 v161, v161, v153
  v_add_f32 v162, v162, v154
  v_add_f32 v163, v163, v155
  v_mul_f32 v58, v58, v136
  v_mul_f32 v59, v59, v137
  v_mfma_f32_16x16x32_bf16 v[106:109], a[236:239], a[92:95], v[106:109]
  s_waitcnt lgkmcnt(4)
  ds_read_b128 a[228:231], v3 offset:17408
  v_mul_f32 v60, v60, v138
  v_mul_f32 v61, v61, v139
  v_cndmask_b32 v58, v58, v160, s[38:39]
  v_cndmask_b32 v59, v59, v161, s[38:39]
  v_cndmask_b32 v60, v60, v162, s[38:39]
  v_cndmask_b32 v61, v61, v163, s[38:39]
  v_cvt_pk_bf16_f32 v184, v58, v59
  v_mfma_f32_16x16x32_bf16 v[98:101], a[240:243], a[12:15], v[98:101]
  s_add_u32 s33, s23, 20480
  buffer_load_dwordx4 v2, s[4:7], s33 offen offset:0 lds
  v_cvt_pk_bf16_f32 v185, v60, v61
  v_mul_f32 v156, v78, v148
  v_mul_f32 v157, v79, v149
  v_exp_f32 v156, v156 clamp
  v_mul_f32 v158, v80, v150
  v_mfma_f32_16x16x32_bf16 v[110:113], a[240:243], a[92:95], v[110:113]
  s_waitcnt lgkmcnt(4)
  ds_read_b128 a[232:235], v3 offset:18432
  v_exp_f32 v157, v157 clamp
  v_exp_f32 v158, v158 clamp
  v_mul_f32 v159, v81, v151
  v_fma_f32 v164, v78, v140, s29
  v_fma_f32 v165, v79, v141, s29
  v_mfma_f32_16x16x32_bf16 v[90:93], a[244:247], a[16:19], v[90:93]
  buffer_load_dwordx4 v2, s[4:7], s33 offen offset:1024 lds
  v_exp_f32 v159, v159 clamp
  v_fma_f32 v166, v80, v142, s29
  v_fma_f32 v167, v81, v143, s29
  v_max_f32 v164, s29, v164
  v_max_f32 v165, s29, v165
  v_mfma_f32_16x16x32_bf16 v[102:105], a[244:247], a[96:99], v[102:105]
  s_waitcnt lgkmcnt(4)
  ds_read_b128 a[236:239], v3 offset:19456
  v_max_f32 v166, s29, v166
  v_max_f32 v167, s29, v167
  v_add_f32 v164, v164, v156
  v_add_f32 v165, v165, v157
  v_add_f32 v166, v166, v158
  v_add_f32 v167, v167, v159
  v_mul_f32 v78, v78, v140
  v_mfma_f32_16x16x32_bf16 v[94:97], a[248:251], a[16:19], v[94:97]
  buffer_load_dwordx4 v2, s[4:7], s33 offen offset:2048 lds
  v_mul_f32 v79, v79, v141
  v_mul_f32 v80, v80, v142
  v_mul_f32 v81, v81, v143
  v_cndmask_b32 v78, v78, v164, s[38:39]
  v_cndmask_b32 v79, v79, v165, s[38:39]
  v_cndmask_b32 v80, v80, v166, s[38:39]
  v_mfma_f32_16x16x32_bf16 v[106:109], a[248:251], a[96:99], v[106:109]
  s_waitcnt lgkmcnt(4)
  ds_read_b128 a[240:243], v3 offset:20480
  v_cndmask_b32 v81, v81, v167, s[38:39]
  v_cvt_pk_bf16_f32 v186, v78, v79
  v_cvt_pk_bf16_f32 v187, v80, v81
  v_mul_f32 v62, v62, v136
  v_mul_f32 v63, v63, v137
  v_mul_f32 v64, v64, v138
  v_mul_f32 v65, v65, v139
  v_mfma_f32_16x16x32_bf16 v[98:101], a[252:255], a[16:19], v[98:101]
  buffer_load_dwordx4 v2, s[4:7], s33 offen offset:3072 lds
  v_cvt_pk_bf16_f32 v188, v62, v63
  v_cvt_pk_bf16_f32 v189, v64, v65
  v_mul_f32 v82, v82, v140
  v_mul_f32 v83, v83, v141
  v_mul_f32 v84, v84, v142
  v_mul_f32 v85, v85, v143
  v_mfma_f32_16x16x32_bf16 v[110:113], a[252:255], a[96:99], v[110:113]
  s_waitcnt lgkmcnt(4)
  ds_read_b128 a[244:247], v3 offset:21504
  v_cvt_pk_bf16_f32 v190, v82, v83
  v_cvt_pk_bf16_f32 v191, v84, v85
  v_mul_f32 v66, v66, v136
  v_mul_f32 v67, v67, v137
  v_mul_f32 v68, v68, v138
  v_mul_f32 v69, v69, v139
  v_cvt_pk_bf16_f32 v192, v66, v67
  v_mfma_f32_16x16x32_bf16 v[90:93], a[224:227], a[20:23], v[90:93]
  s_add_u32 m0, s21, 45056
  v_cvt_pk_bf16_f32 v193, v68, v69
  v_mul_f32 v86, v86, v140
  v_mul_f32 v87, v87, v141
  v_mul_f32 v88, v88, v142
  v_mul_f32 v89, v89, v143
  v_cvt_pk_bf16_f32 v194, v86, v87
  v_cvt_pk_bf16_f32 v195, v88, v89
  v_mfma_f32_16x16x32_bf16 v[50:53], v[176:179], v[184:187], 0
  v_mfma_f32_16x16x32_bf16 v[102:105], a[224:227], a[100:103], v[102:105]
  s_waitcnt lgkmcnt(4)
  ds_read_b128 a[248:251], v3 offset:22528
  v_mfma_f32_16x16x32_bf16 v[54:57], v[176:179], v[188:191], 0
  v_mfma_f32_16x16x32_bf16 v[58:61], v[180:183], v[184:187], 0
  v_mfma_f32_16x16x32_bf16 v[62:65], v[180:183], v[188:191], 0
  v_mfma_f32_16x16x32_bf16 v[94:97], a[228:231], a[20:23], v[94:97]
  s_add_u32 s33, s23, 24576
  buffer_load_dwordx4 v2, s[4:7], s33 offen offset:0 lds
  v_mfma_f32_16x16x32_bf16 v[66:69], v[180:183], v[192:195], 0
  v_mfma_f32_16x16x32_bf16 v[70:73], v[184:187], v[188:191], 0
  v_mfma_f32_16x16x32_bf16 v[106:109], a[228:231], a[100:103], v[106:109]
  s_waitcnt lgkmcnt(4)
  ds_read_b128 a[252:255], v3 offset:23552
  v_mfma_f32_16x16x32_bf16 v[74:77], v[184:187], v[192:195], 0
  v_mfma_f32_16x16x32_bf16 v[78:81], v[176:179], v[46:49], 0
  v_mfma_f32_16x16x32_bf16 v[82:85], v[180:183], v[46:49], 0
  v_mfma_f32_16x16x32_bf16 v[98:101], a[232:235], a[20:23], v[98:101]
  s_add_u32 m0, s21, 0
  v_mfma_f32_16x16x32_bf16 v[86:89], v[184:187], v[46:49], 0
  s_mov_b64 exec, s[40:41]
  ds_write_b128 v11, v[50:53] offset:512
  s_mov_b64 exec, s[42:43]
  ds_write_b128 v11, v[54:57] offset:768
  s_mov_b64 exec, -1
  v_mfma_f32_16x16x32_bf16 v[110:113], a[232:235], a[100:103], v[110:113]
  s_waitcnt lgkmcnt(6)
  ds_read_b128 a[224:227], v3 offset:24576
  s_mov_b64 exec, s[44:45]
  ds_write_b128 v12, v[58:61] offset:1856
  s_mov_b64 exec, s[46:47]
  ds_write_b128 v12, v[62:65] offset:2112
  s_mov_b64 exec, -1
  s_mov_b64 exec, s[48:49]
  ds_write_b128 v12, v[66:69] offset:2368
  s_mov_b64 exec, s[50:51]
  ds_write_b128 v11, v[70:73] offset:3136
  s_mov_b64 exec, -1
  v_mfma_f32_16x16x32_bf16 v[90:93], a[236:239], a[24:27], v[90:93]
  s_add_u32 s33, s24, 0
  buffer_load_dwordx4 v2, s[4:7], s33 offen offset:1024 lds
  s_mov_b64 exec, s[52:53]
  ds_write_b128 v11, v[74:77] offset:3392
  s_mov_b64 exec, s[54:55]
  ds_write_b128 v11, v[78:81] offset:960
  s_mov_b64 exec, -1
  s_mov_b64 exec, s[56:57]
  ds_write_b128 v11, v[82:85] offset:2304
  s_mov_b64 exec, s[58:59]
  ds_write_b128 v11, v[86:89] offset:3648
  s_mov_b64 exec, -1
  v_mfma_f32_16x16x32_bf16 v[102:105], a[236:239], a[104:107], v[102:105]
  s_waitcnt lgkmcnt(14)
  ds_read_b128 a[228:231], v3 offset:25600
  v_mfma_f32_16x16x32_bf16 v[94:97], a[240:243], a[24:27], v[94:97]
  s_waitcnt lgkmcnt(1)
  buffer_load_dwordx4 v2, s[4:7], s33 offen offset:2048 lds
  s_barrier
  ds_read_b32 v152, v13 offset:0
  ds_read_b32 v153, v13 offset:3360
  ds_read_b32 v154, v13 offset:6720
  ds_read_b32 v155, v13 offset:10080
  ds_read_b32 v156, v13 offset:1024
  v_mfma_f32_16x16x32_bf16 v[106:109], a[240:243], a[104:107], v[106:109]
  ds_read_b128 a[232:235], v3 offset:26624
  ds_read_b32 v157, v13 offset:4384
  ds_read_b32 v158, v13 offset:7744
  ds_read_b32 v159, v13 offset:11104
  ds_read_b32 v160, v13 offset:2048
  ds_read_b32 v161, v13 offset:5408
  ds_read_b32 v162, v13 offset:8768
  ds_read_b32 v163, v13 offset:12128
  v_mfma_f32_16x16x32_bf16 v[98:101], a[244:247], a[24:27], v[98:101]
  buffer_load_dwordx4 v2, s[4:7], s33 offen offset:3072 lds
  ds_read_b32 v164, v13 offset:3072
  ds_read_b32 v165, v13 offset:6432
  ds_read_b32 v166, v13 offset:9792
  ds_read_b32 v167, v13 offset:13152
  s_mul_i32 s36, s14, 3360
  s_add_u32 s36, s36, s20
  v_mfma_f32_16x16x32_bf16 v[110:113], a[244:247], a[104:107], v[110:113]
  ds_read_b128 a[236:239], v3 offset:27648
  s_add_u32 s36, s36, 25825280
  v_mfma_f32_16x16x32_bf16 v[90:93], a[248:251], a[28:31], v[90:93]
  s_add_u32 m0, s21, 4096
  v_mfma_f32_16x16x32_bf16 v[102:105], a[248:251], a[108:111], v[102:105]
  ds_read_b128 a[240:243], v3 offset:28672
  v_mfma_f32_16x16x32_bf16 v[94:97], a[252:255], a[28:31], v[94:97]
  s_add_u32 s33, s24, 4096
  buffer_load_dwordx4 v2, s[4:7], s33 offen offset:0 lds
  v_mfma_f32_16x16x32_bf16 v[106:109], a[252:255], a[108:111], v[106:109]
  ds_read_b128 a[244:247], v3 offset:29696
  v_mfma_f32_16x16x32_bf16 v[98:101], a[224:227], a[28:31], v[98:101]
  s_waitcnt lgkmcnt(15)
  v_add_f32 v152, v152, v153
  v_add_f32 v154, v154, v155
  v_add_f32 v152, v152, v154
  buffer_atomic_add_f32 v152, v14, s[4:7], s36 offen offset:0
  v_mfma_f32_16x16x32_bf16 v[110:113], a[224:227], a[108:111], v[110:113]
  ds_read_b128 a[248:251], v3 offset:30720
  v_mfma_f32_16x16x32_bf16 v[90:93], a[228:231], a[32:35], v[90:93]
  s_waitcnt lgkmcnt(12)
  v_add_f32 v156, v156, v157
  v_add_f32 v158, v158, v159
  v_add_f32 v156, v156, v158
  buffer_atomic_add_f32 v156, v14, s[4:7], s36 offen offset:1024
  v_mfma_f32_16x16x32_bf16 v[102:105], a[228:231], a[112:115], v[102:105]
  ds_read_b128 a[252:255], v3 offset:31744
  v_mfma_f32_16x16x32_bf16 v[94:97], a[232:235], a[32:35], v[94:97]
  s_waitcnt lgkmcnt(9)
  v_add_f32 v160, v160, v161
  v_add_f32 v162, v162, v163
  v_add_f32 v160, v160, v162
  buffer_atomic_add_f32 v160, v14, s[4:7], s36 offen offset:2048
  v_mfma_f32_16x16x32_bf16 v[106:109], a[232:235], a[112:115], v[106:109]
  s_waitcnt lgkmcnt(4)
  ds_read_b128 a[224:227], v3 offset:32768
  v_mfma_f32_16x16x32_bf16 v[98:101], a[236:239], a[32:35], v[98:101]
  v_add_f32 v164, v164, v165
  v_add_f32 v166, v166, v167
  v_add_f32 v164, v164, v166
  buffer_atomic_add_f32 v164, v15, s[4:7], s36 offen offset:3072
  s_lshl_b32 s34, s26, 2
  s_add_u32 s34, s34, s20
  s_add_u32 s34, s34, 25915392
  v_mfma_f32_16x16x32_bf16 v[110:113], a[236:239], a[112:115], v[110:113]
  s_waitcnt lgkmcnt(4)
  ds_read_b128 a[228:231], v3 offset:33792
  v_mfma_f32_16x16x32_bf16 v[90:93], a[240:243], a[36:39], v[90:93]
  v_mfma_f32_16x16x32_bf16 v[102:105], a[240:243], a[116:119], v[102:105]
  s_waitcnt lgkmcnt(4)
  ds_read_b128 a[232:235], v3 offset:34816
  v_mfma_f32_16x16x32_bf16 v[94:97], a[244:247], a[36:39], v[94:97]
  v_mfma_f32_16x16x32_bf16 v[106:109], a[244:247], a[116:119], v[106:109]
  s_waitcnt lgkmcnt(4)
  ds_read_b128 a[236:239], v3 offset:35840
  v_mfma_f32_16x16x32_bf16 v[98:101], a[248:251], a[36:39], v[98:101]
  s_barrier
  v_mfma_f32_16x16x32_bf16 v[110:113], a[248:251], a[116:119], v[110:113]
  s_waitcnt lgkmcnt(4)
  ds_read_b128 a[240:243], v3 offset:36864
  v_mfma_f32_16x16x32_bf16 v[90:93], a[252:255], a[40:43], v[90:93]
  s_add_u32 m0, s21, 61440
  v_mfma_f32_16x16x32_bf16 v[102:105], a[252:255], a[120:123], v[102:105]
  s_waitcnt lgkmcnt(4)
  ds_read_b128 a[244:247], v3 offset:37888
  v_mfma_f32_16x16x32_bf16 v[94:97], a[224:227], a[40:43], v[94:97]
  s_add_u32 s33, s23, 40960
  buffer_load_dwordx4 v2, s[4:7], s33 offen offset:0 lds
  v_mfma_f32_16x16x32_bf16 v[106:109], a[224:227], a[120:123], v[106:109]
  s_waitcnt lgkmcnt(4)
  ds_read_b128 a[248:251], v3 offset:38912
  v_mfma_f32_16x16x32_bf16 v[98:101], a[228:231], a[40:43], v[98:101]
  buffer_load_dwordx4 v2, s[4:7], s33 offen offset:1024 lds
  v_mfma_f32_16x16x32_bf16 v[110:113], a[228:231], a[120:123], v[110:113]
  s_waitcnt lgkmcnt(4)
  ds_read_b128 a[252:255], v3 offset:39936
  v_mfma_f32_16x16x32_bf16 v[90:93], a[232:235], a[44:47], v[90:93]
  buffer_load_dwordx4 v2, s[4:7], s33 offen offset:2048 lds
  v_mfma_f32_16x16x32_bf16 v[102:105], a[232:235], a[124:127], v[102:105]
  s_waitcnt lgkmcnt(4)
  ds_read_b128 a[224:227], v3 offset:40960
  v_mfma_f32_16x16x32_bf16 v[94:97], a[236:239], a[44:47], v[94:97]
  buffer_load_dwordx4 v2, s[4:7], s33 offen offset:3072 lds
  v_mfma_f32_16x16x32_bf16 v[106:109], a[236:239], a[124:127], v[106:109]
  s_waitcnt lgkmcnt(4)
  ds_read_b128 a[228:231], v3 offset:41984
  v_mfma_f32_16x16x32_bf16 v[98:101], a[240:243], a[44:47], v[98:101]
  s_add_u32 m0, s21, 65536
  v_mfma_f32_16x16x32_bf16 v[110:113], a[240:243], a[124:127], v[110:113]
  s_waitcnt lgkmcnt(4)
  ds_read_b128 a[232:235], v3 offset:43008
  v_mfma_f32_16x16x32_bf16 v[90:93], a[244:247], a[48:51], v[90:93]
  s_add_u32 s33, s23, 45056
  buffer_load_dwordx4 v2, s[4:7], s33 offen offset:0 lds
  v_mfma_f32_16x16x32_bf16 v[102:105], a[244:247], a[128:131], v[102:105]
  s_waitcnt lgkmcnt(4)
  ds_read_b128 a[236:239], v3 offset:44032
  v_mfma_f32_16x16x32_bf16 v[94:97], a[248:251], a[48:51], v[94:97]
  v_mfma_f32_16x16x32_bf16 v[106:109], a[248:251], a[128:131], v[106:109]
  s_waitcnt lgkmcnt(4)
  ds_read_b128 a[240:243], v3 offset:45056
  v_mfma_f32_16x16x32_bf16 v[98:101], a[252:255], a[48:51], v[98:101]
  v_mfma_f32_16x16x32_bf16 v[110:113], a[252:255], a[128:131], v[110:113]
  s_waitcnt lgkmcnt(4)
  ds_read_b128 a[244:247], v3 offset:46080
  v_mfma_f32_16x16x32_bf16 v[90:93], a[224:227], a[52:55], v[90:93]
  v_mfma_f32_16x16x32_bf16 v[102:105], a[224:227], a[132:135], v[102:105]
  s_waitcnt lgkmcnt(4)
  ds_read_b128 a[248:251], v3 offset:47104
  v_mfma_f32_16x16x32_bf16 v[94:97], a[228:231], a[52:55], v[94:97]
  v_mfma_f32_16x16x32_bf16 v[106:109], a[228:231], a[132:135], v[106:109]
  s_waitcnt lgkmcnt(4)
  ds_read_b128 a[252:255], v3 offset:48128
  v_mfma_f32_16x16x32_bf16 v[98:101], a[232:235], a[52:55], v[98:101]
  v_mfma_f32_16x16x32_bf16 v[110:113], a[232:235], a[132:135], v[110:113]
  s_waitcnt lgkmcnt(4)
  ds_read_b128 a[224:227], v3 offset:49152
  v_mfma_f32_16x16x32_bf16 v[90:93], a[236:239], a[56:59], v[90:93]
  v_mfma_f32_16x16x32_bf16 v[102:105], a[236:239], a[136:139], v[102:105]
  s_waitcnt lgkmcnt(4)
  ds_read_b128 a[228:231], v3 offset:50176
  v_mfma_f32_16x16x32_bf16 v[94:97], a[240:243], a[56:59], v[94:97]
  v_mfma_f32_16x16x32_bf16 v[106:109], a[240:243], a[136:139], v[106:109]
  s_waitcnt lgkmcnt(4)
  ds_read_b128 a[232:235], v3 offset:51200
  v_mfma_f32_16x16x32_bf16 v[98:101], a[244:247], a[56:59], v[98:101]
  v_mfma_f32_16x16x32_bf16 v[110:113], a[244:247], a[136:139], v[110:113]
  s_waitcnt lgkmcnt(4)
  ds_read_b128 a[236:239], v3 offset:52224
  v_mfma_f32_16x16x32_bf16 v[90:93], a[248:251], a[60:63], v[90:93]
  v_mfma_f32_16x16x32_bf16 v[102:105], a[248:251], a[140:143], v[102:105]
  s_waitcnt lgkmcnt(4)
  ds_read_b128 a[240:243], v3 offset:53248
  v_mfma_f32_16x16x32_bf16 v[94:97], a[252:255], a[60:63], v[94:97]
  v_mfma_f32_16x16x32_bf16 v[106:109], a[252:255], a[140:143], v[106:109]
  s_waitcnt lgkmcnt(4)
  ds_read_b128 a[244:247], v3 offset:54272
  v_mfma_f32_16x16x32_bf16 v[98:101], a[224:227], a[60:63], v[98:101]
  v_mfma_f32_16x16x32_bf16 v[110:113], a[224:227], a[140:143], v[110:113]
  s_waitcnt lgkmcnt(4)
  ds_read_b128 a[248:251], v3 offset:55296
  v_mfma_f32_16x16x32_bf16 v[90:93], a[228:231], a[64:67], v[90:93]
  v_mfma_f32_16x16x32_bf16 v[102:105], a[228:231], a[144:147], v[102:105]
  s_waitcnt lgkmcnt(4)
  ds_read_b128 a[252:255], v3 offset:56320
  v_mfma_f32_16x16x32_bf16 v[94:97], a[232:235], a[64:67], v[94:97]
  s_barrier
  v_mfma_f32_16x16x32_bf16 v[106:109], a[232:235], a[144:147], v[106:109]
  s_waitcnt lgkmcnt(4)
  ds_read_b128 a[224:227], v3 offset:57344
  v_mfma_f32_16x16x32_bf16 v[98:101], a[236:239], a[64:67], v[98:101]
  s_add_u32 m0, s21, 81920
  v_mfma_f32_16x16x32_bf16 v[110:113], a[236:239], a[144:147], v[110:113]
  s_waitcnt lgkmcnt(4)
  ds_read_b128 a[228:231], v3 offset:58368
  v_mfma_f32_16x16x32_bf16 v[90:93], a[240:243], a[68:71], v[90:93]
  s_add_u32 s33, s23, 61440
  buffer_load_dwordx4 v2, s[4:7], s33 offen offset:0 lds
  v_mfma_f32_16x16x32_bf16 v[102:105], a[240:243], a[148:151], v[102:105]
  s_waitcnt lgkmcnt(4)
  ds_read_b128 a[232:235], v3 offset:59392
  v_mfma_f32_16x16x32_bf16 v[94:97], a[244:247], a[68:71], v[94:97]
  s_waitcnt vmcnt(6)
  buffer_load_dwordx4 v2, s[4:7], s33 offen offset:1024 lds
  s_barrier
  buffer_store_dword v25, v23, s[4:7], s34 offen offset:0 sc1
  v_mfma_f32_16x16x32_bf16 v[106:109], a[244:247], a[148:151], v[106:109]
  s_waitcnt lgkmcnt(4)
  ds_read_b128 a[236:239], v3 offset:60416
  v_mfma_f32_16x16x32_bf16 v[98:101], a[248:251], a[68:71], v[98:101]
  buffer_load_dwordx4 v2, s[4:7], s33 offen offset:2048 lds
  v_mfma_f32_16x16x32_bf16 v[110:113], a[248:251], a[148:151], v[110:113]
  s_waitcnt lgkmcnt(4)
  ds_read_b128 a[240:243], v3 offset:61440
  v_mfma_f32_16x16x32_bf16 v[90:93], a[252:255], a[72:75], v[90:93]
  buffer_load_dwordx4 v2, s[4:7], s33 offen offset:3072 lds
  v_mfma_f32_16x16x32_bf16 v[102:105], a[252:255], a[152:155], v[102:105]
  s_waitcnt lgkmcnt(4)
  ds_read_b128 a[244:247], v3 offset:62464
  v_mfma_f32_16x16x32_bf16 v[94:97], a[224:227], a[72:75], v[94:97]
  s_add_u32 m0, s21, 86016
  v_mfma_f32_16x16x32_bf16 v[106:109], a[224:227], a[152:155], v[106:109]
  s_waitcnt lgkmcnt(4)
  ds_read_b128 a[248:251], v3 offset:63488
  v_mfma_f32_16x16x32_bf16 v[98:101], a[228:231], a[72:75], v[98:101]
  s_add_u32 s33, s23, 65536
  buffer_load_dwordx4 v2, s[4:7], s33 offen offset:0 lds
  v_mfma_f32_16x16x32_bf16 v[110:113], a[228:231], a[152:155], v[110:113]
  s_waitcnt lgkmcnt(4)
  ds_read_b128 a[252:255], v3 offset:64512
  v_mfma_f32_16x16x32_bf16 v[90:93], a[232:235], a[76:79], v[90:93]
  v_mfma_f32_16x16x32_bf16 v[102:105], a[232:235], a[156:159], v[102:105]
  s_waitcnt lgkmcnt(4)
  v_mfma_f32_16x16x32_bf16 v[94:97], a[236:239], a[76:79], v[94:97]
  v_mfma_f32_16x16x32_bf16 v[106:109], a[236:239], a[156:159], v[106:109]
  s_waitcnt lgkmcnt(3)
  v_mfma_f32_16x16x32_bf16 v[98:101], a[240:243], a[76:79], v[98:101]
  v_mfma_f32_16x16x32_bf16 v[110:113], a[240:243], a[156:159], v[110:113]
  s_waitcnt lgkmcnt(2)
  v_mfma_f32_16x16x32_bf16 v[90:93], a[244:247], v[128:131], v[90:93]
  v_mfma_f32_16x16x32_bf16 v[102:105], a[244:247], v[132:135], v[102:105]
  s_waitcnt lgkmcnt(1)
  v_mfma_f32_16x16x32_bf16 v[94:97], a[248:251], v[128:131], v[94:97]
  v_mfma_f32_16x16x32_bf16 v[106:109], a[248:251], v[132:135], v[106:109]
  s_waitcnt lgkmcnt(0)
  v_mfma_f32_16x16x32_bf16 v[98:101], a[252:255], v[128:131], v[98:101]
  v_mfma_f32_16x16x32_bf16 v[110:113], a[252:255], v[132:135], v[110:113]
  s_barrier
  s_mul_i32 s36, s14, 1280
  s_add_u32 s36, s36, s30
  s_add_u32 s36, s36, 2621440
  v_mul_f32 v168, v90, v126
  v_mul_f32 v169, v91, v126
  v_mul_f32 v170, v92, v126
  v_mul_f32 v171, v93, v126
  v_fma_f32 v90, v90, v122, s29
  v_fma_f32 v91, v91, v122, s29
  v_fma_f32 v92, v92, v122, s29
  v_fma_f32 v93, v93, v122, s29
  v_exp_f32 v168, v168 clamp
  v_exp_f32 v169, v169 clamp
  v_exp_f32 v170, v170 clamp
  v_exp_f32 v171, v171 clamp
  v_max_f32 v90, s29, v90
  v_max_f32 v91, s29, v91
  v_max_f32 v92, s29, v92
  v_max_f32 v93, s29, v93
  v_add_f32 v90, v90, v168
  v_add_f32 v91, v91, v169
  v_add_f32 v92, v92, v170
  v_add_f32 v93, v93, v171
  v_cvt_pk_bf16_f32 v196, v90, v91
  v_cvt_pk_bf16_f32 v197, v92, v93
  v_mul_f32 v172, v94, v126
  v_mul_f32 v173, v95, v126
  v_mul_f32 v174, v96, v126
  v_mul_f32 v175, v97, v126
  v_fma_f32 v94, v94, v122, s29
  v_fma_f32 v95, v95, v122, s29
  v_fma_f32 v96, v96, v122, s29
  v_fma_f32 v97, v97, v122, s29
  v_exp_f32 v172, v172 clamp
  v_exp_f32 v173, v173 clamp
  v_exp_f32 v174, v174 clamp
  v_exp_f32 v175, v175 clamp
  v_max_f32 v94, s29, v94
  v_max_f32 v95, s29, v95
  v_max_f32 v96, s29, v96
  v_max_f32 v97, s29, v97
  v_add_f32 v94, v94, v172
  v_add_f32 v95, v95, v173
  v_add_f32 v96, v96, v174
  v_add_f32 v97, v97, v175
  v_cvt_pk_bf16_f32 v198, v94, v95
  v_cvt_pk_bf16_f32 v199, v96, v97
  buffer_store_dwordx4 v[196:199], v2, s[4:7], s36 offen sc1
  v_mul_f32 v168, v98, v126
  v_mul_f32 v169, v99, v126
  v_mul_f32 v170, v100, v126
  v_mul_f32 v171, v101, v126
  v_fma_f32 v98, v98, v122, s29
  v_fma_f32 v99, v99, v122, s29
  v_fma_f32 v100, v100, v122, s29
  v_fma_f32 v101, v101, v122, s29
  v_exp_f32 v168, v168 clamp
  v_exp_f32 v169, v169 clamp
  v_exp_f32 v170, v170 clamp
  v_exp_f32 v171, v171 clamp
  v_max_f32 v98, s29, v98
  v_max_f32 v99, s29, v99
  v_max_f32 v100, s29, v100
  v_max_f32 v101, s29, v101
  v_add_f32 v98, v98, v168
  v_add_f32 v99, v99, v169
  v_add_f32 v100, v100, v170
  v_add_f32 v101, v101, v171
  v_cvt_pk_bf16_f32 v200, v98, v99
  v_cvt_pk_bf16_f32 v201, v100, v101
  buffer_store_dwordx2 v[200:201], v9, s[4:7], s36 offen offset:1024 sc1
  v_mul_f32 v168, v102, v127
  v_mul_f32 v169, v103, v127
  v_mul_f32 v170, v104, v127
  v_mul_f32 v171, v105, v127
  v_fma_f32 v102, v102, v123, s29
  v_fma_f32 v103, v103, v123, s29
  v_fma_f32 v104, v104, v123, s29
  v_fma_f32 v105, v105, v123, s29
  v_exp_f32 v168, v168 clamp
  v_exp_f32 v169, v169 clamp
  v_exp_f32 v170, v170 clamp
  v_exp_f32 v171, v171 clamp
  v_max_f32 v102, s29, v102
  v_max_f32 v103, s29, v103
  v_max_f32 v104, s29, v104
  v_max_f32 v105, s29, v105
  v_add_f32 v102, v102, v168
  v_add_f32 v103, v103, v169
  v_add_f32 v104, v104, v170
  v_add_f32 v105, v105, v171
  v_cvt_pk_bf16_f32 v202, v102, v103
  v_cvt_pk_bf16_f32 v203, v104, v105
  v_mul_f32 v172, v106, v127
  v_mul_f32 v173, v107, v127
  v_mul_f32 v174, v108, v127
  v_mul_f32 v175, v109, v127
  v_fma_f32 v106, v106, v123, s29
  v_fma_f32 v107, v107, v123, s29
  v_fma_f32 v108, v108, v123, s29
  v_fma_f32 v109, v109, v123, s29
  v_exp_f32 v172, v172 clamp
  v_exp_f32 v173, v173 clamp
  v_exp_f32 v174, v174 clamp
  v_exp_f32 v175, v175 clamp
  v_max_f32 v106, s29, v106
  v_max_f32 v107, s29, v107
  v_max_f32 v108, s29, v108
  v_max_f32 v109, s29, v109
  v_add_f32 v106, v106, v172
  v_add_f32 v107, v107, v173
  v_add_f32 v108, v108, v174
  v_add_f32 v109, v109, v175
  v_cvt_pk_bf16_f32 v204, v106, v107
  v_cvt_pk_bf16_f32 v205, v108, v109
  s_add_u32 s36, s36, 20480
  buffer_store_dwordx4 v[202:205], v2, s[4:7], s36 offen sc1
  v_mul_f32 v168, v110, v127
  v_mul_f32 v169, v111, v127
  v_mul_f32 v170, v112, v127
  v_mul_f32 v171, v113, v127
  v_fma_f32 v110, v110, v123, s29
  v_fma_f32 v111, v111, v123, s29
  v_fma_f32 v112, v112, v123, s29
  v_fma_f32 v113, v113, v123, s29
  v_exp_f32 v168, v168 clamp
  v_exp_f32 v169, v169 clamp
  v_exp_f32 v170, v170 clamp
  v_exp_f32 v171, v171 clamp
  v_max_f32 v110, s29, v110
  v_max_f32 v111, s29, v111
  v_max_f32 v112, s29, v112
  v_max_f32 v113, s29, v113
  v_add_f32 v110, v110, v168
  v_add_f32 v111, v111, v169
  v_add_f32 v112, v112, v170
  v_add_f32 v113, v113, v171
  v_cvt_pk_bf16_f32 v206, v110, v111
  v_cvt_pk_bf16_f32 v207, v112, v113
  buffer_store_dwordx2 v[206:207], v9, s[4:7], s36 offen offset:1024 sc1
  s_lshr_b32 s34, s26, 4
  s_lshl_b32 s34, s34, 11
  s_and_b32 s35, s26, 15
  s_lshl_b32 s35, s35, 2
  s_add_u32 s34, s34, s35
  s_add_u32 s34, s34, s20
  s_add_u32 s34, s34, 25931776
  s_branch L_p2
.p2align 6
L_layer:
  s_mul_i32 s30, s15, 20480
  s_add_u32 s30, s30, s20
  s_add_u32 s30, s30, 10620928
  s_add_u32 s31, s30, 20480
  s_lshl_b32 s36, s15, 10
  s_add_u32 s36, s36, s20
  s_add_u32 s36, s36, 25563136
  s_lshl_b32 s35, s26, 7
  s_add_u32 s35, s35, 41291776
  s_cmp_lg_u32 s12, 0
  s_cbranch_scc1 L_pd1
  s_mov_b32 s37, 200000
L_pl1:
  buffer_load_dword v252, v24, s[4:7], s35 offen sc1
  s_waitcnt vmcnt(0)
  v_cmp_eq_u32 vcc, 0, v252
  s_nop 1
  s_cbranch_vccz L_pd1
  s_sub_u32 s37, s37, 1
  s_cmp_lg_u32 s37, 0
  s_cbranch_scc1 L_pl1
L_pd1:
  s_barrier
  buffer_load_dwordx4 a[0:3], v2, s[4:7], s30 offen offset:0 sc1
  buffer_load_dwordx4 a[4:7], v2, s[4:7], s30 offen offset:1024 sc1
  buffer_load_dwordx4 a[80:83], v2, s[4:7], s31 offen offset:0 sc1
  buffer_load_dwordx4 a[84:87], v2, s[4:7], s31 offen offset:1024 sc1
  buffer_load_dwordx4 a[8:11], v2, s[4:7], s30 offen offset:2048 sc1
  buffer_load_dwordx4 a[12:15], v2, s[4:7], s30 offen offset:3072 sc1
  buffer_load_dwordx4 a[88:91], v2, s[4:7], s31 offen offset:2048 sc1
  buffer_load_dwordx4 a[92:95], v2, s[4:7], s31 offen offset:3072 sc1
  s_add_u32 s32, s30, 4096
  buffer_load_dwordx4 a[16:19], v2, s[4:7], s32 offen offset:0 sc1
  buffer_load_dwordx4 a[20:23], v2, s[4:7], s32 offen offset:1024 sc1
  s_add_u32 s32, s31, 4096
  buffer_load_dwordx4 a[96:99], v2, s[4:7], s32 offen offset:0 sc1
  buffer_load_dwordx4 a[100:103], v2, s[4:7], s32 offen offset:1024 sc1
  s_waitcnt vmcnt(47)
  s_barrier
  ds_read_b128 a[224:227], v3 offset:57344
  ds_read_b128 a[228:231], v3 offset:58368
  ds_read_b128 a[232:235], v3 offset:59392
  ds_read_b128 a[236:239], v3 offset:60416
  ds_read_b128 a[240:243], v3 offset:61440
  ds_read_b128 a[244:247], v3 offset:62464
  s_waitcnt vmcnt(8) lgkmcnt(5)
  v_mfma_f32_16x16x32_bf16 v[50:53], a[0:3], a[224:227], 0
  s_add_u32 s32, s30, 4096
  buffer_load_dwordx4 a[24:27], v2, s[4:7], s32 offen offset:2048 sc1
  v_mfma_f32_16x16x32_bf16 v[70:73], a[80:83], a[224:227], 0
  s_waitcnt lgkmcnt(4)
  ds_read_b128 a[248:251], v3 offset:63488
  v_mfma_f32_16x16x32_bf16 v[54:57], a[0:3], a[228:231], 0
  v_mfma_f32_16x16x32_bf16 v[74:77], a[80:83], a[228:231], 0
  s_waitcnt lgkmcnt(4)
  ds_read_b128 a[252:255], v3 offset:64512
  v_mfma_f32_16x16x32_bf16 v[58:61], a[0:3], a[232:235], 0
  buffer_load_dwordx4 a[28:31], v2, s[4:7], s32 offen offset:3072 sc1
  v_mfma_f32_16x16x32_bf16 v[78:81], a[80:83], a[232:235], 0
  s_waitcnt lgkmcnt(4)
  ds_read_b128 a[224:227], v4 offset:0
  v_mfma_f32_16x16x32_bf16 v[62:65], a[0:3], a[236:239], 0
  v_mfma_f32_16x16x32_bf16 v[82:85], a[80:83], a[236:239], 0
  s_waitcnt lgkmcnt(4)
  ds_read_b128 a[228:231], v4 offset:1024
  v_mfma_f32_16x16x32_bf16 v[66:69], a[0:3], a[240:243], 0
  s_add_u32 s32, s31, 4096
  buffer_load_dwordx4 a[104:107], v2, s[4:7], s32 offen offset:2048 sc1
  v_mfma_f32_16x16x32_bf16 v[86:89], a[80:83], a[240:243], 0
  s_waitcnt lgkmcnt(4)
  ds_read_b128 a[232:235], v4 offset:2048
  v_mfma_f32_16x16x32_bf16 v[50:53], a[4:7], a[244:247], v[50:53]
  v_mfma_f32_16x16x32_bf16 v[70:73], a[84:87], a[244:247], v[70:73]
  s_waitcnt lgkmcnt(4)
  ds_read_b128 a[236:239], v4 offset:3072
  v_mfma_f32_16x16x32_bf16 v[54:57], a[4:7], a[248:251], v[54:57]
  buffer_load_dwordx4 a[108:111], v2, s[4:7], s32 offen offset:3072 sc1
  v_mfma_f32_16x16x32_bf16 v[74:77], a[84:87], a[248:251], v[74:77]
  s_waitcnt lgkmcnt(4)
  ds_read_b128 a[240:243], v4 offset:4096
  v_mfma_f32_16x16x32_bf16 v[58:61], a[4:7], a[252:255], v[58:61]
  v_mfma_f32_16x16x32_bf16 v[78:81], a[84:87], a[252:255], v[78:81]
  s_waitcnt lgkmcnt(4)
  ds_read_b128 a[244:247], v4 offset:5120
  v_mfma_f32_16x16x32_bf16 v[62:65], a[4:7], a[224:227], v[62:65]
  buffer_load_dwordx2 v[114:115], v7, s[4:7], s36 offen offset:0 sc1
  v_mfma_f32_16x16x32_bf16 v[82:85], a[84:87], a[224:227], v[82:85]
  s_waitcnt lgkmcnt(4)
  ds_read_b128 a[248:251], v4 offset:6144
  v_mfma_f32_16x16x32_bf16 v[66:69], a[4:7], a[228:231], v[66:69]
  v_mfma_f32_16x16x32_bf16 v[86:89], a[84:87], a[228:231], v[86:89]
  s_waitcnt vmcnt(9) lgkmcnt(4)
  ds_read_b128 a[252:255], v4 offset:7168
  v_mfma_f32_16x16x32_bf16 v[50:53], a[8:11], a[232:235], v[50:53]
  buffer_load_dwordx2 v[116:117], v7, s[4:7], s36 offen offset:128 sc1
  v_mfma_f32_16x16x32_bf16 v[70:73], a[88:91], a[232:235], v[70:73]
  s_waitcnt lgkmcnt(4)
  ds_read_b128 a[224:227], v4 offset:8192
  v_mfma_f32_16x16x32_bf16 v[54:57], a[8:11], a[236:239], v[54:57]
  v_mfma_f32_16x16x32_bf16 v[74:77], a[88:91], a[236:239], v[74:77]
  s_waitcnt lgkmcnt(4)
  ds_read_b128 a[228:231], v4 offset:9216
  v_mfma_f32_16x16x32_bf16 v[58:61], a[8:11], a[240:243], v[58:61]
  buffer_load_dwordx2 v[118:119], v7, s[4:7], s36 offen offset:1024 sc1
  v_mfma_f32_16x16x32_bf16 v[78:81], a[88:91], a[240:243], v[78:81]
  s_waitcnt lgkmcnt(4)
  ds_read_b128 a[232:235], v4 offset:10240
  v_mfma_f32_16x16x32_bf16 v[62:65], a[8:11], a[244:247], v[62:65]
  v_mfma_f32_16x16x32_bf16 v[82:85], a[88:91], a[244:247], v[82:85]
  s_waitcnt lgkmcnt(4)
  ds_read_b128 a[236:239], v4 offset:11264
  v_mfma_f32_16x16x32_bf16 v[66:69], a[8:11], a[248:251], v[66:69]
  s_barrier
  buffer_load_dwordx2 v[120:121], v7, s[4:7], s36 offen offset:1152 sc1
  v_mfma_f32_16x16x32_bf16 v[86:89], a[88:91], a[248:251], v[86:89]
  s_waitcnt lgkmcnt(4)
  ds_read_b128 a[240:243], v4 offset:12288
  v_mfma_f32_16x16x32_bf16 v[50:53], a[12:15], a[252:255], v[50:53]
  v_mfma_f32_16x16x32_bf16 v[70:73], a[92:95], a[252:255], v[70:73]
  s_waitcnt lgkmcnt(4)
  ds_read_b128 a[244:247], v4 offset:13312
  v_mfma_f32_16x16x32_bf16 v[54:57], a[12:15], a[224:227], v[54:57]
  s_add_u32 s32, s30, 8192
  buffer_load_dwordx4 a[32:35], v2, s[4:7], s32 offen offset:0 sc1
  v_mfma_f32_16x16x32_bf16 v[74:77], a[92:95], a[224:227], v[74:77]
  s_waitcnt lgkmcnt(4)
  ds_read_b128 a[248:251], v4 offset:14336
  v_mfma_f32_16x16x32_bf16 v[58:61], a[12:15], a[228:231], v[58:61]
  v_mfma_f32_16x16x32_bf16 v[78:81], a[92:95], a[228:231], v[78:81]
  s_waitcnt lgkmcnt(4)
  ds_read_b128 a[252:255], v4 offset:15360
  v_mfma_f32_16x16x32_bf16 v[62:65], a[12:15], a[232:235], v[62:65]
  buffer_load_dwordx4 a[36:39], v2, s[4:7], s32 offen offset:1024 sc1
  v_mfma_f32_16x16x32_bf16 v[82:85], a[92:95], a[232:235], v[82:85]
  s_waitcnt lgkmcnt(4)
  ds_read_b128 a[224:227], v4 offset:16384
  v_mfma_f32_16x16x32_bf16 v[66:69], a[12:15], a[236:239], v[66:69]
  v_mfma_f32_16x16x32_bf16 v[86:89], a[92:95], a[236:239], v[86:89]
  s_waitcnt vmcnt(10) lgkmcnt(4)
  ds_read_b128 a[228:231], v4 offset:17408
  v_mfma_f32_16x16x32_bf16 v[50:53], a[16:19], a[240:243], v[50:53]
  s_add_u32 s32, s31, 8192
  buffer_load_dwordx4 a[112:115], v2, s[4:7], s32 offen offset:0 sc1
  v_mfma_f32_16x16x32_bf16 v[70:73], a[96:99], a[240:243], v[70:73]
  s_waitcnt lgkmcnt(4)
  ds_read_b128 a[232:235], v4 offset:18432
  v_mfma_f32_16x16x32_bf16 v[54:57], a[16:19], a[244:247], v[54:57]
  v_mfma_f32_16x16x32_bf16 v[74:77], a[96:99], a[244:247], v[74:77]
  s_waitcnt lgkmcnt(4)
  ds_read_b128 a[236:239], v4 offset:19456
  v_mfma_f32_16x16x32_bf16 v[58:61], a[16:19], a[248:251], v[58:61]
  buffer_load_dwordx4 a[116:119], v2, s[4:7], s32 offen offset:1024 sc1
  v_mfma_f32_16x16x32_bf16 v[78:81], a[96:99], a[248:251], v[78:81]
  s_waitcnt lgkmcnt(4)
  ds_read_b128 a[240:243], v4 offset:20480
  v_mfma_f32_16x16x32_bf16 v[62:65], a[16:19], a[252:255], v[62:65]
  v_mfma_f32_16x16x32_bf16 v[82:85], a[96:99], a[252:255], v[82:85]
  s_waitcnt lgkmcnt(4)
  ds_read_b128 a[244:247], v4 offset:21504
  v_mfma_f32_16x16x32_bf16 v[66:69], a[16:19], a[224:227], v[66:69]
  s_add_u32 s32, s30, 8192
  buffer_load_dwordx4 a[40:43], v2, s[4:7], s32 offen offset:2048 sc1
  v_mfma_f32_16x16x32_bf16 v[86:89], a[96:99], a[224:227], v[86:89]
  s_waitcnt lgkmcnt(4)
  ds_read_b128 a[248:251], v4 offset:22528
  v_mfma_f32_16x16x32_bf16 v[50:53], a[20:23], a[228:231], v[50:53]
  v_mfma_f32_16x16x32_bf16 v[70:73], a[100:103], a[228:231], v[70:73]
  s_waitcnt lgkmcnt(4)
  ds_read_b128 a[252:255], v4 offset:23552
  v_mfma_f32_16x16x32_bf16 v[54:57], a[20:23], a[232:235], v[54:57]
  buffer_load_dwordx4 a[44:47], v2, s[4:7], s32 offen offset:3072 sc1
  v_mfma_f32_16x16x32_bf16 v[74:77], a[100:103], a[232:235], v[74:77]
  s_waitcnt lgkmcnt(4)
  ds_read_b128 a[224:227], v4 offset:24576
  v_mfma_f32_16x16x32_bf16 v[58:61], a[20:23], a[236:239], v[58:61]
  v_mfma_f32_16x16x32_bf16 v[78:81], a[100:103], a[236:239], v[78:81]
  s_waitcnt lgkmcnt(4)
  ds_read_b128 a[228:231], v4 offset:25600
  v_mfma_f32_16x16x32_bf16 v[62:65], a[20:23], a[240:243], v[62:65]
  s_add_u32 s32, s31, 8192
  buffer_load_dwordx4 a[120:123], v2, s[4:7], s32 offen offset:2048 sc1
  v_mfma_f32_16x16x32_bf16 v[82:85], a[100:103], a[240:243], v[82:85]
  s_waitcnt lgkmcnt(4)
  ds_read_b128 a[232:235], v4 offset:26624
  v_mfma_f32_16x16x32_bf16 v[66:69], a[20:23], a[244:247], v[66:69]
  v_mfma_f32_16x16x32_bf16 v[86:89], a[100:103], a[244:247], v[86:89]
  s_waitcnt vmcnt(11) lgkmcnt(4)
  ds_read_b128 a[236:239], v4 offset:27648
  v_mfma_f32_16x16x32_bf16 v[50:53], a[24:27], a[248:251], v[50:53]
  buffer_load_dwordx4 a[124:127], v2, s[4:7], s32 offen offset:3072 sc1
  v_mfma_f32_16x16x32_bf16 v[70:73], a[104:107], a[248:251], v[70:73]
  s_waitcnt lgkmcnt(4)
  ds_read_b128 a[240:243], v4 offset:28672
  v_mfma_f32_16x16x32_bf16 v[54:57], a[24:27], a[252:255], v[54:57]
  v_mfma_f32_16x16x32_bf16 v[74:77], a[104:107], a[252:255], v[74:77]
  s_waitcnt lgkmcnt(4)
  ds_read_b128 a[244:247], v4 offset:29696
  v_mfma_f32_16x16x32_bf16 v[58:61], a[24:27], a[224:227], v[58:61]
  s_add_u32 s32, s30, 12288
  buffer_load_dwordx4 a[48:51], v2, s[4:7], s32 offen offset:0 sc1
  v_mfma_f32_16x16x32_bf16 v[78:81], a[104:107], a[224:227], v[78:81]
  s_waitcnt lgkmcnt(4)
  ds_read_b128 a[248:251], v4 offset:30720
  v_mfma_f32_16x16x32_bf16 v[62:65], a[24:27], a[228:231], v[62:65]
  v_mfma_f32_16x16x32_bf16 v[82:85], a[104:107], a[228:231], v[82:85]
  s_waitcnt lgkmcnt(4)
  ds_read_b128 a[252:255], v4 offset:31744
  v_mfma_f32_16x16x32_bf16 v[66:69], a[24:27], a[232:235], v[66:69]
  s_barrier
  buffer_load_dwordx4 a[52:55], v2, s[4:7], s32 offen offset:1024 sc1
  v_mfma_f32_16x16x32_bf16 v[86:89], a[104:107], a[232:235], v[86:89]
  s_waitcnt lgkmcnt(4)
  ds_read_b128 a[224:227], v2 offset:0
  v_mfma_f32_16x16x32_bf16 v[50:53], a[28:31], a[236:239], v[50:53]
  v_mfma_f32_16x16x32_bf16 v[70:73], a[108:111], a[236:239], v[70:73]
  s_waitcnt lgkmcnt(4)
  ds_read_b128 a[228:231], v2 offset:1024
  v_mfma_f32_16x16x32_bf16 v[54:57], a[28:31], a[240:243], v[54:57]
  s_add_u32 s32, s31, 12288
  buffer_load_dwordx4 a[128:131], v2, s[4:7], s32 offen offset:0 sc1
  v_mfma_f32_16x16x32_bf16 v[74:77], a[108:111], a[240:243], v[74:77]
  s_waitcnt lgkmcnt(4)
  ds_read_b128 a[232:235], v2 offset:2048
  v_mfma_f32_16x16x32_bf16 v[58:61], a[28:31], a[244:247], v[58:61]
  v_mfma_f32_16x16x32_bf16 v[78:81], a[108:111], a[244:247], v[78:81]
  s_waitcnt lgkmcnt(4)
  ds_read_b128 a[236:239], v2 offset:3072
  v_mfma_f32_16x16x32_bf16 v[62:65], a[28:31], a[248:251], v[62:65]
  buffer_load_dwordx4 a[132:135], v2, s[4:7], s32 offen offset:1024 sc1
  v_mfma_f32_16x16x32_bf16 v[82:85], a[108:111], a[248:251], v[82:85]
  s_waitcnt lgkmcnt(4)
  ds_read_b128 a[240:243], v2 offset:4096
  v_mfma_f32_16x16x32_bf16 v[66:69], a[28:31], a[252:255], v[66:69]
  v_mfma_f32_16x16x32_bf16 v[86:89], a[108:111], a[252:255], v[86:89]
  s_waitcnt vmcnt(8) lgkmcnt(4)
  ds_read_b128 a[244:247], v2 offset:5120
  v_mfma_f32_16x16x32_bf16 v[50:53], a[32:35], a[224:227], v[50:53]
  s_add_u32 s32, s30, 12288
  buffer_load_dwordx4 a[56:59], v2, s[4:7], s32 offen offset:2048 sc1
  v_mfma_f32_16x16x32_bf16 v[70:73], a[112:115], a[224:227], v[70:73]
  s_waitcnt lgkmcnt(4)
  ds_read_b128 a[248:251], v2 offset:6144
  v_mfma_f32_16x16x32_bf16 v[54:57], a[32:35], a[228:231], v[54:57]
  v_mfma_f32_16x16x32_bf16 v[74:77], a[112:115], a[228:231], v[74:77]
  s_waitcnt lgkmcnt(4)
  ds_read_b128 a[252:255], v2 offset:7168
  v_mfma_f32_16x16x32_bf16 v[58:61], a[32:35], a[232:235], v[58:61]
  buffer_load_dwordx4 a[60:63], v2, s[4:7], s32 offen offset:3072 sc1
  v_mfma_f32_16x16x32_bf16 v[78:81], a[112:115], a[232:235], v[78:81]
  s_waitcnt lgkmcnt(4)
  ds_read_b128 a[224:227], v2 offset:8192
  v_mfma_f32_16x16x32_bf16 v[62:65], a[32:35], a[236:239], v[62:65]
  v_mfma_f32_16x16x32_bf16 v[82:85], a[112:115], a[236:239], v[82:85]
  s_waitcnt lgkmcnt(4)
  ds_read_b128 a[228:231], v2 offset:9216
  v_mfma_f32_16x16x32_bf16 v[66:69], a[32:35], a[240:243], v[66:69]
  s_add_u32 s32, s31, 12288
  buffer_load_dwordx4 a[136:139], v2, s[4:7], s32 offen offset:2048 sc1
  v_mfma_f32_16x16x32_bf16 v[86:89], a[112:115], a[240:243], v[86:89]
  s_waitcnt lgkmcnt(4)
  ds_read_b128 a[232:235], v2 offset:10240
  v_mfma_f32_16x16x32_bf16 v[50:53], a[36:39], a[244:247], v[50:53]
  v_mfma_f32_16x16x32_bf16 v[70:73], a[116:119], a[244:247], v[70:73]
  s_waitcnt lgkmcnt(4)
  ds_read_b128 a[236:239], v2 offset:11264
  v_mfma_f32_16x16x32_bf16 v[54:57], a[36:39], a[248:251], v[54:57]
  buffer_load_dwordx4 a[140:143], v2, s[4:7], s32 offen offset:3072 sc1
  v_mfma_f32_16x16x32_bf16 v[74:77], a[116:119], a[248:251], v[74:77]
  s_waitcnt lgkmcnt(4)
  ds_read_b128 a[240:243], v2 offset:12288
  v_mfma_f32_16x16x32_bf16 v[58:61], a[36:39], a[252:255], v[58:61]
  v_mfma_f32_16x16x32_bf16 v[78:81], a[116:119], a[252:255], v[78:81]
  s_waitcnt lgkmcnt(4)
  ds_read_b128 a[244:247], v2 offset:13312
  v_mfma_f32_16x16x32_bf16 v[62:65], a[36:39], a[224:227], v[62:65]
  s_add_u32 s32, s30, 16384
  buffer_load_dwordx4 a[64:67], v2, s[4:7], s32 offen offset:0 sc1
  v_mfma_f32_16x16x32_bf16 v[82:85], a[116:119], a[224:227], v[82:85]
  s_waitcnt lgkmcnt(4)
  ds_read_b128 a[248:251], v2 offset:14336
  v_mfma_f32_16x16x32_bf16 v[66:69], a[36:39], a[228:231], v[66:69]
  v_mfma_f32_16x16x32_bf16 v[86:89], a[116:119], a[228:231], v[86:89]
  s_waitcnt vmcnt(9) lgkmcnt(4)
  ds_read_b128 a[252:255], v2 offset:15360
  v_mfma_f32_16x16x32_bf16 v[50:53], a[40:43], a[232:235], v[50:53]
  buffer_load_dwordx4 a[68:71], v2, s[4:7], s32 offen offset:1024 sc1
  v_mfma_f32_16x16x32_bf16 v[70:73], a[120:123], a[232:235], v[70:73]
  s_waitcnt lgkmcnt(4)
  ds_read_b128 a[224:227], v2 offset:16384
  v_mfma_f32_16x16x32_bf16 v[54:57], a[40:43], a[236:239], v[54:57]
  v_mfma_f32_16x16x32_bf16 v[74:77], a[120:123], a[236:239], v[74:77]
  s_waitcnt lgkmcnt(4)
  ds_read_b128 a[228:231], v2 offset:17408
  v_mfma_f32_16x16x32_bf16 v[58:61], a[40:43], a[240:243], v[58:61]
  s_add_u32 s32, s31, 16384
  buffer_load_dwordx4 a[144:147], v2, s[4:7], s32 offen offset:0 sc1
  v_mfma_f32_16x16x32_bf16 v[78:81], a[120:123], a[240:243], v[78:81]
  s_waitcnt lgkmcnt(4)
  ds_read_b128 a[232:235], v2 offset:18432
  v_mfma_f32_16x16x32_bf16 v[62:65], a[40:43], a[244:247], v[62:65]
  v_add_f32 v114, v114, v116
  v_add_f32 v115, v115, v117
  v_mfma_f32_16x16x32_bf16 v[82:85], a[120:123], a[244:247], v[82:85]
  s_waitcnt lgkmcnt(4)
  ds_read_b128 a[236:239], v2 offset:19456
  v_mov_b32 v152, v114
  v_mfma_f32_16x16x32_bf16 v[66:69], a[40:43], a[248:251], v[66:69]
  s_barrier
  buffer_load_dwordx4 a[148:151], v2, s[4:7], s32 offen offset:1024 sc1
  v_mfma_f32_16x16x32_bf16 v[86:89], a[120:123], a[248:251], v[86:89]
  s_waitcnt lgkmcnt(4)
  ds_read_b128 a[240:243], v2 offset:20480
  v_permlane32_swap_b32 v114, v152
  v_mfma_f32_16x16x32_bf16 v[50:53], a[44:47], a[252:255], v[50:53]
  v_add_f32 v114, v114, v152
  v_mov_b32 v152, v114
  v_mfma_f32_16x16x32_bf16 v[70:73], a[124:127], a[252:255], v[70:73]
  s_waitcnt lgkmcnt(4)
  ds_read_b128 a[244:247], v2 offset:21504
  v_permlane16_swap_b32 v114, v152
  v_mfma_f32_16x16x32_bf16 v[54:57], a[44:47], a[224:227], v[54:57]
  s_add_u32 s32, s30, 16384
  buffer_load_dwordx4 a[72:75], v2, s[4:7], s32 offen offset:2048 sc1
  v_mfma_f32_16x16x32_bf16 v[74:77], a[124:127], a[224:227], v[74:77]
  s_waitcnt lgkmcnt(4)
  ds_read_b128 a[248:251], v2 offset:22528
  v_add_f32 v114, v114, v152
  v_mfma_f32_16x16x32_bf16 v[58:61], a[44:47], a[228:231], v[58:61]
  v_mov_b32 v153, v115
  s_nop 1
  v_permlane32_swap_b32 v115, v153
  v_mfma_f32_16x16x32_bf16 v[78:81], a[124:127], a[228:231], v[78:81]
  s_waitcnt lgkmcnt(4)
  ds_read_b128 a[252:255], v2 offset:23552
  v_add_f32 v115, v115, v153
  v_mfma_f32_16x16x32_bf16 v[62:65], a[44:47], a[232:235], v[62:65]
  buffer_load_dwordx4 a[76:79], v2, s[4:7], s32 offen offset:3072 sc1
  v_mfma_f32_16x16x32_bf16 v[82:85], a[124:127], a[232:235], v[82:85]
  s_waitcnt lgkmcnt(4)
  ds_read_b128 a[224:227], v2 offset:24576
  v_mov_b32 v153, v115
  v_mfma_f32_16x16x32_bf16 v[66:69], a[44:47], a[236:239], v[66:69]
  s_nop 0
  v_permlane16_swap_b32 v115, v153
  v_add_f32 v115, v115, v153
  v_mfma_f32_16x16x32_bf16 v[86:89], a[124:127], a[236:239], v[86:89]
  s_waitcnt vmcnt(10) lgkmcnt(4)
  ds_read_b128 a[228:231], v2 offset:25600
  v_mul_f32 v114, 0xbacccccd, v114
  v_mfma_f32_16x16x32_bf16 v[50:53], a[48:51], a[240:243], v[50:53]
  s_add_u32 s32, s31, 16384
  buffer_load_dwordx4 a[152:155], v2, s[4:7], s32 offen offset:2048 sc1
  v_mfma_f32_16x16x32_bf16 v[70:73], a[128:131], a[240:243], v[70:73]
  s_waitcnt lgkmcnt(4)
  ds_read_b128 a[232:235], v2 offset:26624
  v_mul_f32 v115, 0x3acccccd, v115
  v_mfma_f32_16x16x32_bf16 v[54:57], a[48:51], a[244:247], v[54:57]
  v_fma_f32 v115, -v114, v114, v115
  v_max_f32 v115, 0, v115
  v_mfma_f32_16x16x32_bf16 v[74:77], a[128:131], a[244:247], v[74:77]
  s_waitcnt lgkmcnt(4)
  ds_read_b128 a[236:239], v2 offset:27648
  v_add_f32 v115, 0x3727c5ac, v115
  v_mfma_f32_16x16x32_bf16 v[58:61], a[48:51], a[248:251], v[58:61]
  buffer_load_dwordx4 a[156:159], v2, s[4:7], s32 offen offset:3072 sc1
  v_mfma_f32_16x16x32_bf16 v[78:81], a[128:131], a[248:251], v[78:81]
  s_waitcnt lgkmcnt(4)
  ds_read_b128 a[240:243], v2 offset:28672
  v_cvt_pk_bf16_f32 v152, v114, v114
  v_mfma_f32_16x16x32_bf16 v[62:65], a[48:51], a[252:255], v[62:65]
  v_rsq_f32 v122, v115
  v_mfma_f32_16x16x32_bf16 v[82:85], a[128:131], a[252:255], v[82:85]
  s_waitcnt lgkmcnt(4)
  ds_read_b128 a[244:247], v2 offset:29696
  v_mul_f32 v124, v115, v122
  v_mfma_f32_16x16x32_bf16 v[66:69], a[48:51], a[224:227], v[66:69]
  s_mul_i32 s33, s12, 2048
  v_and_b32 v152, 0xffff0000, v152
  v_sub_f32 v116, v114, v152
  v_mfma_f32_16x16x32_bf16 v[86:89], a[128:131], a[224:227], v[86:89]
  s_waitcnt lgkmcnt(4)
  ds_read_b128 a[248:251], v2 offset:30720
  v_cvt_pk_bf16_f32 v128, v114, v116
  v_mfma_f32_16x16x32_bf16 v[50:53], a[52:55], a[228:231], v[50:53]
  s_add_u32 m0, s33, 122880
  v_and_b32 v152, 0xffff0000, v128
  v_sub_f32 v117, v116, v152
  v_mfma_f32_16x16x32_bf16 v[70:73], a[132:135], a[228:231], v[70:73]
  s_waitcnt lgkmcnt(4)
  ds_read_b128 a[252:255], v2 offset:31744
  v_mov_b32 v129, v128
  v_mfma_f32_16x16x32_bf16 v[54:57], a[52:55], a[232:235], v[54:57]
  s_sub_u32 s33, s33, s21
  v_cvt_pk_bf16_f32 v130, v114, v117
  v_mov_b32 v131, 0
  v_mfma_f32_16x16x32_bf16 v[74:77], a[132:135], a[232:235], v[74:77]
  s_waitcnt lgkmcnt(4)
  ds_read_b128 a[224:227], v2 offset:32768
  v_mul_f32 v126, 0x3fb8aa3b, v122
  v_mfma_f32_16x16x32_bf16 v[58:61], a[52:55], a[236:239], v[58:61]
  s_add_u32 s33, s33, s22
  v_add_f32 v118, v118, v120
  v_add_f32 v119, v119, v121
  v_mfma_f32_16x16x32_bf16 v[78:81], a[132:135], a[236:239], v[78:81]
  s_waitcnt lgkmcnt(4)
  ds_read_b128 a[228:231], v2 offset:33792
  v_mov_b32 v152, v118
  v_mfma_f32_16x16x32_bf16 v[62:65], a[52:55], a[240:243], v[62:65]
  s_add_u32 s33, s33, 163840
  buffer_load_dwordx4 v2, s[4:7], s33 offen offset:0 lds
  v_mfma_f32_16x16x32_bf16 v[82:85], a[132:135], a[240:243], v[82:85]
  s_waitcnt lgkmcnt(4)
  ds_read_b128 a[232:235], v2 offset:34816
  v_permlane32_swap_b32 v118, v152
  v_mfma_f32_16x16x32_bf16 v[66:69], a[52:55], a[244:247], v[66:69]
  v_add_f32 v118, v118, v152
  v_mov_b32 v152, v118
  v_mfma_f32_16x16x32_bf16 v[86:89], a[132:135], a[244:247], v[86:89]
  s_waitcnt vmcnt(9) lgkmcnt(4)
  ds_read_b128 a[236:239], v2 offset:35840
  v_permlane16_swap_b32 v118, v152
  v_mfma_f32_16x16x32_bf16 v[50:53], a[56:59], a[248:251], v[50:53]
  buffer_load_dwordx4 v2, s[4:7], s33 offen offset:1024 lds
  v_mfma_f32_16x16x32_bf16 v[70:73], a[136:139], a[248:251], v[70:73]
  s_waitcnt lgkmcnt(4)
  ds_read_b128 a[240:243], v2 offset:36864
  v_add_f32 v118, v118, v152
  v_mfma_f32_16x16x32_bf16 v[54:57], a[56:59], a[252:255], v[54:57]
  v_mov_b32 v153, v119
  s_nop 1
  v_permlane32_swap_b32 v119, v153
  v_mfma_f32_16x16x32_bf16 v[74:77], a[136:139], a[252:255], v[74:77]
  s_waitcnt lgkmcnt(4)
  ds_read_b128 a[244:247], v2 offset:37888
  v_add_f32 v119, v119, v153
  v_mfma_f32_16x16x32_bf16 v[58:61], a[56:59], a[224:227], v[58:61]
  v_mov_b32 v153, v119
  s_nop 1
  v_permlane16_swap_b32 v119, v153
  v_mfma_f32_16x16x32_bf16 v[78:81], a[136:139], a[224:227], v[78:81]
  s_waitcnt lgkmcnt(4)
  ds_read_b128 a[248:251], v2 offset:38912
  v_add_f32 v119, v119, v153
  v_mfma_f32_16x16x32_bf16 v[62:65], a[56:59], a[228:231], v[62:65]
  v_mul_f32 v118, 0xbacccccd, v118
  v_mul_f32 v119, 0x3acccccd, v119
  v_mfma_f32_16x16x32_bf16 v[82:85], a[136:139], a[228:231], v[82:85]
  s_waitcnt lgkmcnt(4)
  ds_read_b128 a[252:255], v2 offset:39936
  v_fma_f32 v119, -v118, v118, v119
  v_mfma_f32_16x16x32_bf16 v[66:69], a[56:59], a[232:235], v[66:69]
  s_barrier
  v_max_f32 v119, 0, v119
  v_mfma_f32_16x16x32_bf16 v[86:89], a[136:139], a[232:235], v[86:89]
  s_waitcnt lgkmcnt(4)
  ds_read_b128 a[224:227], v2 offset:40960
  v_add_f32 v119, 0x3727c5ac, v119
  v_mfma_f32_16x16x32_bf16 v[50:53], a[60:63], a[236:239], v[50:53]
  s_add_u32 m0, s21, 0
  v_rsq_f32 v123, v119
  v_mfma_f32_16x16x32_bf16 v[70:73], a[140:143], a[236:239], v[70:73]
  s_waitcnt lgkmcnt(4)
  ds_read_b128 a[228:231], v2 offset:41984
  v_cvt_pk_bf16_f32 v152, v118, v118
  v_mfma_f32_16x16x32_bf16 v[54:57], a[60:63], a[240:243], v[54:57]
  s_add_u32 s33, s24, 0
  buffer_load_dwordx4 v2, s[4:7], s33 offen offset:0 lds
  v_mfma_f32_16x16x32_bf16 v[74:77], a[140:143], a[240:243], v[74:77]
  s_waitcnt lgkmcnt(4)
  ds_read_b128 a[232:235], v2 offset:43008
  v_mul_f32 v125, v119, v123
  v_mfma_f32_16x16x32_bf16 v[58:61], a[60:63], a[244:247], v[58:61]
  v_and_b32 v152, 0xffff0000, v152
  v_sub_f32 v120, v118, v152
  v_mfma_f32_16x16x32_bf16 v[78:81], a[140:143], a[244:247], v[78:81]
  s_waitcnt lgkmcnt(4)
  ds_read_b128 a[236:239], v2 offset:44032
  v_cvt_pk_bf16_f32 v132, v118, v120
  v_mfma_f32_16x16x32_bf16 v[62:65], a[60:63], a[248:251], v[62:65]
  buffer_load_dwordx4 v2, s[4:7], s33 offen offset:1024 lds
  v_mfma_f32_16x16x32_bf16 v[82:85], a[140:143], a[248:251], v[82:85]
  s_waitcnt lgkmcnt(4)
  ds_read_b128 a[240:243], v2 offset:45056
  v_and_b32 v152, 0xffff0000, v132
  v_mfma_f32_16x16x32_bf16 v[66:69], a[60:63], a[252:255], v[66:69]
  v_sub_f32 v121, v120, v152
  v_mov_b32 v133, v132
  v_mfma_f32_16x16x32_bf16 v[86:89], a[140:143], a[252:255], v[86:89]
  s_waitcnt vmcnt(8) lgkmcnt(4)
  ds_read_b128 a[244:247], v2 offset:46080
  v_cvt_pk_bf16_f32 v134, v118, v121
  v_mfma_f32_16x16x32_bf16 v[50:53], a[64:67], a[224:227], v[50:53]
  buffer_load_dwordx4 v2, s[4:7], s33 offen offset:2048 lds
  v_mfma_f32_16x16x32_bf16 v[70:73], a[144:147], a[224:227], v[70:73]
  s_waitcnt lgkmcnt(4)
  ds_read_b128 a[248:251], v2 offset:47104
  v_mov_b32 v135, 0
  v_mfma_f32_16x16x32_bf16 v[54:57], a[64:67], a[228:231], v[54:57]
  v_mul_f32 v127, 0x3fb8aa3b, v123
  ds_write_b32 v26, v122 offset:0
  v_mfma_f32_16x16x32_bf16 v[74:77], a[144:147], a[228:231], v[74:77]
  s_waitcnt lgkmcnt(5)
  ds_read_b128 a[252:255], v2 offset:48128
  ds_write_b32 v26, v123 offset:64
  v_mfma_f32_16x16x32_bf16 v[58:61], a[64:67], a[232:235], v[58:61]
  buffer_load_dwordx4 v2, s[4:7], s33 offen offset:3072 lds
  v_mfma_f32_16x16x32_bf16 v[78:81], a[144:147], a[232:235], v[78:81]
  s_waitcnt lgkmcnt(6)
  ds_read_b128 a[224:227], v2 offset:49152
  v_mfma_f32_16x16x32_bf16 v[62:65], a[64:67], a[236:239], v[62:65]
  v_mfma_f32_16x16x32_bf16 v[82:85], a[144:147], a[236:239], v[82:85]
  s_waitcnt lgkmcnt(6)
  ds_read_b128 a[228:231], v2 offset:50176
  v_mfma_f32_16x16x32_bf16 v[66:69], a[64:67], a[240:243], v[66:69]
  s_add_u32 m0, s21, 4096
  v_mfma_f32_16x16x32_bf16 v[86:89], a[144:147], a[240:243], v[86:89]
  s_waitcnt lgkmcnt(6)
  ds_read_b128 a[232:235], v2 offset:51200
  v_mfma_f32_16x16x32_bf16 v[50:53], a[68:71], a[244:247], v[50:53]
  s_add_u32 s33, s24, 4096
  buffer_load_dwordx4 v2, s[4:7], s33 offen offset:0 lds
  v_mfma_f32_16x16x32_bf16 v[70:73], a[148:151], a[244:247], v[70:73]
  s_waitcnt lgkmcnt(6)
  ds_read_b128 a[236:239], v2 offset:52224
  v_mfma_f32_16x16x32_bf16 v[54:57], a[68:71], a[248:251], v[54:57]
  v_mfma_f32_16x16x32_bf16 v[74:77], a[148:151], a[248:251], v[74:77]
  s_waitcnt lgkmcnt(5)
  ds_read_b128 a[240:243], v2 offset:53248
  v_mfma_f32_16x16x32_bf16 v[58:61], a[68:71], a[252:255], v[58:61]
  v_mfma_f32_16x16x32_bf16 v[78:81], a[148:151], a[252:255], v[78:81]
  s_waitcnt lgkmcnt(4)
  ds_read_b128 a[244:247], v2 offset:54272
  v_mfma_f32_16x16x32_bf16 v[62:65], a[68:71], a[224:227], v[62:65]
  ds_read_b128 v[136:139], v27 offset:0
  ds_read_b128 v[140:143], v27 offset:64
  v_mfma_f32_16x16x32_bf16 v[82:85], a[148:151], a[224:227], v[82:85]
  s_waitcnt lgkmcnt(6)
  ds_read_b128 a[248:251], v2 offset:55296
  v_mfma_f32_16x16x32_bf16 v[66:69], a[68:71], a[228:231], v[66:69]
  v_mfma_f32_16x16x32_bf16 v[86:89], a[148:151], a[228:231], v[86:89]
  s_waitcnt vmcnt(7) lgkmcnt(6)
  ds_read_b128 a[252:255], v2 offset:56320
  v_mfma_f32_16x16x32_bf16 v[50:53], a[72:75], a[232:235], v[50:53]
  v_mfma_f32_16x16x32_bf16 v[70:73], a[152:155], a[232:235], v[70:73]
  s_waitcnt lgkmcnt(6)
  ds_read_b128 a[224:227], v2 offset:57344
  v_mfma_f32_16x16x32_bf16 v[54:57], a[72:75], a[236:239], v[54:57]
  v_mfma_f32_16x16x32_bf16 v[74:77], a[152:155], a[236:239], v[74:77]
  s_waitcnt lgkmcnt(6)
  ds_read_b128 a[228:231], v2 offset:58368
  v_mfma_f32_16x16x32_bf16 v[58:61], a[72:75], a[240:243], v[58:61]
  v_mfma_f32_16x16x32_bf16 v[78:81], a[152:155], a[240:243], v[78:81]
  s_waitcnt lgkmcnt(6)
  ds_read_b128 a[232:235], v2 offset:59392
  v_mfma_f32_16x16x32_bf16 v[62:65], a[72:75], a[244:247], v[62:65]
  v_mfma_f32_16x16x32_bf16 v[82:85], a[152:155], a[244:247], v[82:85]
  s_waitcnt lgkmcnt(4)
  ds_read_b128 a[236:239], v2 offset:60416
  v_mfma_f32_16x16x32_bf16 v[66:69], a[72:75], a[248:251], v[66:69]
  s_barrier
  v_mfma_f32_16x16x32_bf16 v[86:89], a[152:155], a[248:251], v[86:89]
  s_waitcnt lgkmcnt(4)
  ds_read_b128 a[240:243], v2 offset:61440
  v_mfma_f32_16x16x32_bf16 v[50:53], a[76:79], a[252:255], v[50:53]
  s_add_u32 m0, s21, 20480
  v_mfma_f32_16x16x32_bf16 v[70:73], a[156:159], a[252:255], v[70:73]
  s_waitcnt lgkmcnt(4)
  ds_read_b128 a[244:247], v2 offset:62464
  v_mfma_f32_16x16x32_bf16 v[54:57], a[76:79], a[224:227], v[54:57]
  s_add_u32 s33, s23, 0
  buffer_load_dwordx4 v2, s[4:7], s33 offen offset:0 lds
  v_mfma_f32_16x16x32_bf16 v[74:77], a[156:159], a[224:227], v[74:77]
  s_waitcnt lgkmcnt(4)
  ds_read_b128 a[248:251], v2 offset:63488
  v_mfma_f32_16x16x32_bf16 v[58:61], a[76:79], a[228:231], v[58:61]
  v_mul_f32 v144, 0x3fb8aa3b, v136
  v_mul_f32 v145, 0x3fb8aa3b, v137
  v_mfma_f32_16x16x32_bf16 v[78:81], a[156:159], a[228:231], v[78:81]
  s_waitcnt lgkmcnt(4)
  ds_read_b128 a[252:255], v2 offset:64512
  v_mul_f32 v146, 0x3fb8aa3b, v138
  v_mfma_f32_16x16x32_bf16 v[62:65], a[76:79], a[232:235], v[62:65]
  buffer_load_dwordx4 v2, s[4:7], s33 offen offset:1024 lds
  v_mfma_f32_16x16x32_bf16 v[82:85], a[156:159], a[232:235], v[82:85]
  s_waitcnt lgkmcnt(4)
  ds_read_b128 a[224:227], v3 offset:0
  v_mul_f32 v147, 0x3fb8aa3b, v139
  v_mfma_f32_16x16x32_bf16 v[66:69], a[76:79], a[236:239], v[66:69]
  v_mul_f32 v148, 0x3fb8aa3b, v140
  v_mul_f32 v149, 0x3fb8aa3b, v141
  v_mfma_f32_16x16x32_bf16 v[86:89], a[156:159], a[236:239], v[86:89]
  s_waitcnt lgkmcnt(4)
  ds_read_b128 a[228:231], v3 offset:1024
  v_mul_f32 v150, 0x3fb8aa3b, v142
  v_mfma_f32_16x16x32_bf16 v[50:53], v[128:131], a[240:243], v[50:53]
  buffer_load_dwordx4 v2, s[4:7], s33 offen offset:2048 lds
  v_mfma_f32_16x16x32_bf16 v[70:73], v[132:135], a[240:243], v[70:73]
  s_waitcnt lgkmcnt(4)
  ds_read_b128 a[232:235], v3 offset:2048
  v_mul_f32 v151, 0x3fb8aa3b, v143
  v_mfma_f32_16x16x32_bf16 v[54:57], v[128:131], a[244:247], v[54:57]
  v_mfma_f32_16x16x32_bf16 v[74:77], v[132:135], a[244:247], v[74:77]
  s_waitcnt lgkmcnt(4)
  ds_read_b128 a[236:239], v3 offset:3072
  v_mfma_f32_16x16x32_bf16 v[58:61], v[128:131], a[248:251], v[58:61]
  buffer_load_dwordx4 v2, s[4:7], s33 offen offset:3072 lds
  v_mfma_f32_16x16x32_bf16 v[78:81], v[132:135], a[248:251], v[78:81]
  s_waitcnt lgkmcnt(4)
  ds_read_b128 a[240:243], v3 offset:4096
  v_mfma_f32_16x16x32_bf16 v[62:65], v[128:131], a[252:255], v[62:65]
  v_mfma_f32_16x16x32_bf16 v[82:85], v[132:135], a[252:255], v[82:85]
  s_waitcnt lgkmcnt(4)
  ds_read_b128 a[244:247], v3 offset:5120
  v_mfma_f32_16x16x32_bf16 v[66:69], v[128:131], a[224:227], v[66:69]
  s_add_u32 m0, s21, 24576
  v_mfma_f32_16x16x32_bf16 v[86:89], v[132:135], a[224:227], v[86:89]
  s_waitcnt lgkmcnt(4)
  ds_read_b128 a[248:251], v3 offset:6144
  v_mfma_f32_16x16x32_bf16 v[90:93], a[228:231], a[0:3], 0
  s_add_u32 s33, s23, 4096
  buffer_load_dwordx4 v2, s[4:7], s33 offen offset:0 lds
  v_mfma_f32_16x16x32_bf16 v[102:105], a[228:231], a[80:83], 0
  s_waitcnt lgkmcnt(4)
  ds_read_b128 a[252:255], v3 offset:7168
  v_mfma_f32_16x16x32_bf16 v[94:97], a[232:235], a[0:3], 0
  v_mul_f32 v152, v50, v144
  v_mul_f32 v153, v51, v145
  v_exp_f32 v152, v152 clamp
  v_exp_f32 v153, v153 clamp
  v_mul_f32 v154, v52, v146
  v_mul_f32 v155, v53, v147
  v_mfma_f32_16x16x32_bf16 v[106:109], a[232:235], a[80:83], 0
  s_waitcnt lgkmcnt(4)
  ds_read_b128 a[224:227], v3 offset:8192
  v_exp_f32 v154, v154 clamp
  v_exp_f32 v155, v155 clamp
  v_fma_f32 v50, v50, v136, s29
  v_fma_f32 v51, v51, v137, s29
  v_fma_f32 v52, v52, v138, s29
  v_mfma_f32_16x16x32_bf16 v[98:101], a[236:239], a[0:3], 0
  v_fma_f32 v53, v53, v139, s29
  v_max_f32 v50, s29, v50
  v_max_f32 v51, s29, v51
  v_max_f32 v52, s29, v52
  v_max_f32 v53, s29, v53
  v_add_f32 v50, v50, v152
  v_add_f32 v51, v51, v153
  v_add_f32 v52, v52, v154
  v_mfma_f32_16x16x32_bf16 v[110:113], a[236:239], a[80:83], 0
  s_waitcnt lgkmcnt(4)
  ds_read_b128 a[228:231], v3 offset:9216
  v_add_f32 v53, v53, v155
  v_cvt_pk_bf16_f32 v176, v50, v51
  v_cvt_pk_bf16_f32 v177, v52, v53
  v_mul_f32 v156, v70, v148
  v_mul_f32 v157, v71, v149
  v_exp_f32 v156, v156 clamp
  v_mfma_f32_16x16x32_bf16 v[90:93], a[240:243], a[4:7], v[90:93]
  v_exp_f32 v157, v157 clamp
  v_mul_f32 v158, v72, v150
  v_mul_f32 v159, v73, v151
  v_exp_f32 v158, v158 clamp
  v_exp_f32 v159, v159 clamp
  v_mfma_f32_16x16x32_bf16 v[102:105], a[240:243], a[84:87], v[102:105]
  s_waitcnt lgkmcnt(4)
  ds_read_b128 a[232:235], v3 offset:10240
  v_fma_f32 v70, v70, v140, s29
  v_fma_f32 v71, v71, v141, s29
  v_fma_f32 v72, v72, v142, s29
  v_fma_f32 v73, v73, v143, s29
  v_max_f32 v70, s29, v70
  v_max_f32 v71, s29, v71
  v_max_f32 v72, s29, v72
  v_mfma_f32_16x16x32_bf16 v[94:97], a[244:247], a[4:7], v[94:97]
  v_max_f32 v73, s29, v73
  v_add_f32 v70, v70, v156
  v_add_f32 v71, v71, v157
  v_add_f32 v72, v72, v158
  v_add_f32 v73, v73, v159
  v_cvt_pk_bf16_f32 v178, v70, v71
  v_cvt_pk_bf16_f32 v179, v72, v73
  v_mul_f32 v152, v54, v144
  v_mfma_f32_16x16x32_bf16 v[106:109], a[244:247], a[84:87], v[106:109]
  s_waitcnt lgkmcnt(4)
  ds_read_b128 a[236:239], v3 offset:11264
  v_exp_f32 v152, v152 clamp
  v_mul_f32 v153, v55, v145
  v_mul_f32 v154, v56, v146
  v_exp_f32 v153, v153 clamp
  v_mul_f32 v155, v57, v147
  v_mfma_f32_16x16x32_bf16 v[98:101], a[248:251], a[4:7], v[98:101]
  v_exp_f32 v154, v154 clamp
  v_exp_f32 v155, v155 clamp
  v_fma_f32 v54, v54, v136, s29
  v_fma_f32 v55, v55, v137, s29
  v_fma_f32 v56, v56, v138, s29
  v_fma_f32 v57, v57, v139, s29
  v_mfma_f32_16x16x32_bf16 v[110:113], a[248:251], a[84:87], v[110:113]
  s_waitcnt lgkmcnt(4)
  ds_read_b128 a[240:243], v3 offset:12288
  v_max_f32 v54, s29, v54
  v_max_f32 v55, s29, v55
  v_max_f32 v56, s29, v56
  v_max_f32 v57, s29, v57
  v_add_f32 v54, v54, v152
  v_add_f32 v55, v55, v153
  v_add_f32 v56, v56, v154
  v_mfma_f32_16x16x32_bf16 v[90:93], a[252:255], a[8:11], v[90:93]
  v_add_f32 v57, v57, v155
  v_cvt_pk_bf16_f32 v180, v54, v55
  v_cvt_pk_bf16_f32 v181, v56, v57
  v_mul_f32 v156, v74, v148
  v_mul_f32 v157, v75, v149
  v_exp_f32 v156, v156 clamp
  v_mul_f32 v158, v76, v150
  v_mfma_f32_16x16x32_bf16 v[102:105], a[252:255], a[88:91], v[102:105]
  s_waitcnt lgkmcnt(4)
  ds_read_b128 a[244:247], v3 offset:13312
  v_exp_f32 v157, v157 clamp
  v_exp_f32 v158, v158 clamp
  v_mul_f32 v159, v77, v151
  v_fma_f32 v74, v74, v140, s29
  v_fma_f32 v75, v75, v141, s29
  v_mfma_f32_16x16x32_bf16 v[94:97], a[224:227], a[8:11], v[94:97]
  v_exp_f32 v159, v159 clamp
  v_fma_f32 v76, v76, v142, s29
  v_fma_f32 v77, v77, v143, s29
  v_max_f32 v74, s29, v74
  v_max_f32 v75, s29, v75
  v_max_f32 v76, s29, v76
  v_max_f32 v77, s29, v77
  v_mfma_f32_16x16x32_bf16 v[106:109], a[224:227], a[88:91], v[106:109]
  s_waitcnt lgkmcnt(4)
  ds_read_b128 a[248:251], v3 offset:14336
  v_add_f32 v74, v74, v156
  v_add_f32 v75, v75, v157
  v_add_f32 v76, v76, v158
  v_add_f32 v77, v77, v159
  v_cvt_pk_bf16_f32 v182, v74, v75
  v_cvt_pk_bf16_f32 v183, v76, v77
  v_mul_f32 v152, v58, v144
  v_mfma_f32_16x16x32_bf16 v[98:101], a[228:231], a[8:11], v[98:101]
  v_exp_f32 v152, v152 clamp
  v_mul_f32 v153, v59, v145
  v_mul_f32 v154, v60, v146
  v_exp_f32 v153, v153 clamp
  v_exp_f32 v154, v154 clamp
  v_mfma_f32_16x16x32_bf16 v[110:113], a[228:231], a[88:91], v[110:113]
  s_waitcnt lgkmcnt(4)
  ds_read_b128 a[252:255], v3 offset:15360
  v_mul_f32 v155, v61, v147
  v_fma_f32 v160, v58, v136, s29
  v_exp_f32 v155, v155 clamp
  v_fma_f32 v161, v59, v137, s29
  v_fma_f32 v162, v60, v138, s29
  v_fma_f32 v163, v61, v139, s29
  v_mfma_f32_16x16x32_bf16 v[90:93], a[232:235], a[12:15], v[90:93]
  s_barrier
  v_max_f32 v160, s29, v160
  v_max_f32 v161, s29, v161
  v_max_f32 v162, s29, v162
  v_max_f32 v163, s29, v163
  v_add_f32 v160, v160, v152
  v_add_f32 v161, v161, v153
  v_add_f32 v162, v162, v154
  v_mfma_f32_16x16x32_bf16 v[102:105], a[232:235], a[92:95], v[102:105]
  s_waitcnt lgkmcnt(4)
  ds_read_b128 a[224:227], v3 offset:16384
  v_add_f32 v163, v163, v155
  v_mul_f32 v58, v58, v136
  v_mul_f32 v59, v59, v137
  v_mul_f32 v60, v60, v138
  v_mul_f32 v61, v61, v139
  v_cndmask_b32 v58, v58, v160, s[38:39]
  v_cndmask_b32 v59, v59, v161, s[38:39]
  v_mfma_f32_16x16x32_bf16 v[94:97], a[236:239], a[12:15], v[94:97]
  s_add_u32 m0, s21, 40960
  v_cndmask_b32 v60, v60, v162, s[38:39]
  v_cndmask_b32 v61, v61, v163, s[38:39]
  v_cvt_pk_bf16_f32 v184, v58, v59
  v_cvt_pk_bf16_f32 v185, v60, v61
  v_mul_f32 v156, v78, v148
  v_mul_f32 v157, v79, v149
  v_exp_f32 v156, v156 clamp
  v_mfma_f32_16x16x32_bf16 v[106:109], a[236:239], a[92:95], v[106:109]
  s_waitcnt lgkmcnt(4)
  ds_read_b128 a[228:231], v3 offset:17408
  v_exp_f32 v157, v157 clamp
  v_mul_f32 v158, v80, v150
  v_mul_f32 v159, v81, v151
  v_exp_f32 v158, v158 clamp
  v_fma_f32 v164, v78, v140, s29
  v_mfma_f32_16x16x32_bf16 v[98:101], a[240:243], a[12:15], v[98:101]
  s_add_u32 s33, s23, 20480
  buffer_load_dwordx4 v2, s[4:7], s33 offen offset:0 lds
  v_exp_f32 v159, v159 clamp
  v_fma_f32 v165, v79, v141, s29
  v_fma_f32 v166, v80, v142, s29
  v_fma_f32 v167, v81, v143, s29
  v_max_f32 v164, s29, v164
  v_mfma_f32_16x16x32_bf16 v[110:113], a[240:243], a[92:95], v[110:113]
  s_waitcnt lgkmcnt(4)
  ds_read_b128 a[232:235], v3 offset:18432
  v_max_f32 v165, s29, v165
  v_max_f32 v166, s29, v166
  v_max_f32 v167, s29, v167
  v_add_f32 v164, v164, v156
  v_add_f32 v165, v165, v157
  v_add_f32 v166, v166, v158
  v_add_f32 v167, v167, v159
  v_mfma_f32_16x16x32_bf16 v[90:93], a[244:247], a[16:19], v[90:93]
  v_mul_f32 v78, v78, v140
  v_mul_f32 v79, v79, v141
  v_mul_f32 v80, v80, v142
  v_mul_f32 v81, v81, v143
  v_cndmask_b32 v78, v78, v164, s[38:39]
  v_cndmask_b32 v79, v79, v165, s[38:39]
  v_cndmask_b32 v80, v80, v166, s[38:39]
  v_cndmask_b32 v81, v81, v167, s[38:39]
  v_mfma_f32_16x16x32_bf16 v[102:105], a[244:247], a[96:99], v[102:105]
  s_waitcnt lgkmcnt(4)
  ds_read_b128 a[236:239], v3 offset:19456
  v_cvt_pk_bf16_f32 v186, v78, v79
  v_cvt_pk_bf16_f32 v187, v80, v81
  v_mul_f32 v62, v62, v136
  v_mul_f32 v63, v63, v137
  v_mul_f32 v64, v64, v138
  v_mul_f32 v65, v65, v139
  v_cvt_pk_bf16_f32 v188, v62, v63
  v_mfma_f32_16x16x32_bf16 v[94:97], a[248:251], a[16:19], v[94:97]
  buffer_load_dwordx4 v2, s[4:7], s33 offen offset:1024 lds
  v_cvt_pk_bf16_f32 v189, v64, v65
  v_mul_f32 v82, v82, v140
  v_mul_f32 v83, v83, v141
  v_mul_f32 v84, v84, v142
  v_mul_f32 v85, v85, v143
  v_cvt_pk_bf16_f32 v190, v82, v83
  v_mfma_f32_16x16x32_bf16 v[106:109], a[248:251], a[96:99], v[106:109]
  s_waitcnt lgkmcnt(4)
  ds_read_b128 a[240:243], v3 offset:20480
  v_cvt_pk_bf16_f32 v191, v84, v85
  v_mul_f32 v66, v66, v136
  v_mul_f32 v67, v67, v137
  v_mul_f32 v68, v68, v138
  v_mul_f32 v69, v69, v139
  v_cvt_pk_bf16_f32 v192, v66, v67
  v_cvt_pk_bf16_f32 v193, v68, v69
  v_mfma_f32_16x16x32_bf16 v[98:101], a[252:255], a[16:19], v[98:101]
  v_mul_f32 v86, v86, v140
  v_mul_f32 v87, v87, v141
  v_mul_f32 v88, v88, v142
  v_mul_f32 v89, v89, v143
  v_cvt_pk_bf16_f32 v194, v86, v87
  v_cvt_pk_bf16_f32 v195, v88, v89
  v_mfma_f32_16x16x32_bf16 v[50:53], v[176:179], v[184:187], 0
  v_mfma_f32_16x16x32_bf16 v[110:113], a[252:255], a[96:99], v[110:113]
  s_waitcnt lgkmcnt(4)
  ds_read_b128 a[244:247], v3 offset:21504
  v_mfma_f32_16x16x32_bf16 v[54:57], v[176:179], v[188:191], 0
  v_mfma_f32_16x16x32_bf16 v[58:61], v[180:183], v[184:187], 0
  v_mfma_f32_16x16x32_bf16 v[62:65], v[180:183], v[188:191], 0
  v_mfma_f32_16x16x32_bf16 v[90:93], a[224:227], a[20:23], v[90:93]
  buffer_load_dwordx4 v2, s[4:7], s33 offen offset:2048 lds
  v_mfma_f32_16x16x32_bf16 v[66:69], v[180:183], v[192:195], 0
  v_mfma_f32_16x16x32_bf16 v[70:73], v[184:187], v[188:191], 0
  v_mfma_f32_16x16x32_bf16 v[102:105], a[224:227], a[100:103], v[102:105]
  s_waitcnt lgkmcnt(4)
  ds_read_b128 a[248:251], v3 offset:22528
  v_mfma_f32_16x16x32_bf16 v[74:77], v[184:187], v[192:195], 0
  v_mfma_f32_16x16x32_bf16 v[78:81], v[176:179], v[46:49], 0
  v_mfma_f32_16x16x32_bf16 v[82:85], v[180:183], v[46:49], 0
  v_mfma_f32_16x16x32_bf16 v[94:97], a[228:231], a[20:23], v[94:97]
  v_mfma_f32_16x16x32_bf16 v[86:89], v[184:187], v[46:49], 0
  s_mov_b64 exec, s[40:41]
  ds_write_b128 v11, v[50:53] offset:512
  s_mov_b64 exec, s[42:43]
  ds_write_b128 v11, v[54:57] offset:768
  s_mov_b64 exec, -1
  v_mfma_f32_16x16x32_bf16 v[106:109], a[228:231], a[100:103], v[106:109]
  s_waitcnt lgkmcnt(6)
  ds_read_b128 a[252:255], v3 offset:23552
  s_mov_b64 exec, s[44:45]
  ds_write_b128 v12, v[58:61] offset:1856
  s_mov_b64 exec, s[46:47]
  ds_write_b128 v12, v[62:65] offset:2112
  s_mov_b64 exec, -1
  s_mov_b64 exec, s[48:49]
  ds_write_b128 v12, v[66:69] offset:2368
  s_mov_b64 exec, s[50:51]
  ds_write_b128 v11, v[70:73] offset:3136
  s_mov_b64 exec, -1
  v_mfma_f32_16x16x32_bf16 v[98:101], a[232:235], a[20:23], v[98:101]
  buffer_load_dwordx4 v2, s[4:7], s33 offen offset:3072 lds
  s_mov_b64 exec, s[52:53]
  ds_write_b128 v11, v[74:77] offset:3392
  s_mov_b64 exec, s[54:55]
  ds_write_b128 v11, v[78:81] offset:960
  s_mov_b64 exec, -1
  s_mov_b64 exec, s[56:57]
  ds_write_b128 v11, v[82:85] offset:2304
  s_mov_b64 exec, s[58:59]
  ds_write_b128 v11, v[86:89] offset:3648
  s_mov_b64 exec, -1
  v_mfma_f32_16x16x32_bf16 v[110:113], a[232:235], a[100:103], v[110:113]
  s_waitcnt lgkmcnt(14)
  ds_read_b128 a[224:227], v3 offset:24576
  v_mfma_f32_16x16x32_bf16 v[90:93], a[236:239], a[24:27], v[90:93]
  s_waitcnt lgkmcnt(1)
  s_barrier
  ds_read_b32 v152, v13 offset:0
  ds_read_b32 v153, v13 offset:3360
  ds_read_b32 v154, v13 offset:6720
  ds_read_b32 v155, v13 offset:10080
  ds_read_b32 v156, v13 offset:1024
  ds_read_b32 v157, v13 offset:4384
  ds_read_b32 v158, v13 offset:7744
  v_mfma_f32_16x16x32_bf16 v[102:105], a[236:239], a[104:107], v[102:105]
  ds_read_b128 a[228:231], v3 offset:25600
  ds_read_b32 v159, v13 offset:11104
  ds_read_b32 v160, v13 offset:2048
  ds_read_b32 v161, v13 offset:5408
  ds_read_b32 v162, v13 offset:8768
  ds_read_b32 v163, v13 offset:12128
  ds_read_b32 v164, v13 offset:3072
  ds_read_b32 v165, v13 offset:6432
  v_mfma_f32_16x16x32_bf16 v[94:97], a[240:243], a[24:27], v[94:97]
  s_add_u32 m0, s21, 45056
  ds_read_b32 v166, v13 offset:9792
  ds_read_b32 v167, v13 offset:13152
  s_mul_i32 s36, s14, 3360
  s_add_u32 s36, s36, s20
  s_add_u32 s36, s36, 25825280
  v_mfma_f32_16x16x32_bf16 v[106:109], a[240:243], a[104:107], v[106:109]
  ds_read_b128 a[232:235], v3 offset:26624
  v_mfma_f32_16x16x32_bf16 v[98:101], a[244:247], a[24:27], v[98:101]
  s_add_u32 s33, s23, 24576
  buffer_load_dwordx4 v2, s[4:7], s33 offen offset:0 lds
  v_mfma_f32_16x16x32_bf16 v[110:113], a[244:247], a[104:107], v[110:113]
  ds_read_b128 a[236:239], v3 offset:27648
  v_mfma_f32_16x16x32_bf16 v[90:93], a[248:251], a[28:31], v[90:93]
  s_waitcnt lgkmcnt(15)
  v_add_f32 v152, v152, v153
  v_add_f32 v154, v154, v155
  v_add_f32 v152, v152, v154
  buffer_atomic_add_f32 v152, v14, s[4:7], s36 offen offset:0
  v_mfma_f32_16x16x32_bf16 v[102:105], a[248:251], a[108:111], v[102:105]
  ds_read_b128 a[240:243], v3 offset:28672
  v_mfma_f32_16x16x32_bf16 v[94:97], a[252:255], a[28:31], v[94:97]
  s_waitcnt lgkmcnt(11)
  v_add_f32 v156, v156, v157
  v_add_f32 v158, v158, v159
  v_add_f32 v156, v156, v158
  buffer_atomic_add_f32 v156, v14, s[4:7], s36 offen offset:1024
  v_mfma_f32_16x16x32_bf16 v[106:109], a[252:255], a[108:111], v[106:109]
  ds_read_b128 a[244:247], v3 offset:29696
  v_mfma_f32_16x16x32_bf16 v[98:101], a[224:227], a[28:31], v[98:101]
  s_waitcnt lgkmcnt(8)
  v_add_f32 v160, v160, v161
  v_add_f32 v162, v162, v163
  v_add_f32 v160, v160, v162
  buffer_atomic_add_f32 v160, v14, s[4:7], s36 offen offset:2048
  v_mfma_f32_16x16x32_bf16 v[110:113], a[224:227], a[108:111], v[110:113]
  ds_read_b128 a[248:251], v3 offset:30720
  v_mfma_f32_16x16x32_bf16 v[90:93], a[228:231], a[32:35], v[90:93]
  s_waitcnt lgkmcnt(5)
  v_add_f32 v164, v164, v165
  v_add_f32 v166, v166, v167
  v_add_f32 v164, v164, v166
  buffer_atomic_add_f32 v164, v15, s[4:7], s36 offen offset:3072
  s_lshl_b32 s34, s26, 2
  s_add_u32 s34, s34, s20
  s_add_u32 s34, s34, 25915392
  v_mfma_f32_16x16x32_bf16 v[102:105], a[228:231], a[112:115], v[102:105]
  s_waitcnt lgkmcnt(4)
  ds_read_b128 a[252:255], v3 offset:31744
  v_mfma_f32_16x16x32_bf16 v[94:97], a[232:235], a[32:35], v[94:97]
  v_mfma_f32_16x16x32_bf16 v[106:109], a[232:235], a[112:115], v[106:109]
  s_waitcnt lgkmcnt(4)
  ds_read_b128 a[224:227], v3 offset:32768
  v_mfma_f32_16x16x32_bf16 v[98:101], a[236:239], a[32:35], v[98:101]
  v_mfma_f32_16x16x32_bf16 v[110:113], a[236:239], a[112:115], v[110:113]
  s_waitcnt lgkmcnt(4)
  ds_read_b128 a[228:231], v3 offset:33792
  v_mfma_f32_16x16x32_bf16 v[90:93], a[240:243], a[36:39], v[90:93]
  v_mfma_f32_16x16x32_bf16 v[102:105], a[240:243], a[116:119], v[102:105]
  s_waitcnt lgkmcnt(4)
  ds_read_b128 a[232:235], v3 offset:34816
  v_mfma_f32_16x16x32_bf16 v[94:97], a[244:247], a[36:39], v[94:97]
  v_mfma_f32_16x16x32_bf16 v[106:109], a[244:247], a[116:119], v[106:109]
  s_waitcnt lgkmcnt(4)
  ds_read_b128 a[236:239], v3 offset:35840
  v_mfma_f32_16x16x32_bf16 v[98:101], a[248:251], a[36:39], v[98:101]
  s_barrier
  v_mfma_f32_16x16x32_bf16 v[110:113], a[248:251], a[116:119], v[110:113]
  s_waitcnt lgkmcnt(4)
  ds_read_b128 a[240:243], v3 offset:36864
  v_mfma_f32_16x16x32_bf16 v[90:93], a[252:255], a[40:43], v[90:93]
  s_add_u32 m0, s21, 61440
  v_mfma_f32_16x16x32_bf16 v[102:105], a[252:255], a[120:123], v[102:105]
  s_waitcnt lgkmcnt(4)
  ds_read_b128 a[244:247], v3 offset:37888
  v_mfma_f32_16x16x32_bf16 v[94:97], a[224:227], a[40:43], v[94:97]
  s_add_u32 s33, s23, 40960
  buffer_load_dwordx4 v2, s[4:7], s33 offen offset:0 lds
  v_mfma_f32_16x16x32_bf16 v[106:109], a[224:227], a[120:123], v[106:109]
  s_waitcnt lgkmcnt(4)
  ds_read_b128 a[248:251], v3 offset:38912
  v_mfma_f32_16x16x32_bf16 v[98:101], a[228:231], a[40:43], v[98:101]
  v_mfma_f32_16x16x32_bf16 v[110:113], a[228:231], a[120:123], v[110:113]
  s_waitcnt lgkmcnt(4)
  ds_read_b128 a[252:255], v3 offset:39936
  v_mfma_f32_16x16x32_bf16 v[90:93], a[232:235], a[44:47], v[90:93]
  buffer_load_dwordx4 v2, s[4:7], s33 offen offset:1024 lds
  v_mfma_f32_16x16x32_bf16 v[102:105], a[232:235], a[124:127], v[102:105]
  s_waitcnt lgkmcnt(4)
  ds_read_b128 a[224:227], v3 offset:40960
  v_mfma_f32_16x16x32_bf16 v[94:97], a[236:239], a[44:47], v[94:97]
  v_mfma_f32_16x16x32_bf16 v[106:109], a[236:239], a[124:127], v[106:109]
  s_waitcnt lgkmcnt(4)
  ds_read_b128 a[228:231], v3 offset:41984
  v_mfma_f32_16x16x32_bf16 v[98:101], a[240:243], a[44:47], v[98:101]
  buffer_load_dwordx4 v2, s[4:7], s33 offen offset:2048 lds
  v_mfma_f32_16x16x32_bf16 v[110:113], a[240:243], a[124:127], v[110:113]
  s_waitcnt lgkmcnt(4)
  ds_read_b128 a[232:235], v3 offset:43008
  v_mfma_f32_16x16x32_bf16 v[90:93], a[244:247], a[48:51], v[90:93]
  v_mfma_f32_16x16x32_bf16 v[102:105], a[244:247], a[128:131], v[102:105]
  s_waitcnt lgkmcnt(4)
  ds_read_b128 a[236:239], v3 offset:44032
  v_mfma_f32_16x16x32_bf16 v[94:97], a[248:251], a[48:51], v[94:97]
  buffer_load_dwordx4 v2, s[4:7], s33 offen offset:3072 lds
  v_mfma_f32_16x16x32_bf16 v[106:109], a[248:251], a[128:131], v[106:109]
  s_waitcnt lgkmcnt(4)
  ds_read_b128 a[240:243], v3 offset:45056
  v_mfma_f32_16x16x32_bf16 v[98:101], a[252:255], a[48:51], v[98:101]
  v_mfma_f32_16x16x32_bf16 v[110:113], a[252:255], a[128:131], v[110:113]
  s_waitcnt lgkmcnt(4)
  ds_read_b128 a[244:247], v3 offset:46080
  v_mfma_f32_16x16x32_bf16 v[90:93], a[224:227], a[52:55], v[90:93]
  s_add_u32 m0, s21, 65536
  v_mfma_f32_16x16x32_bf16 v[102:105], a[224:227], a[132:135], v[102:105]
  s_waitcnt lgkmcnt(4)
  ds_read_b128 a[248:251], v3 offset:47104
  v_mfma_f32_16x16x32_bf16 v[94:97], a[228:231], a[52:55], v[94:97]
  s_add_u32 s33, s23, 45056
  buffer_load_dwordx4 v2, s[4:7], s33 offen offset:0 lds
  v_mfma_f32_16x16x32_bf16 v[106:109], a[228:231], a[132:135], v[106:109]
  s_waitcnt lgkmcnt(4)
  ds_read_b128 a[252:255], v3 offset:48128
  v_mfma_f32_16x16x32_bf16 v[98:101], a[232:235], a[52:55], v[98:101]
  v_mfma_f32_16x16x32_bf16 v[110:113], a[232:235], a[132:135], v[110:113]
  s_waitcnt lgkmcnt(4)
  ds_read_b128 a[224:227], v3 offset:49152
  v_mfma_f32_16x16x32_bf16 v[90:93], a[236:239], a[56:59], v[90:93]
  v_mfma_f32_16x16x32_bf16 v[102:105], a[236:239], a[136:139], v[102:105]
  s_waitcnt lgkmcnt(4)
  ds_read_b128 a[228:231], v3 offset:50176
  v_mfma_f32_16x16x32_bf16 v[94:97], a[240:243], a[56:59], v[94:97]
  v_mfma_f32_16x16x32_bf16 v[106:109], a[240:243], a[136:139], v[106:109]
  s_waitcnt lgkmcnt(4)
  ds_read_b128 a[232:235], v3 offset:51200
  v_mfma_f32_16x16x32_bf16 v[98:101], a[244:247], a[56:59], v[98:101]
  v_mfma_f32_16x16x32_bf16 v[110:113], a[244:247], a[136:139], v[110:113]
  s_waitcnt lgkmcnt(4)
  ds_read_b128 a[236:239], v3 offset:52224
  v_mfma_f32_16x16x32_bf16 v[90:93], a[248:251], a[60:63], v[90:93]
  v_mfma_f32_16x16x32_bf16 v[102:105], a[248:251], a[140:143], v[102:105]
  s_waitcnt lgkmcnt(4)
  ds_read_b128 a[240:243], v3 offset:53248
  v_mfma_f32_16x16x32_bf16 v[94:97], a[252:255], a[60:63], v[94:97]
  v_mfma_f32_16x16x32_bf16 v[106:109], a[252:255], a[140:143], v[106:109]
  s_waitcnt lgkmcnt(4)
  ds_read_b128 a[244:247], v3 offset:54272
  v_mfma_f32_16x16x32_bf16 v[98:101], a[224:227], a[60:63], v[98:101]
  v_mfma_f32_16x16x32_bf16 v[110:113], a[224:227], a[140:143], v[110:113]
  s_waitcnt lgkmcnt(4)
  ds_read_b128 a[248:251], v3 offset:55296
  v_mfma_f32_16x16x32_bf16 v[90:93], a[228:231], a[64:67], v[90:93]
  v_mfma_f32_16x16x32_bf16 v[102:105], a[228:231], a[144:147], v[102:105]
  s_waitcnt lgkmcnt(4)
  ds_read_b128 a[252:255], v3 offset:56320
  v_mfma_f32_16x16x32_bf16 v[94:97], a[232:235], a[64:67], v[94:97]
  s_waitcnt vmcnt(24)
  s_barrier
  v_mfma_f32_16x16x32_bf16 v[106:109], a[232:235], a[144:147], v[106:109]
  s_waitcnt lgkmcnt(4)
  ds_read_b128 a[224:227], v3 offset:57344
  v_mfma_f32_16x16x32_bf16 v[98:101], a[236:239], a[64:67], v[98:101]
  s_add_u32 m0, s21, 81920
  v_mfma_f32_16x16x32_bf16 v[110:113], a[236:239], a[144:147], v[110:113]
  s_waitcnt lgkmcnt(4)
  ds_read_b128 a[228:231], v3 offset:58368
  v_mfma_f32_16x16x32_bf16 v[90:93], a[240:243], a[68:71], v[90:93]
  s_add_u32 s33, s23, 61440
  buffer_load_dwordx4 v2, s[4:7], s33 offen offset:0 lds
  v_mfma_f32_16x16x32_bf16 v[102:105], a[240:243], a[148:151], v[102:105]
  s_waitcnt lgkmcnt(4)
  ds_read_b128 a[232:235], v3 offset:59392
  v_mfma_f32_16x16x32_bf16 v[94:97], a[244:247], a[68:71], v[94:97]
  s_waitcnt vmcnt(6)
  s_barrier
  buffer_store_dword v25, v23, s[4:7], s34 offen offset:0 sc1
  v_mfma_f32_16x16x32_bf16 v[106:109], a[244:247], a[148:151], v[106:109]
  s_waitcnt lgkmcnt(4)
  ds_read_b128 a[236:239], v3 offset:60416
  v_mfma_f32_16x16x32_bf16 v[98:101], a[248:251], a[68:71], v[98:101]
  buffer_load_dwordx4 v2, s[4:7], s33 offen offset:1024 lds
  v_mfma_f32_16x16x32_bf16 v[110:113], a[248:251], a[148:151], v[110:113]
  s_waitcnt lgkmcnt(4)
  ds_read_b128 a[240:243], v3 offset:61440
  v_mfma_f32_16x16x32_bf16 v[90:93], a[252:255], a[72:75], v[90:93]
  v_mfma_f32_16x16x32_bf16 v[102:105], a[252:255], a[152:155], v[102:105]
  s_waitcnt lgkmcnt(4)
  ds_read_b128 a[244:247], v3 offset:62464
  v_mfma_f32_16x16x32_bf16 v[94:97], a[224:227], a[72:75], v[94:97]
  buffer_load_dwordx4 v2, s[4:7], s33 offen offset:2048 lds
  v_mfma_f32_16x16x32_bf16 v[106:109], a[224:227], a[152:155], v[106:109]
  s_waitcnt lgkmcnt(4)
  ds_read_b128 a[248:251], v3 offset:63488
  v_mfma_f32_16x16x32_bf16 v[98:101], a[228:231], a[72:75], v[98:101]
  v_mfma_f32_16x16x32_bf16 v[110:113], a[228:231], a[152:155], v[110:113]
  s_waitcnt lgkmcnt(4)
  ds_read_b128 a[252:255], v3 offset:64512
  v_mfma_f32_16x16x32_bf16 v[90:93], a[232:235], a[76:79], v[90:93]
  buffer_load_dwordx4 v2, s[4:7], s33 offen offset:3072 lds
  v_mfma_f32_16x16x32_bf16 v[102:105], a[232:235], a[156:159], v[102:105]
  s_waitcnt lgkmcnt(4)
  v_mfma_f32_16x16x32_bf16 v[94:97], a[236:239], a[76:79], v[94:97]
  v_mfma_f32_16x16x32_bf16 v[106:109], a[236:239], a[156:159], v[106:109]
  s_waitcnt lgkmcnt(3)
  v_mfma_f32_16x16x32_bf16 v[98:101], a[240:243], a[76:79], v[98:101]
  s_add_u32 m0, s21, 86016
  v_mfma_f32_16x16x32_bf16 v[110:113], a[240:243], a[156:159], v[110:113]
  s_waitcnt lgkmcnt(2)
  v_mfma_f32_16x16x32_bf16 v[90:93], a[244:247], v[128:131], v[90:93]
  s_add_u32 s33, s23, 65536
  buffer_load_dwordx4 v2, s[4:7], s33 offen offset:0 lds
  v_mfma_f32_16x16x32_bf16 v[102:105], a[244:247], v[132:135], v[102:105]
  s_waitcnt lgkmcnt(1)
  v_mfma_f32_16x16x32_bf16 v[94:97], a[248:251], v[128:131], v[94:97]
  v_mfma_f32_16x16x32_bf16 v[106:109], a[248:251], v[132:135], v[106:109]
  s_waitcnt lgkmcnt(0)
  v_mfma_f32_16x16x32_bf16 v[98:101], a[252:255], v[128:131], v[98:101]
  v_mfma_f32_16x16x32_bf16 v[110:113], a[252:255], v[132:135], v[110:113]
  s_barrier
  s_mul_i32 s36, s14, 1280
  s_add_u32 s36, s36, s30
  s_add_u32 s36, s36, 2621440
  v_mul_f32 v168, v90, v126
  v_mul_f32 v169, v91, v126
  v_mul_f32 v170, v92, v126
  v_mul_f32 v171, v93, v126
  v_fma_f32 v90, v90, v122, s29
  v_fma_f32 v91, v91, v122, s29
  v_fma_f32 v92, v92, v122, s29
  v_fma_f32 v93, v93, v122, s29
  v_exp_f32 v168, v168 clamp
  v_exp_f32 v169, v169 clamp
  v_exp_f32 v170, v170 clamp
  v_exp_f32 v171, v171 clamp
  v_max_f32 v90, s29, v90
  v_max_f32 v91, s29, v91
  v_max_f32 v92, s29, v92
  v_max_f32 v93, s29, v93
  v_add_f32 v90, v90, v168
  v_add_f32 v91, v91, v169
  v_add_f32 v92, v92, v170
  v_add_f32 v93, v93, v171
  v_cvt_pk_bf16_f32 v196, v90, v91
  v_cvt_pk_bf16_f32 v197, v92, v93
  v_mul_f32 v172, v94, v126
  v_mul_f32 v173, v95, v126
  v_mul_f32 v174, v96, v126
  v_mul_f32 v175, v97, v126
  v_fma_f32 v94, v94, v122, s29
  v_fma_f32 v95, v95, v122, s29
  v_fma_f32 v96, v96, v122, s29
  v_fma_f32 v97, v97, v122, s29
  v_exp_f32 v172, v172 clamp
  v_exp_f32 v173, v173 clamp
  v_exp_f32 v174, v174 clamp
  v_exp_f32 v175, v175 clamp
  v_max_f32 v94, s29, v94
  v_max_f32 v95, s29, v95
  v_max_f32 v96, s29, v96
  v_max_f32 v97, s29, v97
  v_add_f32 v94, v94, v172
  v_add_f32 v95, v95, v173
  v_add_f32 v96, v96, v174
  v_add_f32 v97, v97, v175
  v_cvt_pk_bf16_f32 v198, v94, v95
  v_cvt_pk_bf16_f32 v199, v96, v97
  buffer_store_dwordx4 v[196:199], v2, s[4:7], s36 offen sc1
  v_mul_f32 v168, v98, v126
  v_mul_f32 v169, v99, v126
  v_mul_f32 v170, v100, v126
  v_mul_f32 v171, v101, v126
  v_fma_f32 v98, v98, v122, s29
  v_fma_f32 v99, v99, v122, s29
  v_fma_f32 v100, v100, v122, s29
  v_fma_f32 v101, v101, v122, s29
  v_exp_f32 v168, v168 clamp
  v_exp_f32 v169, v169 clamp
  v_exp_f32 v170, v170 clamp
  v_exp_f32 v171, v171 clamp
  v_max_f32 v98, s29, v98
  v_max_f32 v99, s29, v99
  v_max_f32 v100, s29, v100
  v_max_f32 v101, s29, v101
  v_add_f32 v98, v98, v168
  v_add_f32 v99, v99, v169
  v_add_f32 v100, v100, v170
  v_add_f32 v101, v101, v171
  v_cvt_pk_bf16_f32 v200, v98, v99
  v_cvt_pk_bf16_f32 v201, v100, v101
  buffer_store_dwordx2 v[200:201], v9, s[4:7], s36 offen offset:1024 sc1
  v_mul_f32 v168, v102, v127
  v_mul_f32 v169, v103, v127
  v_mul_f32 v170, v104, v127
  v_mul_f32 v171, v105, v127
  v_fma_f32 v102, v102, v123, s29
  v_fma_f32 v103, v103, v123, s29
  v_fma_f32 v104, v104, v123, s29
  v_fma_f32 v105, v105, v123, s29
  v_exp_f32 v168, v168 clamp
  v_exp_f32 v169, v169 clamp
  v_exp_f32 v170, v170 clamp
  v_exp_f32 v171, v171 clamp
  v_max_f32 v102, s29, v102
  v_max_f32 v103, s29, v103
  v_max_f32 v104, s29, v104
  v_max_f32 v105, s29, v105
  v_add_f32 v102, v102, v168
  v_add_f32 v103, v103, v169
  v_add_f32 v104, v104, v170
  v_add_f32 v105, v105, v171
  v_cvt_pk_bf16_f32 v202, v102, v103
  v_cvt_pk_bf16_f32 v203, v104, v105
  v_mul_f32 v172, v106, v127
  v_mul_f32 v173, v107, v127
  v_mul_f32 v174, v108, v127
  v_mul_f32 v175, v109, v127
  v_fma_f32 v106, v106, v123, s29
  v_fma_f32 v107, v107, v123, s29
  v_fma_f32 v108, v108, v123, s29
  v_fma_f32 v109, v109, v123, s29
  v_exp_f32 v172, v172 clamp
  v_exp_f32 v173, v173 clamp
  v_exp_f32 v174, v174 clamp
  v_exp_f32 v175, v175 clamp
  v_max_f32 v106, s29, v106
  v_max_f32 v107, s29, v107
  v_max_f32 v108, s29, v108
  v_max_f32 v109, s29, v109
  v_add_f32 v106, v106, v172
  v_add_f32 v107, v107, v173
  v_add_f32 v108, v108, v174
  v_add_f32 v109, v109, v175
  v_cvt_pk_bf16_f32 v204, v106, v107
  v_cvt_pk_bf16_f32 v205, v108, v109
  s_add_u32 s36, s36, 20480
  buffer_store_dwordx4 v[202:205], v2, s[4:7], s36 offen sc1
  v_mul_f32 v168, v110, v127
  v_mul_f32 v169, v111, v127
  v_mul_f32 v170, v112, v127
  v_mul_f32 v171, v113, v127
  v_fma_f32 v110, v110, v123, s29
  v_fma_f32 v111, v111, v123, s29
  v_fma_f32 v112, v112, v123, s29
  v_fma_f32 v113, v113, v123, s29
  v_exp_f32 v168, v168 clamp
  v_exp_f32 v169, v169 clamp
  v_exp_f32 v170, v170 clamp
  v_exp_f32 v171, v171 clamp
  v_max_f32 v110, s29, v110
  v_max_f32 v111, s29, v111
  v_max_f32 v112, s29, v112
  v_max_f32 v113, s29, v113
  v_add_f32 v110, v110, v168
  v_add_f32 v111, v111, v169
  v_add_f32 v112, v112, v170
  v_add_f32 v113, v113, v171
  v_cvt_pk_bf16_f32 v206, v110, v111
  v_cvt_pk_bf16_f32 v207, v112, v113
  buffer_store_dwordx2 v[206:207], v9, s[4:7], s36 offen offset:1024 sc1
  s_lshr_b32 s34, s26, 4
  s_lshl_b32 s34, s34, 11
  s_and_b32 s35, s26, 15
  s_lshl_b32 s35, s35, 2
  s_add_u32 s34, s34, s35
  s_add_u32 s34, s34, s20
  s_add_u32 s34, s34, 25931776
L_p2:
  v_mov_b32 v150, 0
  v_mov_b32 v151, 0
  v_mov_b32 v152, 0
  v_mov_b32 v153, 0
  ds_write_b128 v20, v[150:153] offset:0
  ds_write_b128 v20, v[150:153] offset:4096
  ds_write_b128 v20, v[150:153] offset:8192
  ds_write_b128 v20, v[150:153] offset:12288
  ds_write_b128 v20, v[150:153] offset:16384
  ds_write_b128 v20, v[150:153] offset:20480
  ds_write_b128 v20, v[150:153] offset:24576
  ds_write_b128 v20, v[150:153] offset:28672
  ds_write_b128 v20, v[150:153] offset:32768
  ds_write_b128 v20, v[150:153] offset:36864
  s_add_u32 s30, s20, 25825280
  s_mul_i32 s31, s16, 20480
  s_add_u32 s31, s31, s20
  s_add_u32 s31, s31, 13242368
  s_lshl_b32 s60, s27, 7
  s_add_u32 s60, s60, s20
  s_add_u32 s60, s60, 25931776
  s_add_u32 s35, s28, s20
  s_add_u32 s35, s35, 25915392
  buffer_load_dwordx4 v[252:255], v2, s[4:7], s35 offen sc1
  s_waitcnt lgkmcnt(0) vmcnt(1)
  s_barrier
  buffer_store_dword v25, v22, s[4:7], s34 offen sc1
  s_waitcnt vmcnt(1)
  v_min_u32 v253, v252, v253
  v_min3_u32 v253, v253, v254, v255
  v_cmp_eq_u32 vcc, 0, v253
  s_nop 1
  s_cbranch_vccz L_ok2k
  s_mov_b32 s37, 200000
L_sp2k:
  buffer_load_dwordx4 v[252:255], v2, s[4:7], s35 offen sc1
  s_waitcnt vmcnt(0)
  v_min_u32 v253, v252, v253
  v_min3_u32 v253, v253, v254, v255
  v_cmp_eq_u32 vcc, 0, v253
  s_nop 1
  s_cbranch_vccz L_ok2k
  s_sub_u32 s37, s37, 1
  s_cmp_lg_u32 s37, 0
  s_cbranch_scc1 L_sp2k
L_ok2k:
  buffer_load_dwordx4 v[50:53], v16, s[4:7], s30 offen sc1
  s_add_u32 s30, s30, 3360
  buffer_load_dwordx4 v[54:57], v16, s[4:7], s30 offen sc1
  s_add_u32 s30, s30, 3360
  buffer_load_dwordx4 v[58:61], v16, s[4:7], s30 offen sc1
  s_add_u32 s30, s30, 3360
  buffer_load_dwordx4 v[62:65], v16, s[4:7], s30 offen sc1
  s_add_u32 s30, s30, 3360
  buffer_load_dwordx4 v[66:69], v16, s[4:7], s30 offen sc1
  s_add_u32 s30, s30, 3360
  buffer_load_dwordx4 v[70:73], v16, s[4:7], s30 offen sc1
  s_add_u32 s30, s30, 3360
  buffer_load_dwordx4 v[74:77], v16, s[4:7], s30 offen sc1
  s_add_u32 s30, s30, 3360
  buffer_load_dwordx4 v[78:81], v16, s[4:7], s30 offen sc1
  s_add_u32 s30, s30, 3360
  buffer_load_dwordx4 v[82:85], v16, s[4:7], s30 offen sc1
  s_add_u32 s30, s30, 3360
  buffer_load_dwordx4 v[86:89], v16, s[4:7], s30 offen sc1
  s_add_u32 s30, s30, 3360
  buffer_load_dwordx4 v[90:93], v16, s[4:7], s30 offen sc1
  s_add_u32 s30, s30, 3360
  buffer_load_dwordx4 v[94:97], v16, s[4:7], s30 offen sc1
  s_add_u32 s30, s30, 3360
  buffer_load_dwordx4 v[98:101], v16, s[4:7], s30 offen sc1
  s_add_u32 s30, s30, 3360
  buffer_load_dwordx4 v[102:105], v16, s[4:7], s30 offen sc1
  s_add_u32 s30, s30, 3360
  buffer_load_dwordx4 v[106:109], v16, s[4:7], s30 offen sc1
  s_add_u32 s30, s30, 3360
  buffer_load_dwordx4 v[110:113], v16, s[4:7], s30 offen sc1
  buffer_load_dword v253, v24, s[4:7], s60 offen sc1
  s_waitcnt vmcnt(16)
  v_cvt_pk_bf16_f32 v50, v50, v51
  v_cvt_pk_bf16_f32 v51, v52, v53
  ds_write_b64 v17, v[50:51] offset:0
  s_waitcnt vmcnt(15)
  v_cvt_pk_bf16_f32 v54, v54, v55
  v_cvt_pk_bf16_f32 v55, v56, v57
  ds_write_b64 v17, v[54:55] offset:2560
  s_waitcnt vmcnt(14)
  v_cvt_pk_bf16_f32 v58, v58, v59
  v_cvt_pk_bf16_f32 v59, v60, v61
  ds_write_b64 v17, v[58:59] offset:5120
  s_waitcnt vmcnt(13)
  v_cvt_pk_bf16_f32 v62, v62, v63
  v_cvt_pk_bf16_f32 v63, v64, v65
  ds_write_b64 v17, v[62:63] offset:7680
  s_waitcnt vmcnt(12)
  v_cvt_pk_bf16_f32 v66, v66, v67
  v_cvt_pk_bf16_f32 v67, v68, v69
  ds_write_b64 v17, v[66:67] offset:10240
  s_waitcnt vmcnt(11)
  v_cvt_pk_bf16_f32 v70, v70, v71
  v_cvt_pk_bf16_f32 v71, v72, v73
  ds_write_b64 v17, v[70:71] offset:12800
  s_waitcnt vmcnt(10)
  v_cvt_pk_bf16_f32 v74, v74, v75
  v_cvt_pk_bf16_f32 v75, v76, v77
  ds_write_b64 v17, v[74:75] offset:15360
  s_waitcnt vmcnt(9)
  v_cvt_pk_bf16_f32 v78, v78, v79
  v_cvt_pk_bf16_f32 v79, v80, v81
  ds_write_b64 v17, v[78:79] offset:17920
  s_waitcnt vmcnt(0)
  v_cmp_eq_u32 vcc, 0, v253
  s_nop 1
  s_cbranch_vccz L_ok2
  s_mov_b32 s37, 200000
L_sp2:
  buffer_load_dword v253, v24, s[4:7], s60 offen offset:0 sc1
  s_waitcnt vmcnt(0)
  v_cmp_eq_u32 vcc, 0, v253
  s_nop 1
  s_cbranch_vccz L_ok2
  s_sub_u32 s37, s37, 1
  s_cmp_lg_u32 s37, 0
  s_cbranch_scc1 L_sp2
L_ok2:
  buffer_load_dwordx4 a[0:3], v21, s[4:7], s31 offen offset:0 sc1
  buffer_load_dwordx4 a[4:7], v21, s[4:7], s31 offen offset:512 sc1
  buffer_load_dwordx4 a[8:11], v21, s[4:7], s31 offen offset:1280 sc1
  buffer_load_dwordx4 a[12:15], v21, s[4:7], s31 offen offset:1792 sc1
  buffer_load_dwordx4 a[16:19], v21, s[4:7], s31 offen offset:2560 sc1
  buffer_load_dwordx4 a[20:23], v21, s[4:7], s31 offen offset:3072 sc1
  v_cvt_pk_bf16_f32 v82, v82, v83
  v_cvt_pk_bf16_f32 v83, v84, v85
  ds_write_b64 v17, v[82:83] offset:20480
  buffer_load_dwordx4 a[24:27], v21, s[4:7], s31 offen offset:3840 sc1
  v_cvt_pk_bf16_f32 v86, v86, v87
  v_cvt_pk_bf16_f32 v87, v88, v89
  ds_write_b64 v17, v[86:87] offset:23040
  s_add_u32 s32, s31, 4096
  buffer_load_dwordx4 a[28:31], v21, s[4:7], s32 offen offset:256 sc1
  v_cvt_pk_bf16_f32 v90, v90, v91
  v_cvt_pk_bf16_f32 v91, v92, v93
  ds_write_b64 v17, v[90:91] offset:25600
  buffer_load_dwordx4 a[32:35], v21, s[4:7], s32 offen offset:1024 sc1
  v_cvt_pk_bf16_f32 v94, v94, v95
  v_cvt_pk_bf16_f32 v95, v96, v97
  ds_write_b64 v17, v[94:95] offset:28160
  buffer_load_dwordx4 a[36:39], v21, s[4:7], s32 offen offset:1536 sc1
  v_cvt_pk_bf16_f32 v98, v98, v99
  v_cvt_pk_bf16_f32 v99, v100, v101
  ds_write_b64 v17, v[98:99] offset:30720
  buffer_load_dwordx4 a[40:43], v21, s[4:7], s32 offen offset:2304 sc1
  v_cvt_pk_bf16_f32 v102, v102, v103
  v_cvt_pk_bf16_f32 v103, v104, v105
  ds_write_b64 v17, v[102:103] offset:33280
  buffer_load_dwordx4 a[44:47], v21, s[4:7], s32 offen offset:2816 sc1
  v_cvt_pk_bf16_f32 v106, v106, v107
  v_cvt_pk_bf16_f32 v107, v108, v109
  ds_write_b64 v17, v[106:107] offset:35840
  buffer_load_dwordx4 a[48:51], v21, s[4:7], s32 offen offset:3584 sc1
  v_cvt_pk_bf16_f32 v110, v110, v111
  v_cvt_pk_bf16_f32 v111, v112, v113
  ds_write_b64 v17, v[110:111] offset:38400
  s_add_u32 s32, s31, 8192
  buffer_load_dwordx4 a[52:55], v21, s[4:7], s32 offen offset:0 sc1
  s_waitcnt lgkmcnt(0)
  s_barrier
  ds_read_b128 a[224:227], v18 offset:0
  ds_read_b128 a[228:231], v19 offset:0
  ds_read_b128 a[232:235], v18 offset:1280
  ds_read_b128 a[236:239], v19 offset:1280
  ds_read_b128 a[240:243], v18 offset:2560
  ds_read_b128 a[244:247], v19 offset:2560
  s_waitcnt vmcnt(13) lgkmcnt(5)
  v_mfma_f32_16x16x32_bf16 v[150:153], a[224:227], a[0:3], 0
  s_waitcnt lgkmcnt(3)
  ds_read_b128 a[248:251], v18 offset:3840
  buffer_load_dwordx4 a[56:59], v21, s[4:7], s32 offen offset:768 sc1
  v_mfma_f32_16x16x32_bf16 v[154:157], a[228:231], a[0:3], v[42:45]
  s_waitcnt vmcnt(13) lgkmcnt(3)
  ds_read_b128 a[252:255], v19 offset:3840
  v_mfma_f32_16x16x32_bf16 v[158:161], a[232:235], a[4:7], 0
  ds_read_b128 a[224:227], v2 offset:20480
  buffer_load_dwordx4 a[60:63], v21, s[4:7], s32 offen offset:1280 sc1
  v_mfma_f32_16x16x32_bf16 v[162:165], a[236:239], a[4:7], v[42:45]
  s_waitcnt vmcnt(13) lgkmcnt(3)
  ds_read_b128 a[228:231], v2 offset:21504
  v_rcp_f32 v155, v155
  v_mfma_f32_16x16x32_bf16 v[166:169], a[240:243], a[8:11], 0
  ds_read_b128 a[232:235], v2 offset:22528
  buffer_load_dwordx4 a[64:67], v21, s[4:7], s32 offen offset:2048 sc1
  v_mfma_f32_16x16x32_bf16 v[170:173], a[244:247], a[8:11], v[42:45]
  v_mul_f32 v150, v150, v155
  v_mul_f32 v151, v151, v155
  v_mul_f32 v152, v152, v155
  v_mul_f32 v153, v153, v155
  v_mul_f32 v154, v154, v155
  v_cvt_pk_bf16_f32 v50, v150, v151
  v_cvt_pk_bf16_f32 v51, v152, v153
  s_waitcnt vmcnt(13) lgkmcnt(3)
  ds_read_b128 a[236:239], v2 offset:23552
  v_rcp_f32 v163, v163
  v_mfma_f32_16x16x32_bf16 v[174:177], a[248:251], a[12:15], 0
  ds_read_b128 a[240:243], v2 offset:24576
  buffer_load_dwordx4 a[68:71], v21, s[4:7], s32 offen offset:2560 sc1
  v_mfma_f32_16x16x32_bf16 v[178:181], a[252:255], a[12:15], v[42:45]
  v_mul_f32 v158, v158, v163
  v_mul_f32 v159, v159, v163
  v_mul_f32 v160, v160, v163
  v_mul_f32 v161, v161, v163
  v_mul_f32 v162, v162, v163
  v_cvt_pk_bf16_f32 v52, v154, v158
  v_cvt_pk_bf16_f32 v53, v159, v160
  v_cvt_pk_bf16_f32 v54, v161, v162
  s_waitcnt lgkmcnt(3)
  ds_read_b128 a[244:247], v18 offset:5120
  v_rcp_f32 v171, v171
  v_mfma_f32_16x16x32_bf16 v[130:133], a[224:227], v[50:53], 0
  ds_read_b128 a[248:251], v19 offset:5120
  buffer_load_dwordx4 a[72:75], v21, s[4:7], s32 offen offset:3328 sc1
  v_mfma_f32_16x16x32_bf16 v[134:137], a[228:231], v[50:53], 0
  s_waitcnt lgkmcnt(3)
  ds_read_b128 a[252:255], v18 offset:6400
  v_rcp_f32 v179, v179
  v_mfma_f32_16x16x32_bf16 v[138:141], a[232:235], v[50:53], 0
  ds_read_b128 a[224:227], v19 offset:6400
  buffer_load_dwordx4 a[76:79], v21, s[4:7], s32 offen offset:3840 sc1
  v_mfma_f32_16x16x32_bf16 v[142:145], a[236:239], v[50:53], 0
  s_waitcnt lgkmcnt(3)
  ds_read_b128 a[228:231], v2 offset:25600
  v_mul_f32 v166, v166, v171
  v_mul_f32 v167, v167, v171
  v_mfma_f32_16x16x32_bf16 v[146:149], a[240:243], v[50:53], 0
  s_waitcnt vmcnt(15) lgkmcnt(3)
  ds_read_b128 a[232:235], v2 offset:26624
  v_mul_f32 v168, v168, v171
  v_mul_f32 v169, v169, v171
  v_mfma_f32_16x16x32_bf16 v[150:153], a[244:247], a[16:19], 0
  s_add_u32 s32, s31, 12288
  ds_read_b128 a[236:239], v2 offset:27648
  buffer_load_dwordx4 a[80:83], v21, s[4:7], s32 offen offset:512 sc1
  v_mfma_f32_16x16x32_bf16 v[154:157], a[248:251], a[16:19], v[42:45]
  v_mul_f32 v170, v170, v171
  v_cvt_pk_bf16_f32 v55, v166, v167
  v_cvt_pk_bf16_f32 v56, v168, v169
  s_waitcnt vmcnt(15) lgkmcnt(3)
  ds_read_b128 a[240:243], v2 offset:28672
  v_mul_f32 v174, v174, v179
  v_mul_f32 v175, v175, v179
  v_mfma_f32_16x16x32_bf16 v[158:161], a[252:255], a[20:23], 0
  ds_read_b128 a[244:247], v2 offset:29696
  buffer_load_dwordx4 a[84:87], v21, s[4:7], s32 offen offset:1024 sc1
  v_mfma_f32_16x16x32_bf16 v[162:165], a[224:227], a[20:23], v[42:45]
  v_mul_f32 v176, v176, v179
  v_mul_f32 v177, v177, v179
  v_mul_f32 v178, v178, v179
  v_cvt_pk_bf16_f32 v57, v170, v174
  v_cvt_pk_bf16_f32 v58, v175, v176
  v_cvt_pk_bf16_f32 v59, v177, v178
  s_waitcnt lgkmcnt(3)
  ds_read_b128 a[248:251], v18 offset:7680
  v_rcp_f32 v155, v155
  v_mfma_f32_16x16x32_bf16 v[130:133], a[228:231], v[54:57], v[130:133]
  ds_read_b128 a[252:255], v19 offset:7680
  buffer_load_dwordx4 a[88:91], v21, s[4:7], s32 offen offset:1792 sc1
  v_mfma_f32_16x16x32_bf16 v[134:137], a[232:235], v[54:57], v[134:137]
  s_waitcnt lgkmcnt(3)
  ds_read_b128 a[224:227], v2 offset:30720
  v_rcp_f32 v163, v163
  v_mfma_f32_16x16x32_bf16 v[138:141], a[236:239], v[54:57], v[138:141]
  ds_read_b128 a[228:231], v2 offset:31744
  buffer_load_dwordx4 a[92:95], v21, s[4:7], s32 offen offset:2304 sc1
  v_mfma_f32_16x16x32_bf16 v[142:145], a[240:243], v[54:57], v[142:145]
  s_waitcnt lgkmcnt(3)
  ds_read_b128 a[232:235], v2 offset:32768
  v_mul_f32 v150, v150, v155
  v_mul_f32 v151, v151, v155
  v_mfma_f32_16x16x32_bf16 v[146:149], a[244:247], v[54:57], v[146:149]
  s_waitcnt vmcnt(17) lgkmcnt(3)
  ds_read_b128 a[236:239], v2 offset:33792
  buffer_load_dwordx4 a[96:99], v21, s[4:7], s32 offen offset:3072 sc1
  v_mfma_f32_16x16x32_bf16 v[166:169], a[248:251], a[24:27], 0
  ds_read_b128 a[240:243], v2 offset:34816
  v_mul_f32 v152, v152, v155
  v_mul_f32 v153, v153, v155
  v_mfma_f32_16x16x32_bf16 v[170:173], a[252:255], a[24:27], v[42:45]
  v_mul_f32 v154, v154, v155
  v_cvt_pk_bf16_f32 v60, v150, v151
  v_cvt_pk_bf16_f32 v61, v152, v153
  s_waitcnt lgkmcnt(3)
  ds_read_b128 a[244:247], v18 offset:8960
  buffer_load_dwordx4 a[100:103], v21, s[4:7], s32 offen offset:3584 sc1
  v_mfma_f32_16x16x32_bf16 v[130:133], a[224:227], v[58:61], v[130:133]
  ds_read_b128 a[248:251], v19 offset:8960
  v_mul_f32 v158, v158, v163
  v_mul_f32 v159, v159, v163
  v_mfma_f32_16x16x32_bf16 v[134:137], a[228:231], v[58:61], v[134:137]
  s_waitcnt lgkmcnt(3)
  ds_read_b128 a[252:255], v18 offset:10240
  v_rcp_f32 v171, v171
  v_mfma_f32_16x16x32_bf16 v[138:141], a[232:235], v[58:61], v[138:141]
  s_add_u32 s32, s31, 16384
  ds_read_b128 a[224:227], v19 offset:10240
  buffer_load_dwordx4 a[104:107], v21, s[4:7], s32 offen offset:256 sc1
  v_mfma_f32_16x16x32_bf16 v[142:145], a[236:239], v[58:61], v[142:145]
  s_waitcnt lgkmcnt(3)
  ds_read_b128 a[228:231], v2 offset:35840
  v_mul_f32 v160, v160, v163
  v_mul_f32 v161, v161, v163
  v_mfma_f32_16x16x32_bf16 v[146:149], a[240:243], v[58:61], v[146:149]
  s_waitcnt vmcnt(19) lgkmcnt(3)
  ds_read_b128 a[232:235], v2 offset:36864
  buffer_load_dwordx4 a[108:111], v21, s[4:7], s32 offen offset:768 sc1
  v_mfma_f32_16x16x32_bf16 v[174:177], a[244:247], a[28:31], 0
  ds_read_b128 a[236:239], v2 offset:37888
  v_mul_f32 v162, v162, v163
  v_cvt_pk_bf16_f32 v62, v154, v158
  v_mfma_f32_16x16x32_bf16 v[178:181], a[248:251], a[28:31], v[42:45]
  v_cvt_pk_bf16_f32 v63, v159, v160
  v_cvt_pk_bf16_f32 v64, v161, v162
  s_waitcnt vmcnt(19) lgkmcnt(3)
  ds_read_b128 a[240:243], v2 offset:38912
  buffer_load_dwordx4 a[112:115], v21, s[4:7], s32 offen offset:1536 sc1
  v_mfma_f32_16x16x32_bf16 v[150:153], a[252:255], a[32:35], 0
  ds_read_b128 a[244:247], v2 offset:39936
  v_mul_f32 v166, v166, v171
  v_mul_f32 v167, v167, v171
  v_mfma_f32_16x16x32_bf16 v[154:157], a[224:227], a[32:35], v[42:45]
  v_mul_f32 v168, v168, v171
  v_mul_f32 v169, v169, v171
  v_mul_f32 v170, v170, v171
  v_cvt_pk_bf16_f32 v65, v166, v167
  v_cvt_pk_bf16_f32 v66, v168, v169
  s_waitcnt lgkmcnt(3)
  ds_read_b128 a[248:251], v18 offset:11520
  buffer_load_dwordx4 a[116:119], v21, s[4:7], s32 offen offset:2048 sc1
  v_mfma_f32_16x16x32_bf16 v[130:133], a[228:231], v[62:65], v[130:133]
  ds_read_b128 a[252:255], v19 offset:11520
  v_rcp_f32 v179, v179
  v_mfma_f32_16x16x32_bf16 v[134:137], a[232:235], v[62:65], v[134:137]
  s_waitcnt lgkmcnt(3)
  ds_read_b128 a[224:227], v2 offset:40960
  buffer_load_dwordx4 a[120:123], v21, s[4:7], s32 offen offset:2816 sc1
  v_mfma_f32_16x16x32_bf16 v[138:141], a[236:239], v[62:65], v[138:141]
  ds_read_b128 a[228:231], v2 offset:41984
  v_rcp_f32 v155, v155
  v_mfma_f32_16x16x32_bf16 v[142:145], a[240:243], v[62:65], v[142:145]
  s_waitcnt lgkmcnt(3)
  ds_read_b128 a[232:235], v2 offset:43008
  buffer_load_dwordx4 a[124:127], v21, s[4:7], s32 offen offset:3328 sc1
  v_mfma_f32_16x16x32_bf16 v[146:149], a[244:247], v[62:65], v[146:149]
  s_waitcnt vmcnt(22) lgkmcnt(3)
  ds_read_b128 a[236:239], v2 offset:44032
  v_mul_f32 v174, v174, v179
  v_mul_f32 v175, v175, v179
  v_mfma_f32_16x16x32_bf16 v[158:161], a[248:251], a[36:39], 0
  s_add_u32 m0, s21, 102400
  ds_read_b128 a[240:243], v2 offset:45056
  v_mul_f32 v176, v176, v179
  v_mul_f32 v177, v177, v179
  v_mfma_f32_16x16x32_bf16 v[162:165], a[252:255], a[36:39], v[42:45]
  v_mul_f32 v178, v178, v179
  v_cvt_pk_bf16_f32 v67, v170, v174
  v_cvt_pk_bf16_f32 v68, v175, v176
  v_cvt_pk_bf16_f32 v69, v177, v178
  s_waitcnt lgkmcnt(3)
  ds_read_b128 a[244:247], v18 offset:12800
  v_mul_f32 v150, v150, v155
  v_mul_f32 v151, v151, v155
  v_mfma_f32_16x16x32_bf16 v[130:133], a[224:227], v[66:69], v[130:133]
  s_add_u32 s33, s23, 81920
  ds_read_b128 a[248:251], v19 offset:12800
  buffer_load_dwordx4 v2, s[4:7], s33 offen offset:0 lds
  v_mfma_f32_16x16x32_bf16 v[134:137], a[228:231], v[66:69], v[134:137]
  s_waitcnt lgkmcnt(3)
  ds_read_b128 a[252:255], v18 offset:14080
  v_rcp_f32 v163, v163
  v_mfma_f32_16x16x32_bf16 v[138:141], a[232:235], v[66:69], v[138:141]
  ds_read_b128 a[224:227], v19 offset:14080
  buffer_load_dwordx4 v2, s[4:7], s33 offen offset:1024 lds
  v_mfma_f32_16x16x32_bf16 v[142:145], a[236:239], v[66:69], v[142:145]
  s_waitcnt lgkmcnt(3)
  ds_read_b128 a[228:231], v2 offset:46080
  v_mul_f32 v152, v152, v155
  v_mul_f32 v153, v153, v155
  v_mfma_f32_16x16x32_bf16 v[146:149], a[240:243], v[66:69], v[146:149]
  s_waitcnt vmcnt(23) lgkmcnt(3)
  ds_read_b128 a[232:235], v2 offset:47104
  buffer_load_dwordx4 v2, s[4:7], s33 offen offset:2048 lds
  v_mfma_f32_16x16x32_bf16 v[166:169], a[244:247], a[40:43], 0
  ds_read_b128 a[236:239], v2 offset:48128
  v_mul_f32 v154, v154, v155
  v_cvt_pk_bf16_f32 v70, v150, v151
  v_mfma_f32_16x16x32_bf16 v[170:173], a[248:251], a[40:43], v[42:45]
  v_cvt_pk_bf16_f32 v71, v152, v153
  s_waitcnt vmcnt(23) lgkmcnt(3)
  ds_read_b128 a[240:243], v2 offset:49152
  buffer_load_dwordx4 v2, s[4:7], s33 offen offset:3072 lds
  v_mfma_f32_16x16x32_bf16 v[174:177], a[252:255], a[44:47], 0
  ds_read_b128 a[244:247], v2 offset:50176
  v_mul_f32 v158, v158, v163
  v_mul_f32 v159, v159, v163
  v_mfma_f32_16x16x32_bf16 v[178:181], a[224:227], a[44:47], v[42:45]
  v_mul_f32 v160, v160, v163
  v_mul_f32 v161, v161, v163
  v_mul_f32 v162, v162, v163
  v_cvt_pk_bf16_f32 v72, v154, v158
  v_cvt_pk_bf16_f32 v73, v159, v160
  v_cvt_pk_bf16_f32 v74, v161, v162
  s_waitcnt lgkmcnt(3)
  ds_read_b128 a[248:251], v18 offset:15360
  v_rcp_f32 v171, v171
  v_mfma_f32_16x16x32_bf16 v[130:133], a[228:231], v[70:73], v[130:133]
  s_add_u32 m0, s21, 106496
  ds_read_b128 a[252:255], v19 offset:15360
  v_mul_f32 v166, v166, v171
  v_mul_f32 v167, v167, v171
  v_mfma_f32_16x16x32_bf16 v[134:137], a[232:235], v[70:73], v[134:137]
  s_waitcnt lgkmcnt(3)
  ds_read_b128 a[224:227], v18 offset:16640
  v_rcp_f32 v179, v179
  v_mfma_f32_16x16x32_bf16 v[138:141], a[236:239], v[70:73], v[138:141]
  s_add_u32 s33, s23, 86016
  ds_read_b128 a[228:231], v19 offset:16640
  buffer_load_dwordx4 v2, s[4:7], s33 offen offset:0 lds
  v_mfma_f32_16x16x32_bf16 v[142:145], a[240:243], v[70:73], v[142:145]
  s_waitcnt lgkmcnt(3)
  ds_read_b128 a[232:235], v2 offset:51200
  v_mul_f32 v168, v168, v171
  v_mul_f32 v169, v169, v171
  v_mfma_f32_16x16x32_bf16 v[146:149], a[244:247], v[70:73], v[146:149]
  s_waitcnt vmcnt(24) lgkmcnt(3)
  ds_read_b128 a[236:239], v2 offset:52224
  v_mul_f32 v170, v170, v171
  v_cvt_pk_bf16_f32 v75, v166, v167
  v_mfma_f32_16x16x32_bf16 v[150:153], a[248:251], a[48:51], 0
  ds_read_b128 a[240:243], v2 offset:53248
  v_cvt_pk_bf16_f32 v76, v168, v169
  v_mul_f32 v174, v174, v179
  v_mfma_f32_16x16x32_bf16 v[154:157], a[252:255], a[48:51], v[42:45]
  s_waitcnt vmcnt(23) lgkmcnt(3)
  ds_read_b128 a[244:247], v2 offset:54272
  v_mul_f32 v175, v175, v179
  v_mul_f32 v176, v176, v179
  v_mfma_f32_16x16x32_bf16 v[158:161], a[224:227], a[52:55], 0
  ds_read_b128 a[248:251], v2 offset:55296
  v_mul_f32 v177, v177, v179
  v_mul_f32 v178, v178, v179
  v_mfma_f32_16x16x32_bf16 v[162:165], a[228:231], a[52:55], v[42:45]
  v_cvt_pk_bf16_f32 v77, v170, v174
  v_cvt_pk_bf16_f32 v78, v175, v176
  v_cvt_pk_bf16_f32 v79, v177, v178
  s_waitcnt lgkmcnt(3)
  ds_read_b128 a[252:255], v18 offset:17920
  v_rcp_f32 v155, v155
  v_mfma_f32_16x16x32_bf16 v[130:133], a[232:235], v[74:77], v[130:133]
  ds_read_b128 a[224:227], v19 offset:17920
  v_mul_f32 v150, v150, v155
  v_mul_f32 v151, v151, v155
  v_mfma_f32_16x16x32_bf16 v[134:137], a[236:239], v[74:77], v[134:137]
  s_waitcnt lgkmcnt(3)
  ds_read_b128 a[228:231], v2 offset:56320
  v_rcp_f32 v163, v163
  v_mfma_f32_16x16x32_bf16 v[138:141], a[240:243], v[74:77], v[138:141]
  ds_read_b128 a[232:235], v2 offset:57344
  v_mul_f32 v152, v152, v155
  v_mul_f32 v153, v153, v155
  v_mfma_f32_16x16x32_bf16 v[142:145], a[244:247], v[74:77], v[142:145]
  s_waitcnt lgkmcnt(3)
  ds_read_b128 a[236:239], v2 offset:58368
  v_mul_f32 v154, v154, v155
  v_cvt_pk_bf16_f32 v80, v150, v151
  v_mfma_f32_16x16x32_bf16 v[146:149], a[248:251], v[74:77], v[146:149]
  s_waitcnt vmcnt(22) lgkmcnt(3)
  ds_read_b128 a[240:243], v2 offset:59392
  v_cvt_pk_bf16_f32 v81, v152, v153
  v_mul_f32 v158, v158, v163
  v_mfma_f32_16x16x32_bf16 v[166:169], a[252:255], a[56:59], 0
  ds_read_b128 a[244:247], v2 offset:60416
  v_mul_f32 v159, v159, v163
  v_mul_f32 v160, v160, v163
  v_mfma_f32_16x16x32_bf16 v[170:173], a[224:227], a[56:59], v[42:45]
  s_waitcnt lgkmcnt(3)
  ds_read_b128 a[248:251], v18 offset:19200
  v_mul_f32 v161, v161, v163
  v_mul_f32 v162, v162, v163
  v_mfma_f32_16x16x32_bf16 v[130:133], a[228:231], v[78:81], v[130:133]
  ds_read_b128 a[252:255], v19 offset:19200
  v_cvt_pk_bf16_f32 v82, v154, v158
  v_cvt_pk_bf16_f32 v83, v159, v160
  v_mfma_f32_16x16x32_bf16 v[134:137], a[232:235], v[78:81], v[134:137]
  s_waitcnt lgkmcnt(3)
  ds_read_b128 a[224:227], v18 offset:20480
  v_rcp_f32 v171, v171
  v_mfma_f32_16x16x32_bf16 v[138:141], a[236:239], v[78:81], v[138:141]
  ds_read_b128 a[228:231], v19 offset:20480
  v_cvt_pk_bf16_f32 v84, v161, v162
  v_mul_f32 v166, v166, v171
  v_mfma_f32_16x16x32_bf16 v[142:145], a[240:243], v[78:81], v[142:145]
  s_barrier
  s_waitcnt lgkmcnt(3)
  ds_read_b128 a[232:235], v2 offset:61440
  v_mul_f32 v167, v167, v171
  v_mfma_f32_16x16x32_bf16 v[146:149], a[244:247], v[78:81], v[146:149]
  s_waitcnt vmcnt(21) lgkmcnt(3)
  ds_read_b128 a[236:239], v2 offset:62464
  v_mul_f32 v168, v168, v171
  v_mul_f32 v169, v169, v171
  v_mfma_f32_16x16x32_bf16 v[174:177], a[248:251], a[60:63], 0
  s_add_u32 m0, s21, 20480
  ds_read_b128 a[240:243], v2 offset:63488
  v_mul_f32 v170, v170, v171
  v_cvt_pk_bf16_f32 v85, v166, v167
  v_mfma_f32_16x16x32_bf16 v[178:181], a[252:255], a[60:63], v[42:45]
  s_waitcnt vmcnt(20) lgkmcnt(3)
  ds_read_b128 a[244:247], v2 offset:64512
  v_cvt_pk_bf16_f32 v86, v168, v169
  v_mfma_f32_16x16x32_bf16 v[150:153], a[224:227], a[64:67], 0
  s_add_u32 s33, s24, 20480
  ds_read_b128 a[248:251], v3 offset:0
  buffer_load_dwordx4 v2, s[4:7], s33 offen offset:0 lds
  v_mfma_f32_16x16x32_bf16 v[154:157], a[228:231], a[64:67], v[42:45]
  s_waitcnt lgkmcnt(3)
  ds_read_b128 a[252:255], v18 offset:21760
  v_rcp_f32 v179, v179
  v_mfma_f32_16x16x32_bf16 v[130:133], a[232:235], v[82:85], v[130:133]
  ds_read_b128 a[224:227], v19 offset:21760
  buffer_load_dwordx4 v2, s[4:7], s33 offen offset:1024 lds
  v_mfma_f32_16x16x32_bf16 v[134:137], a[236:239], v[82:85], v[134:137]
  s_waitcnt lgkmcnt(3)
  ds_read_b128 a[228:231], v3 offset:1024
  v_rcp_f32 v155, v155
  v_mfma_f32_16x16x32_bf16 v[138:141], a[240:243], v[82:85], v[138:141]
  ds_read_b128 a[232:235], v3 offset:2048
  buffer_load_dwordx4 v2, s[4:7], s33 offen offset:2048 lds
  v_mfma_f32_16x16x32_bf16 v[142:145], a[244:247], v[82:85], v[142:145]
  s_waitcnt lgkmcnt(3)
  ds_read_b128 a[236:239], v3 offset:3072
  v_mul_f32 v174, v174, v179
  v_mul_f32 v175, v175, v179
  v_mfma_f32_16x16x32_bf16 v[146:149], a[248:251], v[82:85], v[146:149]
  s_waitcnt vmcnt(22) lgkmcnt(3)
  ds_read_b128 a[240:243], v3 offset:4096
  buffer_load_dwordx4 v2, s[4:7], s33 offen offset:3072 lds
  v_mfma_f32_16x16x32_bf16 v[158:161], a[252:255], a[68:71], 0
  ds_read_b128 a[244:247], v3 offset:5120
  v_mul_f32 v176, v176, v179
  v_mul_f32 v177, v177, v179
  v_mfma_f32_16x16x32_bf16 v[162:165], a[224:227], a[68:71], v[42:45]
  v_mul_f32 v178, v178, v179
  v_cvt_pk_bf16_f32 v87, v170, v174
  v_cvt_pk_bf16_f32 v88, v175, v176
  v_cvt_pk_bf16_f32 v89, v177, v178
  s_waitcnt lgkmcnt(3)
  ds_read_b128 a[248:251], v18 offset:23040
  v_mul_f32 v150, v150, v155
  v_mul_f32 v151, v151, v155
  v_mfma_f32_16x16x32_bf16 v[130:133], a[228:231], v[86:89], v[130:133]
  s_add_u32 m0, s21, 24576
  ds_read_b128 a[252:255], v19 offset:23040
  v_mul_f32 v152, v152, v155
  v_mul_f32 v153, v153, v155
  v_mfma_f32_16x16x32_bf16 v[134:137], a[232:235], v[86:89], v[134:137]
  s_waitcnt lgkmcnt(3)
  ds_read_b128 a[224:227], v18 offset:24320
  v_rcp_f32 v163, v163
  v_mfma_f32_16x16x32_bf16 v[138:141], a[236:239], v[86:89], v[138:141]
  s_add_u32 s33, s24, 24576
  ds_read_b128 a[228:231], v19 offset:24320
  buffer_load_dwordx4 v2, s[4:7], s33 offen offset:0 lds
  v_mfma_f32_16x16x32_bf16 v[142:145], a[240:243], v[86:89], v[142:145]
  s_waitcnt lgkmcnt(3)
  ds_read_b128 a[232:235], v3 offset:6144
  v_mul_f32 v154, v154, v155
  v_cvt_pk_bf16_f32 v90, v150, v151
  v_mfma_f32_16x16x32_bf16 v[146:149], a[244:247], v[86:89], v[146:149]
  s_waitcnt vmcnt(23) lgkmcnt(3)
  ds_read_b128 a[236:239], v3 offset:7168
  v_cvt_pk_bf16_f32 v91, v152, v153
  v_mul_f32 v158, v158, v163
  v_mfma_f32_16x16x32_bf16 v[166:169], a[248:251], a[72:75], 0
  ds_read_b128 a[240:243], v3 offset:8192
  v_mul_f32 v159, v159, v163
  v_mul_f32 v160, v160, v163
  v_mfma_f32_16x16x32_bf16 v[170:173], a[252:255], a[72:75], v[42:45]
  s_waitcnt vmcnt(22) lgkmcnt(3)
  ds_read_b128 a[244:247], v3 offset:9216
  v_mul_f32 v161, v161, v163
  v_mul_f32 v162, v162, v163
  v_mfma_f32_16x16x32_bf16 v[174:177], a[224:227], a[76:79], 0
  ds_read_b128 a[248:251], v3 offset:10240
  v_cvt_pk_bf16_f32 v92, v154, v158
  v_cvt_pk_bf16_f32 v93, v159, v160
  v_mfma_f32_16x16x32_bf16 v[178:181], a[228:231], a[76:79], v[42:45]
  v_cvt_pk_bf16_f32 v94, v161, v162
  s_waitcnt lgkmcnt(3)
  ds_read_b128 a[252:255], v18 offset:25600
  v_rcp_f32 v171, v171
  v_mfma_f32_16x16x32_bf16 v[130:133], a[232:235], v[90:93], v[130:133]
  ds_read_b128 a[224:227], v19 offset:25600
  v_mul_f32 v166, v166, v171
  v_mul_f32 v167, v167, v171
  v_mfma_f32_16x16x32_bf16 v[134:137], a[236:239], v[90:93], v[134:137]
  s_waitcnt lgkmcnt(3)
  ds_read_b128 a[228:231], v18 offset:26880
  v_rcp_f32 v179, v179
  v_mfma_f32_16x16x32_bf16 v[138:141], a[240:243], v[90:93], v[138:141]
  ds_read_b128 a[232:235], v19 offset:26880
  v_mul_f32 v168, v168, v171
  v_mul_f32 v169, v169, v171
  v_mfma_f32_16x16x32_bf16 v[142:145], a[244:247], v[90:93], v[142:145]
  s_waitcnt lgkmcnt(3)
  ds_read_b128 a[236:239], v3 offset:11264
  v_mul_f32 v170, v170, v171
  v_cvt_pk_bf16_f32 v95, v166, v167
  v_mfma_f32_16x16x32_bf16 v[146:149], a[248:251], v[90:93], v[146:149]
  s_waitcnt vmcnt(21) lgkmcnt(3)
  ds_read_b128 a[240:243], v3 offset:12288
  v_cvt_pk_bf16_f32 v96, v168, v169
  v_mul_f32 v174, v174, v179
  v_mfma_f32_16x16x32_bf16 v[150:153], a[252:255], a[80:83], 0
  ds_read_b128 a[244:247], v3 offset:13312
  v_mul_f32 v175, v175, v179
  v_mul_f32 v176, v176, v179
  v_mfma_f32_16x16x32_bf16 v[154:157], a[224:227], a[80:83], v[42:45]
  s_waitcnt vmcnt(20) lgkmcnt(3)
  ds_read_b128 a[248:251], v3 offset:14336
  v_mul_f32 v177, v177, v179
  v_mul_f32 v178, v178, v179
  v_mfma_f32_16x16x32_bf16 v[158:161], a[228:231], a[84:87], 0
  ds_read_b128 a[252:255], v3 offset:15360
  v_cvt_pk_bf16_f32 v97, v170, v174
  v_cvt_pk_bf16_f32 v98, v175, v176
  v_mfma_f32_16x16x32_bf16 v[162:165], a[232:235], a[84:87], v[42:45]
  v_cvt_pk_bf16_f32 v99, v177, v178
  s_waitcnt lgkmcnt(3)
  ds_read_b128 a[224:227], v18 offset:28160
  v_rcp_f32 v155, v155
  v_mfma_f32_16x16x32_bf16 v[130:133], a[236:239], v[94:97], v[130:133]
  ds_read_b128 a[228:231], v19 offset:28160
  v_mul_f32 v150, v150, v155
  v_mul_f32 v151, v151, v155
  v_mfma_f32_16x16x32_bf16 v[134:137], a[240:243], v[94:97], v[134:137]
  s_barrier
  s_waitcnt lgkmcnt(3)
  ds_read_b128 a[232:235], v3 offset:16384
  v_mul_f32 v152, v152, v155
  v_mfma_f32_16x16x32_bf16 v[138:141], a[244:247], v[94:97], v[138:141]
  s_add_u32 m0, s21, 40960
  ds_read_b128 a[236:239], v3 offset:17408
  v_rcp_f32 v163, v163
  v_mfma_f32_16x16x32_bf16 v[142:145], a[248:251], v[94:97], v[142:145]
  s_waitcnt lgkmcnt(3)
  ds_read_b128 a[240:243], v3 offset:18432
  v_mul_f32 v153, v153, v155
  v_mul_f32 v154, v154, v155
  v_mfma_f32_16x16x32_bf16 v[146:149], a[252:255], v[94:97], v[146:149]
  s_waitcnt vmcnt(19) lgkmcnt(3)
  ds_read_b128 a[244:247], v3 offset:19456
  v_cvt_pk_bf16_f32 v100, v150, v151
  v_cvt_pk_bf16_f32 v101, v152, v153
  v_mfma_f32_16x16x32_bf16 v[166:169], a[224:227], a[88:91], 0
  s_add_u32 s33, s24, 40960
  ds_read_b128 a[248:251], v3 offset:20480
  buffer_load_dwordx4 v2, s[4:7], s33 offen offset:0 lds
  v_mfma_f32_16x16x32_bf16 v[170:173], a[228:231], a[88:91], v[42:45]
  s_waitcnt lgkmcnt(3)
  ds_read_b128 a[252:255], v18 offset:29440
  v_mul_f32 v158, v158, v163
  v_mul_f32 v159, v159, v163
  v_mfma_f32_16x16x32_bf16 v[130:133], a[232:235], v[98:101], v[130:133]
  ds_read_b128 a[224:227], v19 offset:29440
  buffer_load_dwordx4 v2, s[4:7], s33 offen offset:1024 lds
  v_mfma_f32_16x16x32_bf16 v[134:137], a[236:239], v[98:101], v[134:137]
  s_waitcnt lgkmcnt(3)
  ds_read_b128 a[228:231], v18 offset:30720
  v_rcp_f32 v171, v171
  v_mfma_f32_16x16x32_bf16 v[138:141], a[240:243], v[98:101], v[138:141]
  ds_read_b128 a[232:235], v19 offset:30720
  buffer_load_dwordx4 v2, s[4:7], s33 offen offset:2048 lds
  v_mfma_f32_16x16x32_bf16 v[142:145], a[244:247], v[98:101], v[142:145]
  s_waitcnt lgkmcnt(3)
  ds_read_b128 a[236:239], v3 offset:21504
  v_mul_f32 v160, v160, v163
  v_mul_f32 v161, v161, v163
  v_mfma_f32_16x16x32_bf16 v[146:149], a[248:251], v[98:101], v[146:149]
  s_waitcnt vmcnt(21) lgkmcnt(3)
  ds_read_b128 a[240:243], v3 offset:22528
  buffer_load_dwordx4 v2, s[4:7], s33 offen offset:3072 lds
  v_mfma_f32_16x16x32_bf16 v[174:177], a[252:255], a[92:95], 0
  ds_read_b128 a[244:247], v3 offset:23552
  v_mul_f32 v162, v162, v163
  v_cvt_pk_bf16_f32 v102, v154, v158
  v_mfma_f32_16x16x32_bf16 v[178:181], a[224:227], a[92:95], v[42:45]
  v_cvt_pk_bf16_f32 v103, v159, v160
  v_cvt_pk_bf16_f32 v104, v161, v162
  s_waitcnt vmcnt(21) lgkmcnt(3)
  ds_read_b128 a[248:251], v3 offset:24576
  v_mul_f32 v166, v166, v171
  v_mul_f32 v167, v167, v171
  v_mfma_f32_16x16x32_bf16 v[150:153], a[228:231], a[96:99], 0
  s_add_u32 m0, s21, 45056
  ds_read_b128 a[252:255], v3 offset:25600
  v_mul_f32 v168, v168, v171
  v_mul_f32 v169, v169, v171
  v_mfma_f32_16x16x32_bf16 v[154:157], a[232:235], a[96:99], v[42:45]
  v_mul_f32 v170, v170, v171
  v_cvt_pk_bf16_f32 v105, v166, v167
  v_cvt_pk_bf16_f32 v106, v168, v169
  s_waitcnt lgkmcnt(3)
  ds_read_b128 a[224:227], v18 offset:32000
  v_rcp_f32 v179, v179
  v_mfma_f32_16x16x32_bf16 v[130:133], a[236:239], v[102:105], v[130:133]
  s_add_u32 s33, s24, 45056
  ds_read_b128 a[228:231], v19 offset:32000
  buffer_load_dwordx4 v2, s[4:7], s33 offen offset:0 lds
  v_mfma_f32_16x16x32_bf16 v[134:137], a[240:243], v[102:105], v[134:137]
  s_waitcnt lgkmcnt(3)
  ds_read_b128 a[232:235], v3 offset:26624
  v_rcp_f32 v155, v155
  v_mfma_f32_16x16x32_bf16 v[138:141], a[244:247], v[102:105], v[138:141]
  ds_read_b128 a[236:239], v3 offset:27648
  v_mul_f32 v174, v174, v179
  v_mul_f32 v175, v175, v179
  v_mfma_f32_16x16x32_bf16 v[142:145], a[248:251], v[102:105], v[142:145]
  s_waitcnt lgkmcnt(3)
  ds_read_b128 a[240:243], v3 offset:28672
  v_mul_f32 v176, v176, v179
  v_mul_f32 v177, v177, v179
  v_mfma_f32_16x16x32_bf16 v[146:149], a[252:255], v[102:105], v[146:149]
  s_waitcnt vmcnt(21) lgkmcnt(3)
  ds_read_b128 a[244:247], v3 offset:29696
  v_mul_f32 v178, v178, v179
  v_cvt_pk_bf16_f32 v107, v170, v174
  v_mfma_f32_16x16x32_bf16 v[158:161], a[224:227], a[100:103], 0
  ds_read_b128 a[248:251], v3 offset:30720
  v_cvt_pk_bf16_f32 v108, v175, v176
  v_cvt_pk_bf16_f32 v109, v177, v178
  v_mfma_f32_16x16x32_bf16 v[162:165], a[228:231], a[100:103], v[42:45]
  s_waitcnt lgkmcnt(3)
  ds_read_b128 a[252:255], v18 offset:33280
  v_mul_f32 v150, v150, v155
  v_mul_f32 v151, v151, v155
  v_mfma_f32_16x16x32_bf16 v[130:133], a[232:235], v[106:109], v[130:133]
  ds_read_b128 a[224:227], v19 offset:33280
  v_mul_f32 v152, v152, v155
  v_mul_f32 v153, v153, v155
  v_mfma_f32_16x16x32_bf16 v[134:137], a[236:239], v[106:109], v[134:137]
  s_waitcnt lgkmcnt(3)
  ds_read_b128 a[228:231], v18 offset:34560
  v_rcp_f32 v163, v163
  v_mfma_f32_16x16x32_bf16 v[138:141], a[240:243], v[106:109], v[138:141]
  ds_read_b128 a[232:235], v19 offset:34560
  v_mul_f32 v154, v154, v155
  v_cvt_pk_bf16_f32 v110, v150, v151
  v_mfma_f32_16x16x32_bf16 v[142:145], a[244:247], v[106:109], v[142:145]
  s_waitcnt lgkmcnt(3)
  ds_read_b128 a[236:239], v3 offset:31744
  v_cvt_pk_bf16_f32 v111, v152, v153
  v_mul_f32 v158, v158, v163
  v_mfma_f32_16x16x32_bf16 v[146:149], a[248:251], v[106:109], v[146:149]
  s_waitcnt vmcnt(20) lgkmcnt(3)
  ds_read_b128 a[240:243], v3 offset:32768
  v_mul_f32 v159, v159, v163
  v_mul_f32 v160, v160, v163
  v_mfma_f32_16x16x32_bf16 v[166:169], a[252:255], a[104:107], 0
  ds_read_b128 a[244:247], v3 offset:33792
  v_mul_f32 v161, v161, v163
  v_mul_f32 v162, v162, v163
  v_mfma_f32_16x16x32_bf16 v[170:173], a[224:227], a[104:107], v[42:45]
  s_waitcnt vmcnt(19) lgkmcnt(3)
  ds_read_b128 a[248:251], v3 offset:34816
  v_cvt_pk_bf16_f32 v112, v154, v158
  v_cvt_pk_bf16_f32 v113, v159, v160
  v_mfma_f32_16x16x32_bf16 v[174:177], a[228:231], a[108:111], 0
  ds_read_b128 a[252:255], v3 offset:35840
  v_cvt_pk_bf16_f32 v114, v161, v162
  v_mfma_f32_16x16x32_bf16 v[178:181], a[232:235], a[108:111], v[42:45]
  s_waitcnt lgkmcnt(3)
  ds_read_b128 a[224:227], v18 offset:35840
  v_rcp_f32 v171, v171
  v_mfma_f32_16x16x32_bf16 v[130:133], a[236:239], v[110:113], v[130:133]
  ds_read_b128 a[228:231], v19 offset:35840
  v_mul_f32 v166, v166, v171
  v_mul_f32 v167, v167, v171
  v_mfma_f32_16x16x32_bf16 v[134:137], a[240:243], v[110:113], v[134:137]
  s_waitcnt lgkmcnt(3)
  ds_read_b128 a[232:235], v18 offset:37120
  v_rcp_f32 v179, v179
  v_mfma_f32_16x16x32_bf16 v[138:141], a[244:247], v[110:113], v[138:141]
  ds_read_b128 a[236:239], v19 offset:37120
  v_mul_f32 v168, v168, v171
  v_mul_f32 v169, v169, v171
  v_mfma_f32_16x16x32_bf16 v[142:145], a[248:251], v[110:113], v[142:145]
  s_waitcnt vmcnt(10)
  s_barrier
  s_waitcnt lgkmcnt(3)
  ds_read_b128 a[240:243], v3 offset:36864
  v_mul_f32 v170, v170, v171
  v_mfma_f32_16x16x32_bf16 v[146:149], a[252:255], v[110:113], v[146:149]
  s_waitcnt lgkmcnt(3)
  ds_read_b128 a[244:247], v3 offset:37888
  v_cvt_pk_bf16_f32 v115, v166, v167
  v_cvt_pk_bf16_f32 v116, v168, v169
  v_mfma_f32_16x16x32_bf16 v[150:153], a[224:227], a[112:115], 0
  s_add_u32 m0, s21, 61440
  ds_read_b128 a[248:251], v3 offset:38912
  v_mul_f32 v174, v174, v179
  v_mul_f32 v175, v175, v179
  v_mfma_f32_16x16x32_bf16 v[154:157], a[228:231], a[112:115], v[42:45]
  s_waitcnt lgkmcnt(3)
  ds_read_b128 a[252:255], v3 offset:39936
  v_mul_f32 v176, v176, v179
  v_mul_f32 v177, v177, v179
  v_mfma_f32_16x16x32_bf16 v[158:161], a[232:235], a[116:119], 0
  s_add_u32 s33, s24, 61440
  ds_read_b128 a[224:227], v3 offset:40960
  buffer_load_dwordx4 v2, s[4:7], s33 offen offset:0 lds
  v_mfma_f32_16x16x32_bf16 v[162:165], a[236:239], a[116:119], v[42:45]
  v_mul_f32 v178, v178, v179
  v_cvt_pk_bf16_f32 v117, v170, v174
  v_cvt_pk_bf16_f32 v118, v175, v176
  v_cvt_pk_bf16_f32 v119, v177, v178
  s_waitcnt lgkmcnt(3)
  ds_read_b128 a[228:231], v18 offset:38400
  v_rcp_f32 v155, v155
  v_mfma_f32_16x16x32_bf16 v[130:133], a[240:243], v[114:117], v[130:133]
  ds_read_b128 a[232:235], v19 offset:38400
  buffer_load_dwordx4 v2, s[4:7], s33 offen offset:1024 lds
  v_mfma_f32_16x16x32_bf16 v[134:137], a[244:247], v[114:117], v[134:137]
  s_waitcnt lgkmcnt(3)
  ds_read_b128 a[236:239], v3 offset:41984
  v_rcp_f32 v163, v163
  v_mfma_f32_16x16x32_bf16 v[138:141], a[248:251], v[114:117], v[138:141]
  ds_read_b128 a[240:243], v3 offset:43008
  buffer_load_dwordx4 v2, s[4:7], s33 offen offset:2048 lds
  v_mfma_f32_16x16x32_bf16 v[142:145], a[252:255], v[114:117], v[142:145]
  s_waitcnt lgkmcnt(3)
  ds_read_b128 a[244:247], v3 offset:44032
  v_mul_f32 v150, v150, v155
  v_mul_f32 v151, v151, v155
  v_mfma_f32_16x16x32_bf16 v[146:149], a[224:227], v[114:117], v[146:149]
  s_waitcnt lgkmcnt(3)
  ds_read_b128 a[248:251], v3 offset:45056
  buffer_load_dwordx4 v2, s[4:7], s33 offen offset:3072 lds
  v_mfma_f32_16x16x32_bf16 v[166:169], a[228:231], a[120:123], 0
  ds_read_b128 a[252:255], v3 offset:46080
  v_mul_f32 v152, v152, v155
  v_mul_f32 v153, v153, v155
  v_mfma_f32_16x16x32_bf16 v[170:173], a[232:235], a[120:123], v[42:45]
  v_mul_f32 v154, v154, v155
  v_cvt_pk_bf16_f32 v120, v150, v151
  v_cvt_pk_bf16_f32 v121, v152, v153
  s_waitcnt lgkmcnt(3)
  ds_read_b128 a[224:227], v18 offset:39680
  v_mul_f32 v158, v158, v163
  v_mul_f32 v159, v159, v163
  v_mfma_f32_16x16x32_bf16 v[130:133], a[236:239], v[118:121], v[130:133]
  s_add_u32 m0, s21, 65536
  ds_read_b128 a[228:231], v19 offset:39680
  v_mul_f32 v160, v160, v163
  v_mul_f32 v161, v161, v163
  v_mfma_f32_16x16x32_bf16 v[134:137], a[240:243], v[118:121], v[134:137]
  s_waitcnt lgkmcnt(3)
  ds_read_b128 a[232:235], v3 offset:47104
  v_rcp_f32 v171, v171
  v_mfma_f32_16x16x32_bf16 v[138:141], a[244:247], v[118:121], v[138:141]
  s_add_u32 s33, s24, 65536
  ds_read_b128 a[236:239], v3 offset:48128
  buffer_load_dwordx4 v2, s[4:7], s33 offen offset:0 lds
  v_mfma_f32_16x16x32_bf16 v[142:145], a[248:251], v[118:121], v[142:145]
  s_waitcnt lgkmcnt(3)
  ds_read_b128 a[240:243], v3 offset:49152
  v_mul_f32 v162, v162, v163
  v_cvt_pk_bf16_f32 v122, v154, v158
  v_mfma_f32_16x16x32_bf16 v[146:149], a[252:255], v[118:121], v[146:149]
  s_waitcnt lgkmcnt(3)
  ds_read_b128 a[244:247], v3 offset:50176
  v_cvt_pk_bf16_f32 v123, v159, v160
  v_cvt_pk_bf16_f32 v124, v161, v162
  v_mfma_f32_16x16x32_bf16 v[174:177], a[224:227], a[124:127], 0
  ds_read_b128 a[248:251], v3 offset:51200
  v_mul_f32 v166, v166, v171
  v_mul_f32 v167, v167, v171
  v_mfma_f32_16x16x32_bf16 v[178:181], a[228:231], a[124:127], v[42:45]
  v_mul_f32 v168, v168, v171
  v_mul_f32 v169, v169, v171
  v_mul_f32 v170, v170, v171
  v_cvt_pk_bf16_f32 v125, v166, v167
  v_cvt_pk_bf16_f32 v126, v168, v169
  s_waitcnt lgkmcnt(3)
  ds_read_b128 a[252:255], v3 offset:52224
  v_mfma_f32_16x16x32_bf16 v[130:133], a[232:235], v[122:125], v[130:133]
  ds_read_b128 a[224:227], v3 offset:53248
  v_mfma_f32_16x16x32_bf16 v[134:137], a[236:239], v[122:125], v[134:137]
  s_waitcnt lgkmcnt(3)
  ds_read_b128 a[228:231], v3 offset:54272
  v_rcp_f32 v179, v179
  v_mfma_f32_16x16x32_bf16 v[138:141], a[240:243], v[122:125], v[138:141]
  ds_read_b128 a[232:235], v3 offset:55296
  v_mul_f32 v174, v174, v179
  v_mul_f32 v175, v175, v179
  v_mfma_f32_16x16x32_bf16 v[142:145], a[244:247], v[122:125], v[142:145]
  s_waitcnt lgkmcnt(3)
  ds_read_b128 a[236:239], v3 offset:56320
  v_mul_f32 v176, v176, v179
  v_mul_f32 v177, v177, v179
  v_mfma_f32_16x16x32_bf16 v[146:149], a[248:251], v[122:125], v[146:149]
  v_mul_f32 v178, v178, v179
  v_cvt_pk_bf16_f32 v127, v170, v174
  v_cvt_pk_bf16_f32 v128, v175, v176
  v_cvt_pk_bf16_f32 v129, v177, v178
  s_nop 1
  v_mfma_f32_16x16x32_bf16 v[130:133], a[252:255], v[126:129], v[130:133]
  s_waitcnt lgkmcnt(2)
  v_mfma_f32_16x16x32_bf16 v[134:137], a[224:227], v[126:129], v[134:137]
  v_mfma_f32_16x16x32_bf16 v[138:141], a[228:231], v[126:129], v[138:141]
  s_waitcnt lgkmcnt(0)
  v_mfma_f32_16x16x32_bf16 v[142:145], a[232:235], v[126:129], v[142:145]
  v_mfma_f32_16x16x32_bf16 v[146:149], a[236:239], v[126:129], v[146:149]
  s_barrier
  s_mul_i32 s36, s16, 20480
  s_mul_i32 s34, s17, 2560
  s_add_u32 s36, s36, s34
  s_add_u32 s36, s36, s20
  s_add_u32 s36, s36, 15863808
  s_lshl_b32 s35, s16, 10
  s_lshl_b32 s34, s17, 7
  s_add_u32 s35, s35, s34
  s_add_u32 s35, s35, s20
  s_add_u32 s35, s35, 25694208
  v_mov_b32 v182, 0
  v_mov_b32 v183, 0
  v_lshlrev_b32 v186, 16, v32
  v_and_b32 v187, 0xffff0000, v32
  v_lshlrev_b32 v188, 16, v33
  v_and_b32 v189, 0xffff0000, v33
  v_lshlrev_b32 v190, 16, v34
  v_and_b32 v191, 0xffff0000, v34
  v_lshlrev_b32 v192, 16, v35
  v_and_b32 v193, 0xffff0000, v35
  v_pk_add_f32 v[186:187], v[186:187], v[130:131]
  v_pk_add_f32 v[188:189], v[188:189], v[132:133]
  v_pk_add_f32 v[190:191], v[190:191], v[134:135]
  v_pk_add_f32 v[192:193], v[192:193], v[136:137]
  v_cvt_pk_bf16_f32 v32, v186, v187
  v_cvt_pk_bf16_f32 v33, v188, v189
  v_cvt_pk_bf16_f32 v34, v190, v191
  v_cvt_pk_bf16_f32 v35, v192, v193
  buffer_store_dwordx4 v[32:35], v2, s[4:7], s36 offen offset:0 sc1
  v_lshlrev_b32 v186, 16, v36
  v_and_b32 v187, 0xffff0000, v36
  v_lshlrev_b32 v188, 16, v37
  v_and_b32 v189, 0xffff0000, v37
  v_lshlrev_b32 v190, 16, v38
  v_and_b32 v191, 0xffff0000, v38
  v_lshlrev_b32 v192, 16, v39
  v_and_b32 v193, 0xffff0000, v39
  v_pk_add_f32 v[186:187], v[186:187], v[138:139]
  v_pk_add_f32 v[188:189], v[188:189], v[140:141]
  v_pk_add_f32 v[190:191], v[190:191], v[142:143]
  v_pk_add_f32 v[192:193], v[192:193], v[144:145]
  v_cvt_pk_bf16_f32 v36, v186, v187
  v_cvt_pk_bf16_f32 v37, v188, v189
  v_cvt_pk_bf16_f32 v38, v190, v191
  v_cvt_pk_bf16_f32 v39, v192, v193
  buffer_store_dwordx4 v[36:39], v2, s[4:7], s36 offen offset:1024 sc1
  v_lshlrev_b32 v186, 16, v40
  v_and_b32 v187, 0xffff0000, v40
  v_lshlrev_b32 v188, 16, v41
  v_and_b32 v189, 0xffff0000, v41
  v_pk_add_f32 v[186:187], v[186:187], v[146:147]
  v_pk_add_f32 v[188:189], v[188:189], v[148:149]
  v_cvt_pk_bf16_f32 v40, v186, v187
  v_cvt_pk_bf16_f32 v41, v188, v189
  buffer_store_dwordx2 v[40:41], v8, s[4:7], s36 offen offset:2048 sc1
  v_dot2_f32_bf16 v182, v32, v46, v182
  v_dot2_f32_bf16 v183, v32, v32, v183
  v_dot2_f32_bf16 v182, v33, v46, v182
  v_dot2_f32_bf16 v183, v33, v33, v183
  v_dot2_f32_bf16 v182, v34, v46, v182
  v_dot2_f32_bf16 v183, v34, v34, v183
  v_dot2_f32_bf16 v182, v35, v46, v182
  v_dot2_f32_bf16 v183, v35, v35, v183
  v_dot2_f32_bf16 v182, v36, v46, v182
  v_dot2_f32_bf16 v183, v36, v36, v183
  v_dot2_f32_bf16 v182, v37, v46, v182
  v_dot2_f32_bf16 v183, v37, v37, v183
  v_dot2_f32_bf16 v182, v38, v46, v182
  v_dot2_f32_bf16 v183, v38, v38, v183
  v_dot2_f32_bf16 v182, v39, v46, v182
  v_dot2_f32_bf16 v183, v39, v39, v183
  v_dot2_f32_bf16 v182, v40, v46, v182
  v_dot2_f32_bf16 v183, v40, v40, v183
  v_dot2_f32_bf16 v182, v41, v46, v182
  v_dot2_f32_bf16 v183, v41, v41, v183
  s_nop 1
  v_mov_b32 v184, v182
  v_mov_b32 v185, v183
  s_nop 0
  v_permlane32_swap_b32 v182, v184
  v_permlane32_swap_b32 v183, v185
  v_add_f32 v182, v182, v184
  v_add_f32 v183, v183, v185
  v_mov_b32 v184, v182
  v_mov_b32 v185, v183
  s_nop 0
  v_permlane16_swap_b32 v182, v184
  v_permlane16_swap_b32 v183, v185
  v_add_f32 v182, v182, v184
  v_add_f32 v183, v183, v185
  buffer_store_dwordx2 v[182:183], v10, s[4:7], s35 offen sc1
  s_lshr_b32 s34, s27, 4
  s_lshl_b32 s34, s34, 11
  s_and_b32 s35, s27, 15
  s_lshl_b32 s35, s35, 2
  s_add_u32 s34, s34, s35
  s_add_u32 s34, s34, s20
  s_add_u32 s34, s34, 25964544
  s_waitcnt vmcnt(0)
  s_barrier
  buffer_store_dword v25, v22, s[4:7], s34 offen offset:0 sc1
  s_add_u32 m0, s21, 81920
  s_add_u32 s33, s24, 81920
  buffer_load_dwordx4 v2, s[4:7], s33 offen offset:0 lds
  buffer_load_dwordx4 v2, s[4:7], s33 offen offset:1024 lds
  buffer_load_dwordx4 v2, s[4:7], s33 offen offset:2048 lds
  buffer_load_dwordx4 v2, s[4:7], s33 offen offset:3072 lds
  s_add_u32 m0, s21, 86016
  s_add_u32 s33, s24, 86016
  buffer_load_dwordx4 v2, s[4:7], s33 offen offset:0 lds
  s_add_u32 m0, s21, 102400
  s_add_u32 s33, s24, 102400
  buffer_load_dwordx4 v2, s[4:7], s33 offen offset:0 lds
  buffer_load_dwordx4 v2, s[4:7], s33 offen offset:1024 lds
  buffer_load_dwordx4 v2, s[4:7], s33 offen offset:2048 lds
  buffer_load_dwordx4 v2, s[4:7], s33 offen offset:3072 lds
  s_add_u32 m0, s21, 106496
  s_add_u32 s33, s24, 106496
  buffer_load_dwordx4 v2, s[4:7], s33 offen offset:0 lds
  s_mul_i32 s30, s15, 20480
  s_add_u32 s30, s30, s20
  s_add_u32 s30, s30, 15863808
  s_add_u32 s31, s30, 20480
  s_lshl_b32 s36, s15, 10
  s_add_u32 s36, s36, s20
  s_add_u32 s36, s36, 25694208
  s_lshl_b32 s35, s26, 7
  s_add_u32 s35, s35, s20
  s_add_u32 s35, s35, 25964544
  s_cmp_lg_u32 s12, 0
  s_cbranch_scc1 L_pd3
  s_mov_b32 s37, 200000
L_pl3:
  buffer_load_dword v252, v24, s[4:7], s35 offen sc1
  s_waitcnt vmcnt(0)
  v_cmp_eq_u32 vcc, 0, v252
  s_nop 1
  s_cbranch_vccz L_pd3
  s_sub_u32 s37, s37, 1
  s_cmp_lg_u32 s37, 0
  s_cbranch_scc1 L_pl3
L_pd3:
  s_barrier
  buffer_load_dwordx4 a[0:3], v2, s[4:7], s30 offen offset:0 sc1
  buffer_load_dwordx4 a[4:7], v2, s[4:7], s30 offen offset:1024 sc1
  buffer_load_dwordx4 a[80:83], v2, s[4:7], s31 offen offset:0 sc1
  buffer_load_dwordx4 a[84:87], v2, s[4:7], s31 offen offset:1024 sc1
  buffer_load_dwordx4 a[8:11], v2, s[4:7], s30 offen offset:2048 sc1
  buffer_load_dwordx4 a[12:15], v2, s[4:7], s30 offen offset:3072 sc1
  buffer_load_dwordx4 a[88:91], v2, s[4:7], s31 offen offset:2048 sc1
  buffer_load_dwordx4 a[92:95], v2, s[4:7], s31 offen offset:3072 sc1
  s_add_u32 s32, s30, 4096
  buffer_load_dwordx4 a[16:19], v2, s[4:7], s32 offen offset:0 sc1
  buffer_load_dwordx4 a[20:23], v2, s[4:7], s32 offen offset:1024 sc1
  s_add_u32 s32, s31, 4096
  buffer_load_dwordx4 a[96:99], v2, s[4:7], s32 offen offset:0 sc1
  buffer_load_dwordx4 a[100:103], v2, s[4:7], s32 offen offset:1024 sc1
  s_barrier
  ds_read_b128 a[224:227], v2 offset:0
  ds_read_b128 a[228:231], v2 offset:1024
  ds_read_b128 a[232:235], v2 offset:2048
  ds_read_b128 a[236:239], v2 offset:3072
  ds_read_b128 a[240:243], v2 offset:4096
  ds_read_b128 a[244:247], v2 offset:5120
  s_waitcnt vmcnt(8) lgkmcnt(5)
  v_mfma_f32_16x16x32_bf16 v[50:53], a[224:227], a[0:3], 0
  s_add_u32 s32, s30, 4096
  buffer_load_dwordx4 a[24:27], v2, s[4:7], s32 offen offset:2048 sc1
  v_mfma_f32_16x16x32_bf16 v[106:109], a[224:227], a[80:83], 0
  s_waitcnt lgkmcnt(4)
  ds_read_b128 a[248:251], v2 offset:6144
  v_mfma_f32_16x16x32_bf16 v[54:57], a[228:231], a[0:3], 0
  v_mfma_f32_16x16x32_bf16 v[110:113], a[228:231], a[80:83], 0
  s_waitcnt lgkmcnt(4)
  ds_read_b128 a[252:255], v2 offset:7168
  v_mfma_f32_16x16x32_bf16 v[58:61], a[232:235], a[0:3], 0
  buffer_load_dwordx4 a[28:31], v2, s[4:7], s32 offen offset:3072 sc1
  v_mfma_f32_16x16x32_bf16 v[114:117], a[232:235], a[80:83], 0
  s_waitcnt lgkmcnt(4)
  ds_read_b128 a[224:227], v2 offset:8192
  v_mfma_f32_16x16x32_bf16 v[62:65], a[236:239], a[0:3], 0
  v_mfma_f32_16x16x32_bf16 v[118:121], a[236:239], a[80:83], 0
  s_waitcnt lgkmcnt(4)
  ds_read_b128 a[228:231], v2 offset:9216
  v_mfma_f32_16x16x32_bf16 v[66:69], a[240:243], a[0:3], 0
  s_add_u32 s32, s31, 4096
  buffer_load_dwordx4 a[104:107], v2, s[4:7], s32 offen offset:2048 sc1
  v_mfma_f32_16x16x32_bf16 v[122:125], a[240:243], a[80:83], 0
  s_waitcnt lgkmcnt(4)
  ds_read_b128 a[232:235], v2 offset:10240
  v_mfma_f32_16x16x32_bf16 v[70:73], a[244:247], a[0:3], 0
  v_mfma_f32_16x16x32_bf16 v[126:129], a[244:247], a[80:83], 0
  s_waitcnt lgkmcnt(4)
  ds_read_b128 a[236:239], v2 offset:11264
  v_mfma_f32_16x16x32_bf16 v[50:53], a[248:251], a[4:7], v[50:53]
  buffer_load_dwordx4 a[108:111], v2, s[4:7], s32 offen offset:3072 sc1
  v_mfma_f32_16x16x32_bf16 v[106:109], a[248:251], a[84:87], v[106:109]
  s_waitcnt lgkmcnt(4)
  ds_read_b128 a[240:243], v2 offset:12288
  v_mfma_f32_16x16x32_bf16 v[54:57], a[252:255], a[4:7], v[54:57]
  v_mfma_f32_16x16x32_bf16 v[110:113], a[252:255], a[84:87], v[110:113]
  s_waitcnt lgkmcnt(4)
  ds_read_b128 a[244:247], v2 offset:13312
  v_mfma_f32_16x16x32_bf16 v[58:61], a[224:227], a[4:7], v[58:61]
  buffer_load_dwordx2 v[162:163], v7, s[4:7], s36 offen offset:0 sc1
  v_mfma_f32_16x16x32_bf16 v[114:117], a[224:227], a[84:87], v[114:117]
  s_waitcnt lgkmcnt(4)
  ds_read_b128 a[248:251], v2 offset:14336
  v_mfma_f32_16x16x32_bf16 v[62:65], a[228:231], a[4:7], v[62:65]
  v_mfma_f32_16x16x32_bf16 v[118:121], a[228:231], a[84:87], v[118:121]
  s_waitcnt lgkmcnt(4)
  ds_read_b128 a[252:255], v2 offset:15360
  v_mfma_f32_16x16x32_bf16 v[66:69], a[232:235], a[4:7], v[66:69]
  buffer_load_dwordx2 v[164:165], v7, s[4:7], s36 offen offset:128 sc1
  v_mfma_f32_16x16x32_bf16 v[122:125], a[232:235], a[84:87], v[122:125]
  s_waitcnt lgkmcnt(4)
  ds_read_b128 a[224:227], v2 offset:16384
  v_mfma_f32_16x16x32_bf16 v[70:73], a[236:239], a[4:7], v[70:73]
  v_mfma_f32_16x16x32_bf16 v[126:129], a[236:239], a[84:87], v[126:129]
  s_waitcnt vmcnt(10) lgkmcnt(4)
  ds_read_b128 a[228:231], v2 offset:17408
  v_mfma_f32_16x16x32_bf16 v[50:53], a[240:243], a[8:11], v[50:53]
  buffer_load_dwordx2 v[166:167], v7, s[4:7], s36 offen offset:1024 sc1
  v_mfma_f32_16x16x32_bf16 v[106:109], a[240:243], a[88:91], v[106:109]
  s_waitcnt lgkmcnt(4)
  ds_read_b128 a[232:235], v2 offset:18432
  v_mfma_f32_16x16x32_bf16 v[54:57], a[244:247], a[8:11], v[54:57]
  v_mfma_f32_16x16x32_bf16 v[110:113], a[244:247], a[88:91], v[110:113]
  s_waitcnt lgkmcnt(4)
  ds_read_b128 a[236:239], v2 offset:19456
  v_mfma_f32_16x16x32_bf16 v[58:61], a[248:251], a[8:11], v[58:61]
  s_barrier
  buffer_load_dwordx2 v[168:169], v7, s[4:7], s36 offen offset:1152 sc1
  v_mfma_f32_16x16x32_bf16 v[114:117], a[248:251], a[88:91], v[114:117]
  s_waitcnt lgkmcnt(4)
  ds_read_b128 a[240:243], v2 offset:20480
  v_mfma_f32_16x16x32_bf16 v[62:65], a[252:255], a[8:11], v[62:65]
  v_mfma_f32_16x16x32_bf16 v[118:121], a[252:255], a[88:91], v[118:121]
  s_waitcnt lgkmcnt(4)
  ds_read_b128 a[244:247], v2 offset:21504
  v_mfma_f32_16x16x32_bf16 v[66:69], a[224:227], a[8:11], v[66:69]
  s_add_u32 s32, s30, 8192
  buffer_load_dwordx4 a[32:35], v2, s[4:7], s32 offen offset:0 sc1
  v_mfma_f32_16x16x32_bf16 v[122:125], a[224:227], a[88:91], v[122:125]
  s_waitcnt lgkmcnt(4)
  ds_read_b128 a[248:251], v2 offset:22528
  v_mfma_f32_16x16x32_bf16 v[70:73], a[228:231], a[8:11], v[70:73]
  v_mfma_f32_16x16x32_bf16 v[126:129], a[228:231], a[88:91], v[126:129]
  s_waitcnt lgkmcnt(4)
  ds_read_b128 a[252:255], v2 offset:23552
  v_mfma_f32_16x16x32_bf16 v[50:53], a[232:235], a[12:15], v[50:53]
  buffer_load_dwordx4 a[36:39], v2, s[4:7], s32 offen offset:1024 sc1
  v_mfma_f32_16x16x32_bf16 v[106:109], a[232:235], a[92:95], v[106:109]
  s_waitcnt lgkmcnt(4)
  ds_read_b128 a[224:227], v2 offset:24576
  v_mfma_f32_16x16x32_bf16 v[54:57], a[236:239], a[12:15], v[54:57]
  v_mfma_f32_16x16x32_bf16 v[110:113], a[236:239], a[92:95], v[110:113]
  s_waitcnt lgkmcnt(4)
  ds_read_b128 a[228:231], v2 offset:25600
  v_mfma_f32_16x16x32_bf16 v[58:61], a[240:243], a[12:15], v[58:61]
  s_add_u32 s32, s31, 8192
  buffer_load_dwordx4 a[112:115], v2, s[4:7], s32 offen offset:0 sc1
  v_mfma_f32_16x16x32_bf16 v[114:117], a[240:243], a[92:95], v[114:117]
  s_waitcnt lgkmcnt(4)
  ds_read_b128 a[232:235], v2 offset:26624
  v_mfma_f32_16x16x32_bf16 v[62:65], a[244:247], a[12:15], v[62:65]
  v_mfma_f32_16x16x32_bf16 v[118:121], a[244:247], a[92:95], v[118:121]
  s_waitcnt lgkmcnt(4)
  ds_read_b128 a[236:239], v2 offset:27648
  v_mfma_f32_16x16x32_bf16 v[66:69], a[248:251], a[12:15], v[66:69]
  buffer_load_dwordx4 a[116:119], v2, s[4:7], s32 offen offset:1024 sc1
  v_mfma_f32_16x16x32_bf16 v[122:125], a[248:251], a[92:95], v[122:125]
  s_waitcnt lgkmcnt(4)
  ds_read_b128 a[240:243], v2 offset:28672
  v_mfma_f32_16x16x32_bf16 v[70:73], a[252:255], a[12:15], v[70:73]
  v_mfma_f32_16x16x32_bf16 v[126:129], a[252:255], a[92:95], v[126:129]
  s_waitcnt vmcnt(12) lgkmcnt(4)
  ds_read_b128 a[244:247], v2 offset:29696
  v_mfma_f32_16x16x32_bf16 v[50:53], a[224:227], a[16:19], v[50:53]
  s_add_u32 s32, s30, 8192
  buffer_load_dwordx4 a[40:43], v2, s[4:7], s32 offen offset:2048 sc1
  v_mfma_f32_16x16x32_bf16 v[106:109], a[224:227], a[96:99], v[106:109]
  s_waitcnt lgkmcnt(4)
  ds_read_b128 a[248:251], v2 offset:30720
  v_mfma_f32_16x16x32_bf16 v[54:57], a[228:231], a[16:19], v[54:57]
  v_mfma_f32_16x16x32_bf16 v[110:113], a[228:231], a[96:99], v[110:113]
  s_waitcnt lgkmcnt(4)
  ds_read_b128 a[252:255], v2 offset:31744
  v_mfma_f32_16x16x32_bf16 v[58:61], a[232:235], a[16:19], v[58:61]
  buffer_load_dwordx4 a[44:47], v2, s[4:7], s32 offen offset:3072 sc1
  v_mfma_f32_16x16x32_bf16 v[114:117], a[232:235], a[96:99], v[114:117]
  s_waitcnt lgkmcnt(4)
  ds_read_b128 a[224:227], v2 offset:32768
  v_mfma_f32_16x16x32_bf16 v[62:65], a[236:239], a[16:19], v[62:65]
  v_mfma_f32_16x16x32_bf16 v[118:121], a[236:239], a[96:99], v[118:121]
  s_waitcnt lgkmcnt(4)
  ds_read_b128 a[228:231], v2 offset:33792
  v_mfma_f32_16x16x32_bf16 v[66:69], a[240:243], a[16:19], v[66:69]
  s_add_u32 s32, s31, 8192
  buffer_load_dwordx4 a[120:123], v2, s[4:7], s32 offen offset:2048 sc1
  v_mfma_f32_16x16x32_bf16 v[122:125], a[240:243], a[96:99], v[122:125]
  s_waitcnt lgkmcnt(4)
  ds_read_b128 a[232:235], v2 offset:34816
  v_mfma_f32_16x16x32_bf16 v[70:73], a[244:247], a[16:19], v[70:73]
  v_mfma_f32_16x16x32_bf16 v[126:129], a[244:247], a[96:99], v[126:129]
  s_waitcnt lgkmcnt(4)
  ds_read_b128 a[236:239], v2 offset:35840
  v_mfma_f32_16x16x32_bf16 v[50:53], a[248:251], a[20:23], v[50:53]
  buffer_load_dwordx4 a[124:127], v2, s[4:7], s32 offen offset:3072 sc1
  v_mfma_f32_16x16x32_bf16 v[106:109], a[248:251], a[100:103], v[106:109]
  s_waitcnt lgkmcnt(4)
  ds_read_b128 a[240:243], v2 offset:36864
  v_mfma_f32_16x16x32_bf16 v[54:57], a[252:255], a[20:23], v[54:57]
  v_mfma_f32_16x16x32_bf16 v[110:113], a[252:255], a[100:103], v[110:113]
  s_waitcnt lgkmcnt(4)
  ds_read_b128 a[244:247], v2 offset:37888
  v_mfma_f32_16x16x32_bf16 v[58:61], a[224:227], a[20:23], v[58:61]
  s_add_u32 s32, s30, 12288
  buffer_load_dwordx4 a[48:51], v2, s[4:7], s32 offen offset:0 sc1
  v_mfma_f32_16x16x32_bf16 v[114:117], a[224:227], a[100:103], v[114:117]
  s_waitcnt lgkmcnt(4)
  ds_read_b128 a[248:251], v2 offset:38912
  v_mfma_f32_16x16x32_bf16 v[62:65], a[228:231], a[20:23], v[62:65]
  v_mfma_f32_16x16x32_bf16 v[118:121], a[228:231], a[100:103], v[118:121]
  s_waitcnt lgkmcnt(4)
  ds_read_b128 a[252:255], v2 offset:39936
  v_mfma_f32_16x16x32_bf16 v[66:69], a[232:235], a[20:23], v[66:69]
  s_barrier
  buffer_load_dwordx4 a[52:55], v2, s[4:7], s32 offen offset:1024 sc1
  v_mfma_f32_16x16x32_bf16 v[122:125], a[232:235], a[100:103], v[122:125]
  s_waitcnt lgkmcnt(4)
  ds_read_b128 a[224:227], v2 offset:40960
  v_mfma_f32_16x16x32_bf16 v[70:73], a[236:239], a[20:23], v[70:73]
  v_mfma_f32_16x16x32_bf16 v[126:129], a[236:239], a[100:103], v[126:129]
  s_waitcnt vmcnt(14) lgkmcnt(4)
  ds_read_b128 a[228:231], v2 offset:41984
  v_mfma_f32_16x16x32_bf16 v[50:53], a[240:243], a[24:27], v[50:53]
  s_add_u32 s32, s31, 12288
  buffer_load_dwordx4 a[128:131], v2, s[4:7], s32 offen offset:0 sc1
  v_mfma_f32_16x16x32_bf16 v[106:109], a[240:243], a[104:107], v[106:109]
  s_waitcnt lgkmcnt(4)
  ds_read_b128 a[232:235], v2 offset:43008
  v_mfma_f32_16x16x32_bf16 v[54:57], a[244:247], a[24:27], v[54:57]
  v_mfma_f32_16x16x32_bf16 v[110:113], a[244:247], a[104:107], v[110:113]
  s_waitcnt lgkmcnt(4)
  ds_read_b128 a[236:239], v2 offset:44032
  v_mfma_f32_16x16x32_bf16 v[58:61], a[248:251], a[24:27], v[58:61]
  buffer_load_dwordx4 a[132:135], v2, s[4:7], s32 offen offset:1024 sc1
  v_mfma_f32_16x16x32_bf16 v[114:117], a[248:251], a[104:107], v[114:117]
  s_waitcnt lgkmcnt(4)
  ds_read_b128 a[240:243], v2 offset:45056
  v_mfma_f32_16x16x32_bf16 v[62:65], a[252:255], a[24:27], v[62:65]
  v_mfma_f32_16x16x32_bf16 v[118:121], a[252:255], a[104:107], v[118:121]
  s_waitcnt lgkmcnt(4)
  ds_read_b128 a[244:247], v2 offset:46080
  v_mfma_f32_16x16x32_bf16 v[66:69], a[224:227], a[24:27], v[66:69]
  s_add_u32 s32, s30, 12288
  buffer_load_dwordx4 a[56:59], v2, s[4:7], s32 offen offset:2048 sc1
  v_mfma_f32_16x16x32_bf16 v[122:125], a[224:227], a[104:107], v[122:125]
  s_waitcnt lgkmcnt(4)
  ds_read_b128 a[248:251], v2 offset:47104
  v_mfma_f32_16x16x32_bf16 v[70:73], a[228:231], a[24:27], v[70:73]
  v_mfma_f32_16x16x32_bf16 v[126:129], a[228:231], a[104:107], v[126:129]
  s_waitcnt lgkmcnt(4)
  ds_read_b128 a[252:255], v2 offset:48128
  v_mfma_f32_16x16x32_bf16 v[50:53], a[232:235], a[28:31], v[50:53]
  buffer_load_dwordx4 a[60:63], v2, s[4:7], s32 offen offset:3072 sc1
  v_mfma_f32_16x16x32_bf16 v[106:109], a[232:235], a[108:111], v[106:109]
  s_waitcnt lgkmcnt(4)
  ds_read_b128 a[224:227], v2 offset:49152
  v_mfma_f32_16x16x32_bf16 v[54:57], a[236:239], a[28:31], v[54:57]
  v_mfma_f32_16x16x32_bf16 v[110:113], a[236:239], a[108:111], v[110:113]
  s_waitcnt lgkmcnt(4)
  ds_read_b128 a[228:231], v2 offset:50176
  v_mfma_f32_16x16x32_bf16 v[58:61], a[240:243], a[28:31], v[58:61]
  s_add_u32 s32, s31, 12288
  buffer_load_dwordx4 a[136:139], v2, s[4:7], s32 offen offset:2048 sc1
  v_mfma_f32_16x16x32_bf16 v[114:117], a[240:243], a[108:111], v[114:117]
  s_waitcnt lgkmcnt(4)
  ds_read_b128 a[232:235], v2 offset:51200
  v_mfma_f32_16x16x32_bf16 v[62:65], a[244:247], a[28:31], v[62:65]
  v_mfma_f32_16x16x32_bf16 v[118:121], a[244:247], a[108:111], v[118:121]
  s_waitcnt lgkmcnt(4)
  ds_read_b128 a[236:239], v2 offset:52224
  v_mfma_f32_16x16x32_bf16 v[66:69], a[248:251], a[28:31], v[66:69]
  buffer_load_dwordx4 a[140:143], v2, s[4:7], s32 offen offset:3072 sc1
  v_mfma_f32_16x16x32_bf16 v[122:125], a[248:251], a[108:111], v[122:125]
  s_waitcnt lgkmcnt(4)
  ds_read_b128 a[240:243], v2 offset:53248
  v_mfma_f32_16x16x32_bf16 v[70:73], a[252:255], a[28:31], v[70:73]
  v_mfma_f32_16x16x32_bf16 v[126:129], a[252:255], a[108:111], v[126:129]
  s_waitcnt vmcnt(12) lgkmcnt(4)
  ds_read_b128 a[244:247], v2 offset:54272
  v_mfma_f32_16x16x32_bf16 v[50:53], a[224:227], a[32:35], v[50:53]
  s_add_u32 s32, s30, 16384
  buffer_load_dwordx4 a[64:67], v2, s[4:7], s32 offen offset:0 sc1
  v_mfma_f32_16x16x32_bf16 v[106:109], a[224:227], a[112:115], v[106:109]
  s_waitcnt lgkmcnt(4)
  ds_read_b128 a[248:251], v2 offset:55296
  v_mfma_f32_16x16x32_bf16 v[54:57], a[228:231], a[32:35], v[54:57]
  v_mfma_f32_16x16x32_bf16 v[110:113], a[228:231], a[112:115], v[110:113]
  s_waitcnt lgkmcnt(4)
  ds_read_b128 a[252:255], v2 offset:56320
  v_mfma_f32_16x16x32_bf16 v[58:61], a[232:235], a[32:35], v[58:61]
  buffer_load_dwordx4 a[68:71], v2, s[4:7], s32 offen offset:1024 sc1
  v_mfma_f32_16x16x32_bf16 v[114:117], a[232:235], a[112:115], v[114:117]
  s_waitcnt lgkmcnt(4)
  ds_read_b128 a[224:227], v2 offset:57344
  v_mfma_f32_16x16x32_bf16 v[62:65], a[236:239], a[32:35], v[62:65]
  v_mfma_f32_16x16x32_bf16 v[118:121], a[236:239], a[112:115], v[118:121]
  s_waitcnt lgkmcnt(4)
  ds_read_b128 a[228:231], v2 offset:58368
  v_mfma_f32_16x16x32_bf16 v[66:69], a[240:243], a[32:35], v[66:69]
  s_add_u32 s32, s31, 16384
  buffer_load_dwordx4 a[144:147], v2, s[4:7], s32 offen offset:0 sc1
  v_mfma_f32_16x16x32_bf16 v[122:125], a[240:243], a[112:115], v[122:125]
  s_waitcnt lgkmcnt(4)
  ds_read_b128 a[232:235], v2 offset:59392
  v_mfma_f32_16x16x32_bf16 v[70:73], a[244:247], a[32:35], v[70:73]
  v_mfma_f32_16x16x32_bf16 v[126:129], a[244:247], a[112:115], v[126:129]
  s_waitcnt lgkmcnt(4)
  ds_read_b128 a[236:239], v2 offset:60416
  v_mfma_f32_16x16x32_bf16 v[50:53], a[248:251], a[36:39], v[50:53]
  s_barrier
  buffer_load_dwordx4 a[148:151], v2, s[4:7], s32 offen offset:1024 sc1
  v_mfma_f32_16x16x32_bf16 v[106:109], a[248:251], a[116:119], v[106:109]
  s_waitcnt lgkmcnt(4)
  ds_read_b128 a[240:243], v2 offset:61440
  v_mfma_f32_16x16x32_bf16 v[54:57], a[252:255], a[36:39], v[54:57]
  v_mfma_f32_16x16x32_bf16 v[110:113], a[252:255], a[116:119], v[110:113]
  s_waitcnt lgkmcnt(4)
  ds_read_b128 a[244:247], v2 offset:62464
  v_mfma_f32_16x16x32_bf16 v[58:61], a[224:227], a[36:39], v[58:61]
  s_add_u32 s32, s30, 16384
  buffer_load_dwordx4 a[72:75], v2, s[4:7], s32 offen offset:2048 sc1
  v_mfma_f32_16x16x32_bf16 v[114:117], a[224:227], a[116:119], v[114:117]
  s_waitcnt lgkmcnt(4)
  ds_read_b128 a[248:251], v2 offset:63488
  v_mfma_f32_16x16x32_bf16 v[62:65], a[228:231], a[36:39], v[62:65]
  v_mfma_f32_16x16x32_bf16 v[118:121], a[228:231], a[116:119], v[118:121]
  s_waitcnt lgkmcnt(4)
  ds_read_b128 a[252:255], v2 offset:64512
  v_mfma_f32_16x16x32_bf16 v[66:69], a[232:235], a[36:39], v[66:69]
  buffer_load_dwordx4 a[76:79], v2, s[4:7], s32 offen offset:3072 sc1
  v_mfma_f32_16x16x32_bf16 v[122:125], a[232:235], a[116:119], v[122:125]
  s_waitcnt lgkmcnt(4)
  ds_read_b128 a[224:227], v3 offset:0
  v_mfma_f32_16x16x32_bf16 v[70:73], a[236:239], a[36:39], v[70:73]
  v_mfma_f32_16x16x32_bf16 v[126:129], a[236:239], a[116:119], v[126:129]
  s_waitcnt vmcnt(14) lgkmcnt(4)
  ds_read_b128 a[228:231], v3 offset:1024
  v_mfma_f32_16x16x32_bf16 v[50:53], a[240:243], a[40:43], v[50:53]
  s_add_u32 s32, s31, 16384
  buffer_load_dwordx4 a[152:155], v2, s[4:7], s32 offen offset:2048 sc1
  v_mfma_f32_16x16x32_bf16 v[106:109], a[240:243], a[120:123], v[106:109]
  s_waitcnt lgkmcnt(4)
  ds_read_b128 a[232:235], v3 offset:2048
  v_mfma_f32_16x16x32_bf16 v[54:57], a[244:247], a[40:43], v[54:57]
  v_mfma_f32_16x16x32_bf16 v[110:113], a[244:247], a[120:123], v[110:113]
  s_waitcnt lgkmcnt(4)
  ds_read_b128 a[236:239], v3 offset:3072
  v_mfma_f32_16x16x32_bf16 v[58:61], a[248:251], a[40:43], v[58:61]
  buffer_load_dwordx4 a[156:159], v2, s[4:7], s32 offen offset:3072 sc1
  v_mfma_f32_16x16x32_bf16 v[114:117], a[248:251], a[120:123], v[114:117]
  s_waitcnt lgkmcnt(4)
  ds_read_b128 a[240:243], v3 offset:4096
  v_mfma_f32_16x16x32_bf16 v[62:65], a[252:255], a[40:43], v[62:65]
  v_mfma_f32_16x16x32_bf16 v[118:121], a[252:255], a[120:123], v[118:121]
  s_waitcnt lgkmcnt(4)
  ds_read_b128 a[244:247], v3 offset:5120
  v_mfma_f32_16x16x32_bf16 v[66:69], a[224:227], a[40:43], v[66:69]
  s_add_u32 m0, s21, 122880
  v_mfma_f32_16x16x32_bf16 v[122:125], a[224:227], a[120:123], v[122:125]
  s_waitcnt lgkmcnt(4)
  ds_read_b128 a[248:251], v3 offset:6144
  v_mfma_f32_16x16x32_bf16 v[70:73], a[228:231], a[40:43], v[70:73]
  s_add_u32 s33, s24, 122880
  buffer_load_dwordx4 v2, s[4:7], s33 offen offset:0 lds
  v_mfma_f32_16x16x32_bf16 v[126:129], a[228:231], a[120:123], v[126:129]
  s_waitcnt lgkmcnt(4)
  ds_read_b128 a[252:255], v3 offset:7168
  v_mfma_f32_16x16x32_bf16 v[50:53], a[232:235], a[44:47], v[50:53]
  v_add_f32 v162, v162, v164
  v_add_f32 v163, v163, v165
  v_mfma_f32_16x16x32_bf16 v[106:109], a[232:235], a[124:127], v[106:109]
  s_waitcnt lgkmcnt(4)
  ds_read_b128 a[224:227], v3 offset:8192
  v_mov_b32 v184, v162
  v_mfma_f32_16x16x32_bf16 v[54:57], a[236:239], a[44:47], v[54:57]
  buffer_load_dwordx4 v2, s[4:7], s33 offen offset:1024 lds
  v_mfma_f32_16x16x32_bf16 v[110:113], a[236:239], a[124:127], v[110:113]
  s_waitcnt lgkmcnt(4)
  ds_read_b128 a[228:231], v3 offset:9216
  v_permlane32_swap_b32 v162, v184
  v_mfma_f32_16x16x32_bf16 v[58:61], a[240:243], a[44:47], v[58:61]
  v_add_f32 v162, v162, v184
  v_mov_b32 v184, v162
  v_mfma_f32_16x16x32_bf16 v[114:117], a[240:243], a[124:127], v[114:117]
  s_waitcnt lgkmcnt(4)
  ds_read_b128 a[232:235], v3 offset:10240
  v_permlane16_swap_b32 v162, v184
  v_mfma_f32_16x16x32_bf16 v[62:65], a[244:247], a[44:47], v[62:65]
  buffer_load_dwordx4 v2, s[4:7], s33 offen offset:2048 lds
  v_mfma_f32_16x16x32_bf16 v[118:121], a[244:247], a[124:127], v[118:121]
  s_waitcnt lgkmcnt(4)
  ds_read_b128 a[236:239], v3 offset:11264
  v_add_f32 v162, v162, v184
  v_mfma_f32_16x16x32_bf16 v[66:69], a[248:251], a[44:47], v[66:69]
  v_mov_b32 v185, v163
  s_nop 1
  v_permlane32_swap_b32 v163, v185
  v_mfma_f32_16x16x32_bf16 v[122:125], a[248:251], a[124:127], v[122:125]
  s_waitcnt lgkmcnt(4)
  ds_read_b128 a[240:243], v3 offset:12288
  v_add_f32 v163, v163, v185
  v_mfma_f32_16x16x32_bf16 v[70:73], a[252:255], a[44:47], v[70:73]
  buffer_load_dwordx4 v2, s[4:7], s33 offen offset:3072 lds
  v_mfma_f32_16x16x32_bf16 v[126:129], a[252:255], a[124:127], v[126:129]
  s_waitcnt vmcnt(16) lgkmcnt(4)
  ds_read_b128 a[244:247], v3 offset:13312
  v_mov_b32 v185, v163
  v_mfma_f32_16x16x32_bf16 v[50:53], a[224:227], a[48:51], v[50:53]
  s_nop 0
  v_permlane16_swap_b32 v163, v185
  v_add_f32 v163, v163, v185
  v_mfma_f32_16x16x32_bf16 v[106:109], a[224:227], a[128:131], v[106:109]
  s_waitcnt lgkmcnt(4)
  ds_read_b128 a[248:251], v3 offset:14336
  v_mul_f32 v162, 0xbacccccd, v162
  v_mfma_f32_16x16x32_bf16 v[54:57], a[228:231], a[48:51], v[54:57]
  s_add_u32 m0, s21, 126976
  v_mul_f32 v163, 0x3acccccd, v163
  v_fma_f32 v163, -v162, v162, v163
  v_mfma_f32_16x16x32_bf16 v[110:113], a[228:231], a[128:131], v[110:113]
  s_waitcnt lgkmcnt(4)
  ds_read_b128 a[252:255], v3 offset:15360
  v_max_f32 v163, 0, v163
  v_mfma_f32_16x16x32_bf16 v[58:61], a[232:235], a[48:51], v[58:61]
  s_barrier
  v_add_f32 v163, 0x3727c5ac, v163
  v_mfma_f32_16x16x32_bf16 v[114:117], a[232:235], a[128:131], v[114:117]
  s_waitcnt lgkmcnt(4)
  ds_read_b128 a[224:227], v3 offset:16384
  v_cvt_pk_bf16_f32 v184, v162, v162
  v_mfma_f32_16x16x32_bf16 v[62:65], a[236:239], a[48:51], v[62:65]
  s_add_u32 s33, s24, 126976
  buffer_load_dwordx4 v2, s[4:7], s33 offen offset:0 lds
  v_mfma_f32_16x16x32_bf16 v[118:121], a[236:239], a[128:131], v[118:121]
  s_waitcnt lgkmcnt(4)
  ds_read_b128 a[228:231], v3 offset:17408
  v_and_b32 v184, 0xffff0000, v184
  v_mfma_f32_16x16x32_bf16 v[66:69], a[240:243], a[48:51], v[66:69]
  v_rsq_f32 v170, v163
  v_mfma_f32_16x16x32_bf16 v[122:125], a[240:243], a[128:131], v[122:125]
  s_waitcnt lgkmcnt(4)
  ds_read_b128 a[232:235], v3 offset:18432
  v_mul_f32 v172, v163, v170
  v_mfma_f32_16x16x32_bf16 v[70:73], a[244:247], a[48:51], v[70:73]
  s_add_u32 m0, s21, 143360
  v_sub_f32 v164, v162, v184
  v_cvt_pk_bf16_f32 v176, v162, v164
  v_mfma_f32_16x16x32_bf16 v[126:129], a[244:247], a[128:131], v[126:129]
  s_waitcnt lgkmcnt(4)
  ds_read_b128 a[236:239], v3 offset:19456
  v_and_b32 v184, 0xffff0000, v176
  v_mfma_f32_16x16x32_bf16 v[50:53], a[248:251], a[52:55], v[50:53]
  s_add_u32 s33, s24, 143360
  buffer_load_dwordx4 v2, s[4:7], s33 offen offset:0 lds
  v_mfma_f32_16x16x32_bf16 v[106:109], a[248:251], a[132:135], v[106:109]
  s_waitcnt lgkmcnt(4)
  ds_read_b128 a[240:243], v3 offset:20480
  v_sub_f32 v165, v164, v184
  v_mfma_f32_16x16x32_bf16 v[54:57], a[252:255], a[52:55], v[54:57]
  v_mov_b32 v177, v176
  v_cvt_pk_bf16_f32 v178, v162, v165
  v_mfma_f32_16x16x32_bf16 v[110:113], a[252:255], a[132:135], v[110:113]
  s_waitcnt lgkmcnt(4)
  ds_read_b128 a[244:247], v3 offset:21504
  v_mov_b32 v179, 0
  v_mfma_f32_16x16x32_bf16 v[58:61], a[224:227], a[52:55], v[58:61]
  buffer_load_dwordx4 v2, s[4:7], s33 offen offset:1024 lds
  v_mfma_f32_16x16x32_bf16 v[114:117], a[224:227], a[132:135], v[114:117]
  s_waitcnt lgkmcnt(4)
  ds_read_b128 a[248:251], v3 offset:22528
  v_mul_f32 v174, 0xbfb8aa3b, v170
  v_mfma_f32_16x16x32_bf16 v[62:65], a[228:231], a[52:55], v[62:65]
  v_add_f32 v166, v166, v168
  v_add_f32 v167, v167, v169
  v_mfma_f32_16x16x32_bf16 v[118:121], a[228:231], a[132:135], v[118:121]
  s_waitcnt lgkmcnt(4)
  ds_read_b128 a[252:255], v3 offset:23552
  v_mov_b32 v184, v166
  v_mfma_f32_16x16x32_bf16 v[66:69], a[232:235], a[52:55], v[66:69]
  buffer_load_dwordx4 v2, s[4:7], s33 offen offset:2048 lds
  v_mfma_f32_16x16x32_bf16 v[122:125], a[232:235], a[132:135], v[122:125]
  s_waitcnt lgkmcnt(4)
  ds_read_b128 a[224:227], v3 offset:24576
  v_permlane32_swap_b32 v166, v184
  v_mfma_f32_16x16x32_bf16 v[70:73], a[236:239], a[52:55], v[70:73]
  v_add_f32 v166, v166, v184
  v_mov_b32 v184, v166
  v_mfma_f32_16x16x32_bf16 v[126:129], a[236:239], a[132:135], v[126:129]
  s_waitcnt vmcnt(16) lgkmcnt(4)
  ds_read_b128 a[228:231], v3 offset:25600
  v_permlane16_swap_b32 v166, v184
  v_mfma_f32_16x16x32_bf16 v[50:53], a[240:243], a[56:59], v[50:53]
  buffer_load_dwordx4 v2, s[4:7], s33 offen offset:3072 lds
  v_mfma_f32_16x16x32_bf16 v[106:109], a[240:243], a[136:139], v[106:109]
  s_waitcnt lgkmcnt(4)
  ds_read_b128 a[232:235], v3 offset:26624
  v_add_f32 v166, v166, v184
  v_mfma_f32_16x16x32_bf16 v[54:57], a[244:247], a[56:59], v[54:57]
  v_mov_b32 v185, v167
  s_nop 1
  v_permlane32_swap_b32 v167, v185
  v_mfma_f32_16x16x32_bf16 v[110:113], a[244:247], a[136:139], v[110:113]
  s_waitcnt lgkmcnt(4)
  ds_read_b128 a[236:239], v3 offset:27648
  v_add_f32 v167, v167, v185
  v_mfma_f32_16x16x32_bf16 v[58:61], a[248:251], a[56:59], v[58:61]
  s_add_u32 m0, s21, 147456
  v_mov_b32 v185, v167
  s_nop 1
  v_permlane16_swap_b32 v167, v185
  v_mfma_f32_16x16x32_bf16 v[114:117], a[248:251], a[136:139], v[114:117]
  s_waitcnt lgkmcnt(4)
  ds_read_b128 a[240:243], v3 offset:28672
  v_add_f32 v167, v167, v185
  v_mfma_f32_16x16x32_bf16 v[62:65], a[252:255], a[56:59], v[62:65]
  s_add_u32 s33, s24, 147456
  buffer_load_dwordx4 v2, s[4:7], s33 offen offset:0 lds
  v_mfma_f32_16x16x32_bf16 v[118:121], a[252:255], a[136:139], v[118:121]
  s_waitcnt lgkmcnt(4)
  ds_read_b128 a[244:247], v3 offset:29696
  v_mul_f32 v166, 0xbacccccd, v166
  v_mfma_f32_16x16x32_bf16 v[66:69], a[224:227], a[56:59], v[66:69]
  v_mul_f32 v167, 0x3acccccd, v167
  v_fma_f32 v167, -v166, v166, v167
  v_mfma_f32_16x16x32_bf16 v[122:125], a[224:227], a[136:139], v[122:125]
  s_waitcnt lgkmcnt(4)
  ds_read_b128 a[248:251], v3 offset:30720
  v_max_f32 v167, 0, v167
  v_mfma_f32_16x16x32_bf16 v[70:73], a[228:231], a[56:59], v[70:73]
  s_add_u32 m0, s21, 0
  v_add_f32 v167, 0x3727c5ac, v167
  v_cvt_pk_bf16_f32 v184, v166, v166
  v_mfma_f32_16x16x32_bf16 v[126:129], a[228:231], a[136:139], v[126:129]
  s_waitcnt lgkmcnt(4)
  ds_read_b128 a[252:255], v3 offset:31744
  v_and_b32 v184, 0xffff0000, v184
  v_mfma_f32_16x16x32_bf16 v[50:53], a[232:235], a[60:63], v[50:53]
  s_add_u32 s33, s24, 163840
  buffer_load_dwordx4 v2, s[4:7], s33 offen offset:0 lds
  v_mfma_f32_16x16x32_bf16 v[106:109], a[232:235], a[140:143], v[106:109]
  s_waitcnt lgkmcnt(4)
  ds_read_b128 a[224:227], v3 offset:32768
  v_sub_f32 v168, v166, v184
  v_mfma_f32_16x16x32_bf16 v[54:57], a[236:239], a[60:63], v[54:57]
  v_rsq_f32 v171, v167
  v_mfma_f32_16x16x32_bf16 v[110:113], a[236:239], a[140:143], v[110:113]
  s_waitcnt lgkmcnt(4)
  ds_read_b128 a[228:231], v3 offset:33792
  v_mul_f32 v173, v167, v171
  v_mfma_f32_16x16x32_bf16 v[58:61], a[240:243], a[60:63], v[58:61]
  buffer_load_dwordx4 v2, s[4:7], s33 offen offset:1024 lds
  v_mfma_f32_16x16x32_bf16 v[114:117], a[240:243], a[140:143], v[114:117]
  s_waitcnt lgkmcnt(4)
  ds_read_b128 a[232:235], v3 offset:34816
  v_cvt_pk_bf16_f32 v180, v166, v168
  v_mfma_f32_16x16x32_bf16 v[62:65], a[244:247], a[60:63], v[62:65]
  v_and_b32 v184, 0xffff0000, v180
  v_sub_f32 v169, v168, v184
  v_mfma_f32_16x16x32_bf16 v[118:121], a[244:247], a[140:143], v[118:121]
  s_waitcnt lgkmcnt(4)
  ds_read_b128 a[236:239], v3 offset:35840
  v_mov_b32 v181, v180
  v_mfma_f32_16x16x32_bf16 v[66:69], a[248:251], a[60:63], v[66:69]
  s_barrier
  buffer_load_dwordx4 v2, s[4:7], s33 offen offset:2048 lds
  v_mfma_f32_16x16x32_bf16 v[122:125], a[248:251], a[140:143], v[122:125]
  s_waitcnt lgkmcnt(4)
  ds_read_b128 a[240:243], v3 offset:36864
  v_cvt_pk_bf16_f32 v182, v166, v169
  v_mfma_f32_16x16x32_bf16 v[70:73], a[252:255], a[60:63], v[70:73]
  v_mov_b32 v183, 0
  v_mul_f32 v175, 0xbfb8aa3b, v171
  v_mfma_f32_16x16x32_bf16 v[126:129], a[252:255], a[140:143], v[126:129]
  s_waitcnt vmcnt(17) lgkmcnt(4)
  ds_read_b128 a[244:247], v3 offset:37888
  s_lshl_b32 s34, s14, 11
  v_mfma_f32_16x16x32_bf16 v[50:53], a[224:227], a[64:67], v[50:53]
  s_mul_i32 s36, s15, 55296
  buffer_load_dwordx4 v2, s[4:7], s33 offen offset:3072 lds
  v_mfma_f32_16x16x32_bf16 v[106:109], a[224:227], a[144:147], v[106:109]
  s_waitcnt lgkmcnt(4)
  ds_read_b128 a[248:251], v3 offset:38912
  s_add_u32 s36, s36, s34
  v_mfma_f32_16x16x32_bf16 v[54:57], a[228:231], a[64:67], v[54:57]
  s_add_u32 s36, s36, s20
  s_add_u32 s36, s36, 18485248
  s_add_u32 s61, s36, 55296
  v_mfma_f32_16x16x32_bf16 v[110:113], a[228:231], a[144:147], v[110:113]
  s_waitcnt lgkmcnt(4)
  ds_read_b128 a[252:255], v3 offset:39936
  s_lshl_b32 s34, s14, 10
  v_mfma_f32_16x16x32_bf16 v[58:61], a[232:235], a[64:67], v[58:61]
  s_add_u32 m0, s21, 4096
  s_sub_u32 s62, 32768, s34
  v_mfma_f32_16x16x32_bf16 v[114:117], a[232:235], a[144:147], v[114:117]
  s_waitcnt lgkmcnt(4)
  ds_read_b128 a[224:227], v3 offset:40960
  v_mfma_f32_16x16x32_bf16 v[62:65], a[236:239], a[64:67], v[62:65]
  s_add_u32 s33, s24, 167936
  buffer_load_dwordx4 v2, s[4:7], s33 offen offset:0 lds
  v_mfma_f32_16x16x32_bf16 v[118:121], a[236:239], a[144:147], v[118:121]
  s_waitcnt lgkmcnt(4)
  ds_read_b128 a[228:231], v3 offset:41984
  v_mfma_f32_16x16x32_bf16 v[66:69], a[240:243], a[64:67], v[66:69]
  v_mfma_f32_16x16x32_bf16 v[122:125], a[240:243], a[144:147], v[122:125]
  s_waitcnt lgkmcnt(4)
  ds_read_b128 a[232:235], v3 offset:43008
  v_mfma_f32_16x16x32_bf16 v[70:73], a[244:247], a[64:67], v[70:73]
  s_add_u32 m0, s21, 20480
  v_mfma_f32_16x16x32_bf16 v[126:129], a[244:247], a[144:147], v[126:129]
  s_waitcnt lgkmcnt(4)
  ds_read_b128 a[236:239], v3 offset:44032
  v_mfma_f32_16x16x32_bf16 v[50:53], a[248:251], a[68:71], v[50:53]
  s_add_u32 s33, s24, 184320
  buffer_load_dwordx4 v2, s[4:7], s33 offen offset:0 lds
  v_mfma_f32_16x16x32_bf16 v[106:109], a[248:251], a[148:151], v[106:109]
  s_waitcnt lgkmcnt(4)
  ds_read_b128 a[240:243], v3 offset:45056
  v_mfma_f32_16x16x32_bf16 v[54:57], a[252:255], a[68:71], v[54:57]
  v_mfma_f32_16x16x32_bf16 v[110:113], a[252:255], a[148:151], v[110:113]
  s_waitcnt lgkmcnt(4)
  ds_read_b128 a[244:247], v3 offset:46080
  v_mfma_f32_16x16x32_bf16 v[58:61], a[224:227], a[68:71], v[58:61]
  buffer_load_dwordx4 v2, s[4:7], s33 offen offset:1024 lds
  v_mfma_f32_16x16x32_bf16 v[114:117], a[224:227], a[148:151], v[114:117]
  s_waitcnt lgkmcnt(4)
  ds_read_b128 a[248:251], v3 offset:47104
  v_mfma_f32_16x16x32_bf16 v[62:65], a[228:231], a[68:71], v[62:65]
  v_mfma_f32_16x16x32_bf16 v[118:121], a[228:231], a[148:151], v[118:121]
  s_waitcnt lgkmcnt(4)
  ds_read_b128 a[252:255], v3 offset:48128
  v_mfma_f32_16x16x32_bf16 v[66:69], a[232:235], a[68:71], v[66:69]
  buffer_load_dwordx4 v2, s[4:7], s33 offen offset:2048 lds
  v_mfma_f32_16x16x32_bf16 v[122:125], a[232:235], a[148:151], v[122:125]
  s_waitcnt lgkmcnt(4)
  ds_read_b128 a[224:227], v3 offset:49152
  v_mfma_f32_16x16x32_bf16 v[70:73], a[236:239], a[68:71], v[70:73]
  v_mfma_f32_16x16x32_bf16 v[126:129], a[236:239], a[148:151], v[126:129]
  s_waitcnt vmcnt(18) lgkmcnt(4)
  ds_read_b128 a[228:231], v3 offset:50176
  v_mfma_f32_16x16x32_bf16 v[50:53], a[240:243], a[72:75], v[50:53]
  buffer_load_dwordx4 v2, s[4:7], s33 offen offset:3072 lds
  v_mfma_f32_16x16x32_bf16 v[106:109], a[240:243], a[152:155], v[106:109]
  s_waitcnt lgkmcnt(4)
  ds_read_b128 a[232:235], v3 offset:51200
  v_mfma_f32_16x16x32_bf16 v[54:57], a[244:247], a[72:75], v[54:57]
  v_mfma_f32_16x16x32_bf16 v[110:113], a[244:247], a[152:155], v[110:113]
  s_waitcnt lgkmcnt(4)
  ds_read_b128 a[236:239], v3 offset:52224
  v_mfma_f32_16x16x32_bf16 v[58:61], a[248:251], a[72:75], v[58:61]
  s_add_u32 m0, s21, 24576
  v_mfma_f32_16x16x32_bf16 v[114:117], a[248:251], a[152:155], v[114:117]
  s_waitcnt lgkmcnt(4)
  ds_read_b128 a[240:243], v3 offset:53248
  v_mfma_f32_16x16x32_bf16 v[62:65], a[252:255], a[72:75], v[62:65]
  s_add_u32 s33, s24, 188416
  buffer_load_dwordx4 v2, s[4:7], s33 offen offset:0 lds
  v_mfma_f32_16x16x32_bf16 v[118:121], a[252:255], a[152:155], v[118:121]
  s_waitcnt lgkmcnt(4)
  ds_read_b128 a[244:247], v3 offset:54272
  v_mfma_f32_16x16x32_bf16 v[66:69], a[224:227], a[72:75], v[66:69]
  v_mfma_f32_16x16x32_bf16 v[122:125], a[224:227], a[152:155], v[122:125]
  s_waitcnt lgkmcnt(4)
  ds_read_b128 a[248:251], v3 offset:55296
  v_mfma_f32_16x16x32_bf16 v[70:73], a[228:231], a[72:75], v[70:73]
  s_add_u32 m0, s21, 40960
  v_mfma_f32_16x16x32_bf16 v[126:129], a[228:231], a[152:155], v[126:129]
  s_waitcnt lgkmcnt(4)
  ds_read_b128 a[252:255], v3 offset:56320
  v_mfma_f32_16x16x32_bf16 v[50:53], a[232:235], a[76:79], v[50:53]
  s_waitcnt vmcnt(15)
  s_barrier
  v_mfma_f32_16x16x32_bf16 v[106:109], a[232:235], a[156:159], v[106:109]
  s_waitcnt lgkmcnt(4)
  ds_read_b128 a[224:227], v3 offset:57344
  v_mfma_f32_16x16x32_bf16 v[54:57], a[236:239], a[76:79], v[54:57]
  s_add_u32 s33, s24, 204800
  buffer_load_dwordx4 v2, s[4:7], s33 offen offset:0 lds
  v_mfma_f32_16x16x32_bf16 v[110:113], a[236:239], a[156:159], v[110:113]
  s_waitcnt lgkmcnt(4)
  ds_read_b128 a[228:231], v3 offset:58368
  v_mfma_f32_16x16x32_bf16 v[58:61], a[240:243], a[76:79], v[58:61]
  v_mfma_f32_16x16x32_bf16 v[114:117], a[240:243], a[156:159], v[114:117]
  s_waitcnt lgkmcnt(4)
  ds_read_b128 a[232:235], v3 offset:59392
  v_mfma_f32_16x16x32_bf16 v[62:65], a[244:247], a[76:79], v[62:65]
  buffer_load_dwordx4 v2, s[4:7], s33 offen offset:1024 lds
  v_mfma_f32_16x16x32_bf16 v[118:121], a[244:247], a[156:159], v[118:121]
  s_waitcnt lgkmcnt(4)
  ds_read_b128 a[236:239], v3 offset:60416
  v_mfma_f32_16x16x32_bf16 v[66:69], a[248:251], a[76:79], v[66:69]
  v_mfma_f32_16x16x32_bf16 v[122:125], a[248:251], a[156:159], v[122:125]
  s_waitcnt lgkmcnt(4)
  ds_read_b128 a[240:243], v3 offset:61440
  v_mfma_f32_16x16x32_bf16 v[70:73], a[252:255], a[76:79], v[70:73]
  buffer_load_dwordx4 v2, s[4:7], s33 offen offset:2048 lds
  v_mfma_f32_16x16x32_bf16 v[126:129], a[252:255], a[156:159], v[126:129]
  s_waitcnt lgkmcnt(4)
  ds_read_b128 a[244:247], v3 offset:62464
  v_mfma_f32_16x16x32_bf16 v[50:53], a[224:227], v[176:179], v[50:53]
  v_mfma_f32_16x16x32_bf16 v[106:109], a[224:227], v[180:183], v[106:109]
  s_waitcnt lgkmcnt(4)
  ds_read_b128 a[248:251], v3 offset:63488
  v_mfma_f32_16x16x32_bf16 v[54:57], a[228:231], v[176:179], v[54:57]
  buffer_load_dwordx4 v2, s[4:7], s33 offen offset:3072 lds
  v_mfma_f32_16x16x32_bf16 v[110:113], a[228:231], v[180:183], v[110:113]
  s_waitcnt lgkmcnt(4)
  ds_read_b128 a[252:255], v3 offset:64512
  v_mfma_f32_16x16x32_bf16 v[58:61], a[232:235], v[176:179], v[58:61]
  v_mfma_f32_16x16x32_bf16 v[114:117], a[232:235], v[180:183], v[114:117]
  s_waitcnt lgkmcnt(4)
  ds_read_b128 a[224:227], v4 offset:0
  v_mfma_f32_16x16x32_bf16 v[62:65], a[236:239], v[176:179], v[62:65]
  s_add_u32 m0, s21, 45056
  v_mfma_f32_16x16x32_bf16 v[118:121], a[236:239], v[180:183], v[118:121]
  s_waitcnt lgkmcnt(4)
  ds_read_b128 a[228:231], v4 offset:1024
  v_mfma_f32_16x16x32_bf16 v[66:69], a[240:243], v[176:179], v[66:69]
  s_add_u32 s33, s24, 208896
  buffer_load_dwordx4 v2, s[4:7], s33 offen offset:0 lds
  v_mfma_f32_16x16x32_bf16 v[122:125], a[240:243], v[180:183], v[122:125]
  s_waitcnt lgkmcnt(4)
  ds_read_b128 a[232:235], v4 offset:2048
  v_mfma_f32_16x16x32_bf16 v[70:73], a[244:247], v[176:179], v[70:73]
  v_mfma_f32_16x16x32_bf16 v[126:129], a[244:247], v[180:183], v[126:129]
  s_waitcnt lgkmcnt(4)
  ds_read_b128 a[236:239], v4 offset:3072
  v_mfma_f32_16x16x32_bf16 v[74:77], a[248:251], a[0:3], 0
  s_add_u32 m0, s21, 61440
  v_mfma_f32_16x16x32_bf16 v[130:133], a[248:251], a[80:83], 0
  s_waitcnt lgkmcnt(4)
  ds_read_b128 a[240:243], v4 offset:4096
  v_mfma_f32_16x16x32_bf16 v[78:81], a[252:255], a[0:3], 0
  s_add_u32 s33, s24, 225280
  buffer_load_dwordx4 v2, s[4:7], s33 offen offset:0 lds
  v_mul_f32 v50, v50, v174
  v_mfma_f32_16x16x32_bf16 v[134:137], a[252:255], a[80:83], 0
  s_waitcnt lgkmcnt(4)
  ds_read_b128 a[244:247], v4 offset:5120
  v_exp_f32 v50, v50
  v_mfma_f32_16x16x32_bf16 v[74:77], a[224:227], a[4:7], v[74:77]
  v_mul_f32 v51, v51, v174
  v_mul_f32 v52, v52, v174
  v_mul_f32 v53, v53, v174
  v_mfma_f32_16x16x32_bf16 v[130:133], a[224:227], a[84:87], v[130:133]
  s_waitcnt lgkmcnt(4)
  ds_read_b128 a[248:251], v4 offset:6144
  v_exp_f32 v51, v51
  v_mfma_f32_16x16x32_bf16 v[78:81], a[228:231], a[4:7], v[78:81]
  buffer_load_dwordx4 v2, s[4:7], s33 offen offset:1024 lds
  v_fma_f32 v50, v50, v172, v172
  v_mfma_f32_16x16x32_bf16 v[134:137], a[228:231], a[84:87], v[134:137]
  s_waitcnt lgkmcnt(4)
  ds_read_b128 a[252:255], v4 offset:7168
  v_exp_f32 v52, v52
  v_mfma_f32_16x16x32_bf16 v[74:77], a[232:235], a[8:11], v[74:77]
  v_exp_f32 v53, v53
  v_fma_f32 v51, v51, v172, v172
  v_mfma_f32_16x16x32_bf16 v[130:133], a[232:235], a[88:91], v[130:133]
  s_waitcnt lgkmcnt(4)
  ds_read_b128 a[224:227], v4 offset:8192
  v_rcp_f32 v50, v50
  v_mfma_f32_16x16x32_bf16 v[78:81], a[236:239], a[8:11], v[78:81]
  buffer_load_dwordx4 v2, s[4:7], s33 offen offset:2048 lds
  v_fma_f32 v52, v52, v172, v172
  v_mfma_f32_16x16x32_bf16 v[134:137], a[236:239], a[88:91], v[134:137]
  s_waitcnt lgkmcnt(4)
  ds_read_b128 a[228:231], v4 offset:9216
  v_rcp_f32 v51, v51
  v_mfma_f32_16x16x32_bf16 v[74:77], a[240:243], a[12:15], v[74:77]
  v_rcp_f32 v52, v52
  v_fma_f32 v53, v53, v172, v172
  v_mfma_f32_16x16x32_bf16 v[130:133], a[240:243], a[92:95], v[130:133]
  s_waitcnt lgkmcnt(4)
  ds_read_b128 a[232:235], v4 offset:10240
  v_rcp_f32 v53, v53
  v_mfma_f32_16x16x32_bf16 v[78:81], a[244:247], a[12:15], v[78:81]
  buffer_load_dwordx4 v2, s[4:7], s33 offen offset:3072 lds
  v_mul_f32 v54, v54, v50
  v_mfma_f32_16x16x32_bf16 v[134:137], a[244:247], a[92:95], v[134:137]
  s_waitcnt lgkmcnt(4)
  ds_read_b128 a[236:239], v4 offset:11264
  v_mul_f32 v55, v55, v51
  v_mul_f32 v56, v56, v52
  v_mfma_f32_16x16x32_bf16 v[74:77], a[248:251], a[16:19], v[74:77]
  s_waitcnt vmcnt(19)
  s_barrier
  v_mul_f32 v57, v57, v53
  v_cvt_pk_bf16_f32 v192, v54, v55
  v_mfma_f32_16x16x32_bf16 v[130:133], a[248:251], a[96:99], v[130:133]
  s_waitcnt lgkmcnt(4)
  ds_read_b128 a[240:243], v4 offset:12288
  v_cvt_pk_bf16_f32 v193, v56, v57
  v_mul_f32 v106, v106, v175
  v_mfma_f32_16x16x32_bf16 v[78:81], a[252:255], a[16:19], v[78:81]
  s_add_u32 m0, s21, 65536
  v_exp_f32 v106, v106
  v_mul_f32 v107, v107, v175
  v_mfma_f32_16x16x32_bf16 v[134:137], a[252:255], a[96:99], v[134:137]
  s_waitcnt lgkmcnt(4)
  ds_read_b128 a[244:247], v4 offset:13312
  v_exp_f32 v107, v107
  v_mfma_f32_16x16x32_bf16 v[74:77], a[224:227], a[20:23], v[74:77]
  s_add_u32 s33, s24, 229376
  buffer_load_dwordx4 v2, s[4:7], s33 offen offset:0 lds
  v_mul_f32 v108, v108, v175
  v_mfma_f32_16x16x32_bf16 v[130:133], a[224:227], a[100:103], v[130:133]
  s_waitcnt lgkmcnt(4)
  ds_read_b128 a[248:251], v4 offset:14336
  v_exp_f32 v108, v108
  v_mfma_f32_16x16x32_bf16 v[78:81], a[228:231], a[20:23], v[78:81]
  v_mul_f32 v109, v109, v175
  v_fma_f32 v106, v106, v173, v173
  v_fma_f32 v107, v107, v173, v173
  v_mfma_f32_16x16x32_bf16 v[134:137], a[228:231], a[100:103], v[134:137]
  s_waitcnt lgkmcnt(4)
  ds_read_b128 a[252:255], v4 offset:15360
  v_exp_f32 v109, v109
  v_mfma_f32_16x16x32_bf16 v[74:77], a[232:235], a[24:27], v[74:77]
  s_add_u32 m0, s21, 81920
  v_rcp_f32 v106, v106
  v_fma_f32 v108, v108, v173, v173
  v_mfma_f32_16x16x32_bf16 v[130:133], a[232:235], a[104:107], v[130:133]
  s_waitcnt lgkmcnt(4)
  ds_read_b128 a[224:227], v4 offset:16384
  v_rcp_f32 v107, v107
  v_mfma_f32_16x16x32_bf16 v[78:81], a[236:239], a[24:27], v[78:81]
  s_add_u32 s33, s24, 245760
  buffer_load_dwordx4 v2, s[4:7], s33 offen offset:0 lds
  v_fma_f32 v109, v109, v173, v173
  v_mfma_f32_16x16x32_bf16 v[134:137], a[236:239], a[104:107], v[134:137]
  s_waitcnt lgkmcnt(4)
  ds_read_b128 a[228:231], v4 offset:17408
  v_rcp_f32 v108, v108
  v_mfma_f32_16x16x32_bf16 v[74:77], a[240:243], a[28:31], v[74:77]
  v_rcp_f32 v109, v109
  v_mul_f32 v110, v110, v106
  v_mfma_f32_16x16x32_bf16 v[130:133], a[240:243], a[108:111], v[130:133]
  s_waitcnt lgkmcnt(4)
  ds_read_b128 a[232:235], v4 offset:18432
  v_mul_f32 v111, v111, v107
  v_mul_f32 v112, v112, v108
  v_mfma_f32_16x16x32_bf16 v[78:81], a[244:247], a[28:31], v[78:81]
  buffer_load_dwordx4 v2, s[4:7], s33 offen offset:1024 lds
  v_mul_f32 v113, v113, v109
  v_mfma_f32_16x16x32_bf16 v[134:137], a[244:247], a[108:111], v[134:137]
  s_waitcnt lgkmcnt(4)
  ds_read_b128 a[236:239], v4 offset:19456
  v_cvt_pk_bf16_f32 v206, v110, v111
  v_cvt_pk_bf16_f32 v207, v112, v113
  v_mfma_f32_16x16x32_bf16 v[74:77], a[248:251], a[32:35], v[74:77]
  v_mul_f32 v58, v58, v174
  v_mul_f32 v59, v59, v174
  v_mul_f32 v60, v60, v174
  v_mfma_f32_16x16x32_bf16 v[130:133], a[248:251], a[112:115], v[130:133]
  s_waitcnt lgkmcnt(4)
  ds_read_b128 a[240:243], v4 offset:20480
  v_exp_f32 v58, v58
  v_mfma_f32_16x16x32_bf16 v[78:81], a[252:255], a[32:35], v[78:81]
  buffer_load_dwordx4 v2, s[4:7], s33 offen offset:2048 lds
  v_mul_f32 v61, v61, v174
  v_mfma_f32_16x16x32_bf16 v[134:137], a[252:255], a[112:115], v[134:137]
  s_waitcnt lgkmcnt(4)
  ds_read_b128 a[244:247], v4 offset:21504
  v_exp_f32 v59, v59
  v_mfma_f32_16x16x32_bf16 v[74:77], a[224:227], a[36:39], v[74:77]
  v_exp_f32 v60, v60
  v_fma_f32 v58, v58, v172, v172
  v_mfma_f32_16x16x32_bf16 v[130:133], a[224:227], a[116:119], v[130:133]
  s_waitcnt lgkmcnt(4)
  ds_read_b128 a[248:251], v4 offset:22528
  v_exp_f32 v61, v61
  v_mfma_f32_16x16x32_bf16 v[78:81], a[228:231], a[36:39], v[78:81]
  buffer_load_dwordx4 v2, s[4:7], s33 offen offset:3072 lds
  v_fma_f32 v59, v59, v172, v172
  v_mfma_f32_16x16x32_bf16 v[134:137], a[228:231], a[116:119], v[134:137]
  s_waitcnt lgkmcnt(4)
  ds_read_b128 a[252:255], v4 offset:23552
  v_rcp_f32 v58, v58
  v_mfma_f32_16x16x32_bf16 v[74:77], a[232:235], a[40:43], v[74:77]
  v_rcp_f32 v59, v59
  v_fma_f32 v60, v60, v172, v172
  v_mfma_f32_16x16x32_bf16 v[130:133], a[232:235], a[120:123], v[130:133]
  s_waitcnt lgkmcnt(4)
  ds_read_b128 a[224:227], v4 offset:24576
  v_rcp_f32 v60, v60
  v_mfma_f32_16x16x32_bf16 v[78:81], a[236:239], a[40:43], v[78:81]
  s_add_u32 m0, s21, 86016
  v_fma_f32 v61, v61, v172, v172
  v_mul_f32 v62, v62, v58
  v_mul_f32 v63, v63, v59
  v_mfma_f32_16x16x32_bf16 v[134:137], a[236:239], a[120:123], v[134:137]
  s_waitcnt lgkmcnt(4)
  ds_read_b128 a[228:231], v4 offset:25600
  v_rcp_f32 v61, v61
  v_mfma_f32_16x16x32_bf16 v[74:77], a[240:243], a[44:47], v[74:77]
  s_add_u32 s33, s24, 249856
  buffer_load_dwordx4 v2, s[4:7], s33 offen offset:0 lds
  v_mul_f32 v64, v64, v60
  v_mfma_f32_16x16x32_bf16 v[130:133], a[240:243], a[124:127], v[130:133]
  s_waitcnt lgkmcnt(4)
  ds_read_b128 a[232:235], v4 offset:26624
  v_mul_f32 v65, v65, v61
  v_cvt_pk_bf16_f32 v194, v62, v63
  v_mfma_f32_16x16x32_bf16 v[78:81], a[244:247], a[44:47], v[78:81]
  v_cvt_pk_bf16_f32 v195, v64, v65
  buffer_store_dwordx4 v[192:195], v2, s[4:7], s36 offen offset:0 sc1
  v_mul_f32 v114, v114, v175
  v_mfma_f32_16x16x32_bf16 v[134:137], a[244:247], a[124:127], v[134:137]
  s_waitcnt lgkmcnt(4)
  ds_read_b128 a[236:239], v4 offset:27648
  v_exp_f32 v114, v114
  v_mfma_f32_16x16x32_bf16 v[74:77], a[248:251], a[48:51], v[74:77]
  s_add_u32 m0, s21, 102400
  v_mul_f32 v115, v115, v175
  v_mul_f32 v116, v116, v175
  v_mul_f32 v117, v117, v175
  v_mfma_f32_16x16x32_bf16 v[130:133], a[248:251], a[128:131], v[130:133]
  s_waitcnt lgkmcnt(4)
  ds_read_b128 a[240:243], v4 offset:28672
  v_exp_f32 v115, v115
  v_mfma_f32_16x16x32_bf16 v[78:81], a[252:255], a[48:51], v[78:81]
  s_add_u32 s33, s24, 266240
  buffer_load_dwordx4 v2, s[4:7], s33 offen offset:0 lds
  v_fma_f32 v114, v114, v173, v173
  v_mfma_f32_16x16x32_bf16 v[134:137], a[252:255], a[128:131], v[134:137]
  s_waitcnt lgkmcnt(4)
  ds_read_b128 a[244:247], v4 offset:29696
  v_exp_f32 v116, v116
  v_mfma_f32_16x16x32_bf16 v[74:77], a[224:227], a[52:55], v[74:77]
  v_exp_f32 v117, v117
  v_fma_f32 v115, v115, v173, v173
  v_mfma_f32_16x16x32_bf16 v[130:133], a[224:227], a[132:135], v[130:133]
  s_waitcnt lgkmcnt(4)
  ds_read_b128 a[248:251], v4 offset:30720
  v_rcp_f32 v114, v114
  v_mfma_f32_16x16x32_bf16 v[78:81], a[228:231], a[52:55], v[78:81]
  buffer_load_dwordx4 v2, s[4:7], s33 offen offset:1024 lds
  v_fma_f32 v116, v116, v173, v173
  v_mfma_f32_16x16x32_bf16 v[134:137], a[228:231], a[132:135], v[134:137]
  s_waitcnt lgkmcnt(4)
  ds_read_b128 a[252:255], v4 offset:31744
  v_rcp_f32 v115, v115
  v_mfma_f32_16x16x32_bf16 v[74:77], a[232:235], a[56:59], v[74:77]
  s_waitcnt vmcnt(23)
  s_barrier
  v_rcp_f32 v116, v116
  v_mfma_f32_16x16x32_bf16 v[130:133], a[232:235], a[136:139], v[130:133]
  s_waitcnt lgkmcnt(4)
  ds_read_b128 a[224:227], v2 offset:0
  v_fma_f32 v117, v117, v173, v173
  v_mul_f32 v118, v118, v114
  v_mfma_f32_16x16x32_bf16 v[78:81], a[236:239], a[56:59], v[78:81]
  buffer_load_dwordx4 v2, s[4:7], s33 offen offset:2048 lds
  v_mul_f32 v119, v119, v115
  v_mfma_f32_16x16x32_bf16 v[134:137], a[236:239], a[136:139], v[134:137]
  s_waitcnt lgkmcnt(4)
  ds_read_b128 a[228:231], v2 offset:1024
  v_rcp_f32 v117, v117
  v_mfma_f32_16x16x32_bf16 v[74:77], a[240:243], a[60:63], v[74:77]
  v_mul_f32 v120, v120, v116
  v_mul_f32 v121, v121, v117
  v_cvt_pk_bf16_f32 v208, v118, v119
  v_mfma_f32_16x16x32_bf16 v[130:133], a[240:243], a[140:143], v[130:133]
  s_waitcnt lgkmcnt(4)
  ds_read_b128 a[232:235], v2 offset:2048
  v_cvt_pk_bf16_f32 v209, v120, v121
  buffer_store_dwordx4 v[206:209], v2, s[4:7], s61 offen offset:0 sc1
  v_mfma_f32_16x16x32_bf16 v[78:81], a[244:247], a[60:63], v[78:81]
  buffer_load_dwordx4 v2, s[4:7], s33 offen offset:3072 lds
  v_mul_f32 v66, v66, v174
  v_mfma_f32_16x16x32_bf16 v[134:137], a[244:247], a[140:143], v[134:137]
  s_waitcnt lgkmcnt(4)
  ds_read_b128 a[236:239], v2 offset:3072
  v_exp_f32 v66, v66
  v_mfma_f32_16x16x32_bf16 v[74:77], a[248:251], a[64:67], v[74:77]
  v_mul_f32 v67, v67, v174
  v_mul_f32 v68, v68, v174
  v_mul_f32 v69, v69, v174
  v_mfma_f32_16x16x32_bf16 v[130:133], a[248:251], a[144:147], v[130:133]
  s_waitcnt lgkmcnt(4)
  ds_read_b128 a[240:243], v2 offset:4096
  v_exp_f32 v67, v67
  v_mfma_f32_16x16x32_bf16 v[78:81], a[252:255], a[64:67], v[78:81]
  s_add_u32 m0, s21, 106496
  v_exp_f32 v68, v68
  v_fma_f32 v66, v66, v172, v172
  v_mfma_f32_16x16x32_bf16 v[134:137], a[252:255], a[144:147], v[134:137]
  s_waitcnt lgkmcnt(4)
  ds_read_b128 a[244:247], v2 offset:5120
  v_exp_f32 v69, v69
  v_mfma_f32_16x16x32_bf16 v[74:77], a[224:227], a[68:71], v[74:77]
  s_add_u32 s33, s24, 270336
  buffer_load_dwordx4 v2, s[4:7], s33 offen offset:0 lds
  v_fma_f32 v67, v67, v172, v172
  v_mfma_f32_16x16x32_bf16 v[130:133], a[224:227], a[148:151], v[130:133]
  s_waitcnt lgkmcnt(4)
  ds_read_b128 a[248:251], v2 offset:6144
  v_rcp_f32 v66, v66
  v_mfma_f32_16x16x32_bf16 v[78:81], a[228:231], a[68:71], v[78:81]
  v_rcp_f32 v67, v67
  v_fma_f32 v68, v68, v172, v172
  v_mfma_f32_16x16x32_bf16 v[134:137], a[228:231], a[148:151], v[134:137]
  s_waitcnt lgkmcnt(4)
  ds_read_b128 a[252:255], v2 offset:7168
  v_rcp_f32 v68, v68
  v_mfma_f32_16x16x32_bf16 v[74:77], a[232:235], a[72:75], v[74:77]
  s_mul_i32 s33, s12, 4096
  v_fma_f32 v69, v69, v172, v172
  v_mul_f32 v70, v70, v66
  v_mul_f32 v71, v71, v67
  v_mfma_f32_16x16x32_bf16 v[130:133], a[232:235], a[152:155], v[130:133]
  s_waitcnt lgkmcnt(4)
  ds_read_b128 a[224:227], v2 offset:8192
  v_rcp_f32 v69, v69
  v_mfma_f32_16x16x32_bf16 v[78:81], a[236:239], a[72:75], v[78:81]
  s_add_u32 m0, s33, 122880
  v_mul_f32 v72, v72, v68
  v_mul_f32 v73, v73, v69
  v_cvt_pk_bf16_f32 v196, v70, v71
  v_mfma_f32_16x16x32_bf16 v[134:137], a[236:239], a[152:155], v[134:137]
  s_waitcnt lgkmcnt(4)
  ds_read_b128 a[228:231], v2 offset:9216
  v_cvt_pk_bf16_f32 v197, v72, v73
  v_mul_f32 v122, v122, v175
  v_mfma_f32_16x16x32_bf16 v[74:77], a[240:243], a[76:79], v[74:77]
  s_sub_u32 s33, s33, s21
  v_exp_f32 v122, v122
  v_mul_f32 v123, v123, v175
  v_mfma_f32_16x16x32_bf16 v[130:133], a[240:243], a[156:159], v[130:133]
  s_waitcnt lgkmcnt(4)
  ds_read_b128 a[232:235], v2 offset:10240
  v_exp_f32 v123, v123
  v_mfma_f32_16x16x32_bf16 v[78:81], a[244:247], a[76:79], v[78:81]
  s_add_u32 s33, s33, s24
  v_mul_f32 v124, v124, v175
  v_mul_f32 v125, v125, v175
  v_fma_f32 v122, v122, v173, v173
  v_mfma_f32_16x16x32_bf16 v[134:137], a[244:247], a[156:159], v[134:137]
  s_waitcnt lgkmcnt(4)
  ds_read_b128 a[236:239], v2 offset:11264
  v_exp_f32 v124, v124
  v_mfma_f32_16x16x32_bf16 v[74:77], a[248:251], v[176:179], v[74:77]
  s_add_u32 s33, s33, 286720
  buffer_load_dwordx4 v2, s[4:7], s33 offen offset:0 lds
  v_fma_f32 v123, v123, v173, v173
  v_mfma_f32_16x16x32_bf16 v[130:133], a[248:251], v[180:183], v[130:133]
  s_waitcnt lgkmcnt(4)
  ds_read_b128 a[240:243], v2 offset:12288
  v_exp_f32 v125, v125
  v_mfma_f32_16x16x32_bf16 v[78:81], a[252:255], v[176:179], v[78:81]
  v_rcp_f32 v122, v122
  v_fma_f32 v124, v124, v173, v173
  v_mfma_f32_16x16x32_bf16 v[134:137], a[252:255], v[180:183], v[134:137]
  s_waitcnt lgkmcnt(4)
  ds_read_b128 a[244:247], v2 offset:13312
  v_rcp_f32 v123, v123
  v_mfma_f32_16x16x32_bf16 v[82:85], a[224:227], a[0:3], 0
  buffer_load_dwordx4 v2, s[4:7], s33 offen offset:1024 lds
  v_fma_f32 v125, v125, v173, v173
  v_mfma_f32_16x16x32_bf16 v[138:141], a[224:227], a[80:83], 0
  s_waitcnt lgkmcnt(4)
  ds_read_b128 a[248:251], v2 offset:14336
  v_rcp_f32 v124, v124
  v_mfma_f32_16x16x32_bf16 v[86:89], a[228:231], a[0:3], 0
  v_rcp_f32 v125, v125
  v_mul_f32 v126, v126, v122
  v_mfma_f32_16x16x32_bf16 v[142:145], a[228:231], a[80:83], 0
  s_waitcnt lgkmcnt(4)
  ds_read_b128 a[252:255], v2 offset:15360
  v_mul_f32 v127, v127, v123
  v_mul_f32 v128, v128, v124
  v_mfma_f32_16x16x32_bf16 v[90:93], a[232:235], a[0:3], 0
  buffer_load_dwordx4 v2, s[4:7], s33 offen offset:2048 lds
  v_mfma_f32_16x16x32_bf16 v[146:149], a[232:235], a[80:83], 0
  s_waitcnt lgkmcnt(4)
  ds_read_b128 a[224:227], v2 offset:16384
  v_mul_f32 v129, v129, v125
  v_mfma_f32_16x16x32_bf16 v[94:97], a[236:239], a[0:3], 0
  v_cvt_pk_bf16_f32 v210, v126, v127
  v_cvt_pk_bf16_f32 v211, v128, v129
  v_mfma_f32_16x16x32_bf16 v[150:153], a[236:239], a[80:83], 0
  s_waitcnt lgkmcnt(4)
  ds_read_b128 a[228:231], v2 offset:17408
  v_mul_f32 v74, v74, v174
  v_mfma_f32_16x16x32_bf16 v[82:85], a[240:243], a[4:7], v[82:85]
  buffer_load_dwordx4 v2, s[4:7], s33 offen offset:3072 lds
  v_mfma_f32_16x16x32_bf16 v[138:141], a[240:243], a[84:87], v[138:141]
  s_waitcnt lgkmcnt(4)
  ds_read_b128 a[232:235], v2 offset:18432
  v_mul_f32 v75, v75, v174
  v_mfma_f32_16x16x32_bf16 v[86:89], a[244:247], a[4:7], v[86:89]
  v_exp_f32 v74, v74
  v_mfma_f32_16x16x32_bf16 v[142:145], a[244:247], a[84:87], v[142:145]
  s_waitcnt lgkmcnt(4)
  ds_read_b128 a[236:239], v2 offset:19456
  v_mul_f32 v76, v76, v174
  v_mfma_f32_16x16x32_bf16 v[90:93], a[248:251], a[4:7], v[90:93]
  s_waitcnt vmcnt(26)
  s_barrier
  v_mul_f32 v77, v77, v174
  v_mfma_f32_16x16x32_bf16 v[146:149], a[248:251], a[84:87], v[146:149]
  s_waitcnt lgkmcnt(4)
  ds_read_b128 a[240:243], v2 offset:20480
  v_fma_f32 v74, v74, v172, v172
  v_mfma_f32_16x16x32_bf16 v[94:97], a[252:255], a[4:7], v[94:97]
  s_add_u32 m0, s21, 143360
  v_exp_f32 v75, v75
  v_mfma_f32_16x16x32_bf16 v[150:153], a[252:255], a[84:87], v[150:153]
  s_waitcnt lgkmcnt(4)
  ds_read_b128 a[244:247], v2 offset:21504
  v_fma_f32 v75, v75, v172, v172
  v_mfma_f32_16x16x32_bf16 v[82:85], a[224:227], a[8:11], v[82:85]
  s_add_u32 s33, s25, 0
  buffer_load_dwordx4 v2, s[4:7], s33 offen offset:0 lds
  v_mfma_f32_16x16x32_bf16 v[138:141], a[224:227], a[88:91], v[138:141]
  s_waitcnt lgkmcnt(4)
  ds_read_b128 a[248:251], v2 offset:22528
  v_mfma_f32_16x16x32_bf16 v[86:89], a[228:231], a[8:11], v[86:89]
  v_exp_f32 v76, v76
  v_mfma_f32_16x16x32_bf16 v[142:145], a[228:231], a[88:91], v[142:145]
  s_waitcnt lgkmcnt(4)
  ds_read_b128 a[252:255], v2 offset:23552
  v_fma_f32 v76, v76, v172, v172
  v_mfma_f32_16x16x32_bf16 v[90:93], a[232:235], a[8:11], v[90:93]
  buffer_load_dwordx4 v2, s[4:7], s33 offen offset:1024 lds
  v_mfma_f32_16x16x32_bf16 v[146:149], a[232:235], a[88:91], v[146:149]
  s_waitcnt lgkmcnt(4)
  ds_read_b128 a[224:227], v2 offset:24576
  v_mfma_f32_16x16x32_bf16 v[94:97], a[236:239], a[8:11], v[94:97]
  v_exp_f32 v77, v77
  v_mfma_f32_16x16x32_bf16 v[150:153], a[236:239], a[88:91], v[150:153]
  s_waitcnt lgkmcnt(4)
  ds_read_b128 a[228:231], v2 offset:25600
  v_fma_f32 v77, v77, v172, v172
  v_mfma_f32_16x16x32_bf16 v[82:85], a[240:243], a[12:15], v[82:85]
  buffer_load_dwordx4 v2, s[4:7], s33 offen offset:2048 lds
  v_mfma_f32_16x16x32_bf16 v[138:141], a[240:243], a[92:95], v[138:141]
  s_waitcnt lgkmcnt(4)
  ds_read_b128 a[232:235], v2 offset:26624
  v_mfma_f32_16x16x32_bf16 v[86:89], a[244:247], a[12:15], v[86:89]
  v_rcp_f32 v74, v74
  v_mfma_f32_16x16x32_bf16 v[142:145], a[244:247], a[92:95], v[142:145]
  s_waitcnt lgkmcnt(4)
  ds_read_b128 a[236:239], v2 offset:27648
  v_mul_f32 v78, v78, v74
  v_mfma_f32_16x16x32_bf16 v[90:93], a[248:251], a[12:15], v[90:93]
  buffer_load_dwordx4 v2, s[4:7], s33 offen offset:3072 lds
  v_mfma_f32_16x16x32_bf16 v[146:149], a[248:251], a[92:95], v[146:149]
  s_waitcnt lgkmcnt(4)
  ds_read_b128 a[240:243], v2 offset:28672
  v_mfma_f32_16x16x32_bf16 v[94:97], a[252:255], a[12:15], v[94:97]
  v_rcp_f32 v75, v75
  v_mfma_f32_16x16x32_bf16 v[150:153], a[252:255], a[92:95], v[150:153]
  s_waitcnt lgkmcnt(4)
  ds_read_b128 a[244:247], v2 offset:29696
  v_mul_f32 v79, v79, v75
  v_mfma_f32_16x16x32_bf16 v[82:85], a[224:227], a[16:19], v[82:85]
  s_add_u32 m0, s21, 147456
  v_rcp_f32 v76, v76
  v_mfma_f32_16x16x32_bf16 v[138:141], a[224:227], a[96:99], v[138:141]
  s_waitcnt lgkmcnt(4)
  ds_read_b128 a[248:251], v2 offset:30720
  v_mul_f32 v80, v80, v76
  v_mfma_f32_16x16x32_bf16 v[86:89], a[228:231], a[16:19], v[86:89]
  s_add_u32 s33, s25, 4096
  buffer_load_dwordx4 v2, s[4:7], s33 offen offset:0 lds
  v_mfma_f32_16x16x32_bf16 v[142:145], a[228:231], a[96:99], v[142:145]
  s_waitcnt lgkmcnt(4)
  ds_read_b128 a[252:255], v2 offset:31744
  v_cvt_pk_bf16_f32 v198, v78, v79
  v_mfma_f32_16x16x32_bf16 v[90:93], a[232:235], a[16:19], v[90:93]
  v_rcp_f32 v77, v77
  v_mfma_f32_16x16x32_bf16 v[146:149], a[232:235], a[96:99], v[146:149]
  s_waitcnt lgkmcnt(4)
  ds_read_b128 a[224:227], v2 offset:32768
  v_mul_f32 v81, v81, v77
  v_mfma_f32_16x16x32_bf16 v[94:97], a[236:239], a[16:19], v[94:97]
  v_cvt_pk_bf16_f32 v199, v80, v81
  buffer_store_dwordx4 v[196:199], v2, s[4:7], s36 offen offset:1024 sc1
  v_mfma_f32_16x16x32_bf16 v[150:153], a[236:239], a[96:99], v[150:153]
  s_waitcnt lgkmcnt(4)
  ds_read_b128 a[228:231], v2 offset:33792
  v_mul_f32 v130, v130, v175
  v_mfma_f32_16x16x32_bf16 v[82:85], a[240:243], a[20:23], v[82:85]
  v_exp_f32 v130, v130
  v_mfma_f32_16x16x32_bf16 v[138:141], a[240:243], a[100:103], v[138:141]
  s_waitcnt lgkmcnt(4)
  ds_read_b128 a[232:235], v2 offset:34816
  v_mul_f32 v131, v131, v175
  v_mfma_f32_16x16x32_bf16 v[86:89], a[244:247], a[20:23], v[86:89]
  v_exp_f32 v131, v131
  v_mfma_f32_16x16x32_bf16 v[142:145], a[244:247], a[100:103], v[142:145]
  s_waitcnt lgkmcnt(4)
  ds_read_b128 a[236:239], v2 offset:35840
  v_mul_f32 v132, v132, v175
  v_mfma_f32_16x16x32_bf16 v[90:93], a[248:251], a[20:23], v[90:93]
  v_exp_f32 v132, v132
  v_mfma_f32_16x16x32_bf16 v[146:149], a[248:251], a[100:103], v[146:149]
  s_waitcnt lgkmcnt(4)
  ds_read_b128 a[240:243], v2 offset:36864
  v_mul_f32 v133, v133, v175
  v_mfma_f32_16x16x32_bf16 v[94:97], a[252:255], a[20:23], v[94:97]
  v_exp_f32 v133, v133
  v_mfma_f32_16x16x32_bf16 v[150:153], a[252:255], a[100:103], v[150:153]
  s_waitcnt lgkmcnt(4)
  ds_read_b128 a[244:247], v2 offset:37888
  v_fma_f32 v130, v130, v173, v173
  v_mfma_f32_16x16x32_bf16 v[82:85], a[224:227], a[24:27], v[82:85]
  v_rcp_f32 v130, v130
  v_mfma_f32_16x16x32_bf16 v[138:141], a[224:227], a[104:107], v[138:141]
  s_waitcnt lgkmcnt(4)
  ds_read_b128 a[248:251], v2 offset:38912
  v_fma_f32 v131, v131, v173, v173
  v_mfma_f32_16x16x32_bf16 v[86:89], a[228:231], a[24:27], v[86:89]
  v_rcp_f32 v131, v131
  v_mfma_f32_16x16x32_bf16 v[142:145], a[228:231], a[104:107], v[142:145]
  s_waitcnt lgkmcnt(4)
  ds_read_b128 a[252:255], v2 offset:39936
  v_fma_f32 v132, v132, v173, v173
  v_mfma_f32_16x16x32_bf16 v[90:93], a[232:235], a[24:27], v[90:93]
  s_waitcnt vmcnt(27)
  s_barrier
  v_fma_f32 v133, v133, v173, v173
  v_mfma_f32_16x16x32_bf16 v[146:149], a[232:235], a[104:107], v[146:149]
  s_waitcnt lgkmcnt(4)
  ds_read_b128 a[224:227], v2 offset:40960
  v_mul_f32 v134, v134, v130
  v_mfma_f32_16x16x32_bf16 v[94:97], a[236:239], a[24:27], v[94:97]
  s_add_u32 m0, s21, 0
  v_rcp_f32 v132, v132
  v_mfma_f32_16x16x32_bf16 v[150:153], a[236:239], a[104:107], v[150:153]
  s_waitcnt lgkmcnt(4)
  ds_read_b128 a[228:231], v2 offset:41984
  v_mul_f32 v135, v135, v131
  v_mfma_f32_16x16x32_bf16 v[82:85], a[240:243], a[28:31], v[82:85]
  s_add_u32 s33, s25, 20480
  buffer_load_dwordx4 v2, s[4:7], s33 offen offset:0 lds
  v_mfma_f32_16x16x32_bf16 v[138:141], a[240:243], a[108:111], v[138:141]
  s_waitcnt lgkmcnt(4)
  ds_read_b128 a[232:235], v2 offset:43008
  v_mul_f32 v136, v136, v132
  v_mfma_f32_16x16x32_bf16 v[86:89], a[244:247], a[28:31], v[86:89]
  v_rcp_f32 v133, v133
  v_mfma_f32_16x16x32_bf16 v[142:145], a[244:247], a[108:111], v[142:145]
  s_waitcnt lgkmcnt(4)
  ds_read_b128 a[236:239], v2 offset:44032
  v_mul_f32 v137, v137, v133
  v_mfma_f32_16x16x32_bf16 v[90:93], a[248:251], a[28:31], v[90:93]
  buffer_load_dwordx4 v2, s[4:7], s33 offen offset:1024 lds
  v_mfma_f32_16x16x32_bf16 v[146:149], a[248:251], a[108:111], v[146:149]
  s_waitcnt lgkmcnt(4)
  ds_read_b128 a[240:243], v2 offset:45056
  v_cvt_pk_bf16_f32 v212, v134, v135
  v_mfma_f32_16x16x32_bf16 v[94:97], a[252:255], a[28:31], v[94:97]
  v_cvt_pk_bf16_f32 v213, v136, v137
  buffer_store_dwordx4 v[210:213], v2, s[4:7], s61 offen offset:1024 sc1
  v_mfma_f32_16x16x32_bf16 v[150:153], a[252:255], a[108:111], v[150:153]
  s_waitcnt lgkmcnt(4)
  ds_read_b128 a[244:247], v2 offset:46080
  s_add_u32 s36, s36, s62
  v_mfma_f32_16x16x32_bf16 v[82:85], a[224:227], a[32:35], v[82:85]
  s_add_u32 s61, s61, s62
  buffer_load_dwordx4 v2, s[4:7], s33 offen offset:2048 lds
  v_mfma_f32_16x16x32_bf16 v[138:141], a[224:227], a[112:115], v[138:141]
  s_waitcnt lgkmcnt(4)
  ds_read_b128 a[248:251], v2 offset:47104
  s_lshr_b32 s62, s62, 1
  v_mfma_f32_16x16x32_bf16 v[86:89], a[228:231], a[32:35], v[86:89]
  s_lshr_b32 s34, s26, 4
  s_lshl_b32 s34, s34, 11
  s_and_b32 s35, s26, 15
  v_mfma_f32_16x16x32_bf16 v[142:145], a[228:231], a[112:115], v[142:145]
  s_waitcnt lgkmcnt(4)
  ds_read_b128 a[252:255], v2 offset:48128
  s_lshl_b32 s35, s35, 2
  v_mfma_f32_16x16x32_bf16 v[90:93], a[232:235], a[32:35], v[90:93]
  s_add_u32 s34, s34, s35
  buffer_load_dwordx4 v2, s[4:7], s33 offen offset:3072 lds
  v_mfma_f32_16x16x32_bf16 v[146:149], a[232:235], a[112:115], v[146:149]
  s_waitcnt lgkmcnt(4)
  ds_read_b128 a[224:227], v2 offset:49152
  s_add_u32 s34, s34, s20
  v_mfma_f32_16x16x32_bf16 v[94:97], a[236:239], a[32:35], v[94:97]
  s_add_u32 s34, s34, 25997312
  v_mfma_f32_16x16x32_bf16 v[150:153], a[236:239], a[112:115], v[150:153]
  s_waitcnt lgkmcnt(4)
  ds_read_b128 a[228:231], v2 offset:50176
  v_mfma_f32_16x16x32_bf16 v[82:85], a[240:243], a[36:39], v[82:85]
  s_add_u32 m0, s21, 4096
  v_mfma_f32_16x16x32_bf16 v[138:141], a[240:243], a[116:119], v[138:141]
  s_waitcnt lgkmcnt(4)
  ds_read_b128 a[232:235], v2 offset:51200
  v_mfma_f32_16x16x32_bf16 v[86:89], a[244:247], a[36:39], v[86:89]
  s_add_u32 s33, s25, 24576
  buffer_load_dwordx4 v2, s[4:7], s33 offen offset:0 lds
  v_mfma_f32_16x16x32_bf16 v[142:145], a[244:247], a[116:119], v[142:145]
  s_waitcnt lgkmcnt(4)
  ds_read_b128 a[236:239], v2 offset:52224
  v_mfma_f32_16x16x32_bf16 v[90:93], a[248:251], a[36:39], v[90:93]
  v_mfma_f32_16x16x32_bf16 v[146:149], a[248:251], a[116:119], v[146:149]
  s_waitcnt lgkmcnt(4)
  ds_read_b128 a[240:243], v2 offset:53248
  v_mfma_f32_16x16x32_bf16 v[94:97], a[252:255], a[36:39], v[94:97]
  v_mfma_f32_16x16x32_bf16 v[150:153], a[252:255], a[116:119], v[150:153]
  s_waitcnt lgkmcnt(4)
  ds_read_b128 a[244:247], v2 offset:54272
  v_mfma_f32_16x16x32_bf16 v[82:85], a[224:227], a[40:43], v[82:85]
  v_mfma_f32_16x16x32_bf16 v[138:141], a[224:227], a[120:123], v[138:141]
  s_waitcnt lgkmcnt(4)
  ds_read_b128 a[248:251], v2 offset:55296
  v_mfma_f32_16x16x32_bf16 v[86:89], a[228:231], a[40:43], v[86:89]
  v_mfma_f32_16x16x32_bf16 v[142:145], a[228:231], a[120:123], v[142:145]
  s_waitcnt lgkmcnt(4)
  ds_read_b128 a[252:255], v2 offset:56320
  v_mfma_f32_16x16x32_bf16 v[90:93], a[232:235], a[40:43], v[90:93]
  v_mfma_f32_16x16x32_bf16 v[146:149], a[232:235], a[120:123], v[146:149]
  s_waitcnt lgkmcnt(4)
  ds_read_b128 a[224:227], v2 offset:57344
  v_mfma_f32_16x16x32_bf16 v[94:97], a[236:239], a[40:43], v[94:97]
  v_mfma_f32_16x16x32_bf16 v[150:153], a[236:239], a[120:123], v[150:153]
  s_waitcnt lgkmcnt(4)
  ds_read_b128 a[228:231], v2 offset:58368
  v_mfma_f32_16x16x32_bf16 v[82:85], a[240:243], a[44:47], v[82:85]
  v_mfma_f32_16x16x32_bf16 v[138:141], a[240:243], a[124:127], v[138:141]
  s_waitcnt lgkmcnt(4)
  ds_read_b128 a[232:235], v2 offset:59392
  v_mfma_f32_16x16x32_bf16 v[86:89], a[244:247], a[44:47], v[86:89]
  v_mfma_f32_16x16x32_bf16 v[142:145], a[244:247], a[124:127], v[142:145]
  s_waitcnt lgkmcnt(4)
  ds_read_b128 a[236:239], v2 offset:60416
  v_mfma_f32_16x16x32_bf16 v[90:93], a[248:251], a[44:47], v[90:93]
  s_waitcnt vmcnt(28)
  s_barrier
  v_mfma_f32_16x16x32_bf16 v[146:149], a[248:251], a[124:127], v[146:149]
  s_waitcnt lgkmcnt(4)
  ds_read_b128 a[240:243], v2 offset:61440
  v_mfma_f32_16x16x32_bf16 v[94:97], a[252:255], a[44:47], v[94:97]
  s_add_u32 m0, s21, 20480
  v_mfma_f32_16x16x32_bf16 v[150:153], a[252:255], a[124:127], v[150:153]
  s_waitcnt lgkmcnt(4)
  ds_read_b128 a[244:247], v2 offset:62464
  v_mfma_f32_16x16x32_bf16 v[82:85], a[224:227], a[48:51], v[82:85]
  s_add_u32 s33, s25, 40960
  buffer_load_dwordx4 v2, s[4:7], s33 offen offset:0 lds
  v_mfma_f32_16x16x32_bf16 v[138:141], a[224:227], a[128:131], v[138:141]
  s_waitcnt lgkmcnt(4)
  ds_read_b128 a[248:251], v2 offset:63488
  v_mfma_f32_16x16x32_bf16 v[86:89], a[228:231], a[48:51], v[86:89]
  v_mfma_f32_16x16x32_bf16 v[142:145], a[228:231], a[128:131], v[142:145]
  s_waitcnt lgkmcnt(4)
  ds_read_b128 a[252:255], v2 offset:64512
  v_mfma_f32_16x16x32_bf16 v[90:93], a[232:235], a[48:51], v[90:93]
  buffer_load_dwordx4 v2, s[4:7], s33 offen offset:1024 lds
  v_mfma_f32_16x16x32_bf16 v[146:149], a[232:235], a[128:131], v[146:149]
  s_waitcnt lgkmcnt(4)
  ds_read_b128 a[224:227], v3 offset:0
  v_mfma_f32_16x16x32_bf16 v[94:97], a[236:239], a[48:51], v[94:97]
  v_mfma_f32_16x16x32_bf16 v[150:153], a[236:239], a[128:131], v[150:153]
  s_waitcnt lgkmcnt(4)
  ds_read_b128 a[228:231], v3 offset:1024
  v_mfma_f32_16x16x32_bf16 v[82:85], a[240:243], a[52:55], v[82:85]
  buffer_load_dwordx4 v2, s[4:7], s33 offen offset:2048 lds
  v_mfma_f32_16x16x32_bf16 v[138:141], a[240:243], a[132:135], v[138:141]
  s_waitcnt lgkmcnt(4)
  ds_read_b128 a[232:235], v3 offset:2048
  v_mfma_f32_16x16x32_bf16 v[86:89], a[244:247], a[52:55], v[86:89]
  v_mfma_f32_16x16x32_bf16 v[142:145], a[244:247], a[132:135], v[142:145]
  s_waitcnt lgkmcnt(4)
  ds_read_b128 a[236:239], v3 offset:3072
  v_mfma_f32_16x16x32_bf16 v[90:93], a[248:251], a[52:55], v[90:93]
  buffer_load_dwordx4 v2, s[4:7], s33 offen offset:3072 lds
  v_mfma_f32_16x16x32_bf16 v[146:149], a[248:251], a[132:135], v[146:149]
  s_waitcnt lgkmcnt(4)
  ds_read_b128 a[240:243], v3 offset:4096
  v_mfma_f32_16x16x32_bf16 v[94:97], a[252:255], a[52:55], v[94:97]
  v_mfma_f32_16x16x32_bf16 v[150:153], a[252:255], a[132:135], v[150:153]
  s_waitcnt lgkmcnt(4)
  ds_read_b128 a[244:247], v3 offset:5120
  v_mfma_f32_16x16x32_bf16 v[82:85], a[224:227], a[56:59], v[82:85]
  s_add_u32 m0, s21, 24576
  v_mfma_f32_16x16x32_bf16 v[138:141], a[224:227], a[136:139], v[138:141]
  s_waitcnt lgkmcnt(4)
  ds_read_b128 a[248:251], v3 offset:6144
  v_mfma_f32_16x16x32_bf16 v[86:89], a[228:231], a[56:59], v[86:89]
  s_add_u32 s33, s25, 45056
  buffer_load_dwordx4 v2, s[4:7], s33 offen offset:0 lds
  v_mfma_f32_16x16x32_bf16 v[142:145], a[228:231], a[136:139], v[142:145]
  s_waitcnt lgkmcnt(4)
  ds_read_b128 a[252:255], v3 offset:7168
  v_mfma_f32_16x16x32_bf16 v[90:93], a[232:235], a[56:59], v[90:93]
  v_mfma_f32_16x16x32_bf16 v[146:149], a[232:235], a[136:139], v[146:149]
  s_waitcnt lgkmcnt(4)
  ds_read_b128 a[224:227], v3 offset:8192
  v_mfma_f32_16x16x32_bf16 v[94:97], a[236:239], a[56:59], v[94:97]
  v_mfma_f32_16x16x32_bf16 v[150:153], a[236:239], a[136:139], v[150:153]
  s_waitcnt lgkmcnt(4)
  ds_read_b128 a[228:231], v3 offset:9216
  v_mfma_f32_16x16x32_bf16 v[82:85], a[240:243], a[60:63], v[82:85]
  v_mfma_f32_16x16x32_bf16 v[138:141], a[240:243], a[140:143], v[138:141]
  s_waitcnt lgkmcnt(4)
  ds_read_b128 a[232:235], v3 offset:10240
  v_mfma_f32_16x16x32_bf16 v[86:89], a[244:247], a[60:63], v[86:89]
  v_mfma_f32_16x16x32_bf16 v[142:145], a[244:247], a[140:143], v[142:145]
  s_waitcnt lgkmcnt(4)
  ds_read_b128 a[236:239], v3 offset:11264
  v_mfma_f32_16x16x32_bf16 v[90:93], a[248:251], a[60:63], v[90:93]
  v_mfma_f32_16x16x32_bf16 v[146:149], a[248:251], a[140:143], v[146:149]
  s_waitcnt lgkmcnt(4)
  ds_read_b128 a[240:243], v3 offset:12288
  v_mfma_f32_16x16x32_bf16 v[94:97], a[252:255], a[60:63], v[94:97]
  v_mfma_f32_16x16x32_bf16 v[150:153], a[252:255], a[140:143], v[150:153]
  s_waitcnt lgkmcnt(4)
  ds_read_b128 a[244:247], v3 offset:13312
  v_mfma_f32_16x16x32_bf16 v[82:85], a[224:227], a[64:67], v[82:85]
  s_waitcnt vmcnt(8)
  s_barrier
  buffer_store_dword v25, v22, s[4:7], s34 offen offset:0 sc1
  v_mfma_f32_16x16x32_bf16 v[138:141], a[224:227], a[144:147], v[138:141]
  s_waitcnt lgkmcnt(4)
  ds_read_b128 a[248:251], v3 offset:14336
  s_lshl_b32 s60, s27, 7
  v_mfma_f32_16x16x32_bf16 v[86:89], a[228:231], a[64:67], v[86:89]
  s_add_u32 s60, s60, s20
  s_add_u32 s60, s60, 25997312
  s_mul_i32 s30, s16, 55296
  v_mfma_f32_16x16x32_bf16 v[142:145], a[228:231], a[144:147], v[142:145]
  s_waitcnt lgkmcnt(4)
  ds_read_b128 a[252:255], v3 offset:15360
  s_add_u32 s30, s30, s20
  v_mfma_f32_16x16x32_bf16 v[90:93], a[232:235], a[64:67], v[90:93]
  s_barrier
  s_add_u32 s30, s30, 18485248
  v_mfma_f32_16x16x32_bf16 v[146:149], a[232:235], a[144:147], v[146:149]
  s_waitcnt lgkmcnt(4)
  ds_read_b128 a[224:227], v3 offset:16384
  v_mfma_f32_16x16x32_bf16 v[94:97], a[236:239], a[64:67], v[94:97]
  s_add_u32 m0, s21, 40960
  v_mfma_f32_16x16x32_bf16 v[150:153], a[236:239], a[144:147], v[150:153]
  s_waitcnt lgkmcnt(4)
  ds_read_b128 a[228:231], v3 offset:17408
  v_mfma_f32_16x16x32_bf16 v[82:85], a[240:243], a[68:71], v[82:85]
  s_add_u32 s33, s25, 61440
  buffer_load_dwordx4 v2, s[4:7], s33 offen offset:0 lds
  v_mfma_f32_16x16x32_bf16 v[138:141], a[240:243], a[148:151], v[138:141]
  s_waitcnt lgkmcnt(4)
  ds_read_b128 a[232:235], v3 offset:18432
  v_mfma_f32_16x16x32_bf16 v[86:89], a[244:247], a[68:71], v[86:89]
  v_mfma_f32_16x16x32_bf16 v[142:145], a[244:247], a[148:151], v[142:145]
  s_waitcnt lgkmcnt(4)
  ds_read_b128 a[236:239], v3 offset:19456
  v_mfma_f32_16x16x32_bf16 v[90:93], a[248:251], a[68:71], v[90:93]
  buffer_load_dwordx4 v2, s[4:7], s33 offen offset:1024 lds
  v_mfma_f32_16x16x32_bf16 v[146:149], a[248:251], a[148:151], v[146:149]
  s_waitcnt lgkmcnt(4)
  ds_read_b128 a[240:243], v3 offset:20480
  v_mfma_f32_16x16x32_bf16 v[94:97], a[252:255], a[68:71], v[94:97]
  v_mfma_f32_16x16x32_bf16 v[150:153], a[252:255], a[148:151], v[150:153]
  s_waitcnt lgkmcnt(4)
  ds_read_b128 a[244:247], v3 offset:21504
  v_mfma_f32_16x16x32_bf16 v[82:85], a[224:227], a[72:75], v[82:85]
  buffer_load_dwordx4 v2, s[4:7], s33 offen offset:2048 lds
  v_mfma_f32_16x16x32_bf16 v[138:141], a[224:227], a[152:155], v[138:141]
  s_waitcnt lgkmcnt(4)
  ds_read_b128 a[248:251], v3 offset:22528
  v_mfma_f32_16x16x32_bf16 v[86:89], a[228:231], a[72:75], v[86:89]
  v_mfma_f32_16x16x32_bf16 v[142:145], a[228:231], a[152:155], v[142:145]
  s_waitcnt lgkmcnt(4)
  ds_read_b128 a[252:255], v3 offset:23552
  v_mfma_f32_16x16x32_bf16 v[90:93], a[232:235], a[72:75], v[90:93]
  buffer_load_dwordx4 v2, s[4:7], s33 offen offset:3072 lds
  v_mfma_f32_16x16x32_bf16 v[146:149], a[232:235], a[152:155], v[146:149]
  s_waitcnt lgkmcnt(4)
  ds_read_b128 a[224:227], v3 offset:24576
  v_mfma_f32_16x16x32_bf16 v[94:97], a[236:239], a[72:75], v[94:97]
  v_mfma_f32_16x16x32_bf16 v[150:153], a[236:239], a[152:155], v[150:153]
  s_waitcnt lgkmcnt(4)
  ds_read_b128 a[228:231], v3 offset:25600
  v_mfma_f32_16x16x32_bf16 v[82:85], a[240:243], a[76:79], v[82:85]
  s_add_u32 m0, s21, 45056
  v_mfma_f32_16x16x32_bf16 v[138:141], a[240:243], a[156:159], v[138:141]
  s_waitcnt lgkmcnt(4)
  ds_read_b128 a[232:235], v3 offset:26624
  v_mfma_f32_16x16x32_bf16 v[86:89], a[244:247], a[76:79], v[86:89]
  s_add_u32 s33, s25, 65536
  buffer_load_dwordx4 v2, s[4:7], s33 offen offset:0 lds
  v_mfma_f32_16x16x32_bf16 v[142:145], a[244:247], a[156:159], v[142:145]
  s_waitcnt lgkmcnt(4)
  ds_read_b128 a[236:239], v3 offset:27648
  v_mfma_f32_16x16x32_bf16 v[90:93], a[248:251], a[76:79], v[90:93]
  v_mfma_f32_16x16x32_bf16 v[146:149], a[248:251], a[156:159], v[146:149]
  s_waitcnt lgkmcnt(4)
  ds_read_b128 a[240:243], v3 offset:28672
  v_mfma_f32_16x16x32_bf16 v[94:97], a[252:255], a[76:79], v[94:97]
  v_mfma_f32_16x16x32_bf16 v[150:153], a[252:255], a[156:159], v[150:153]
  s_waitcnt lgkmcnt(4)
  ds_read_b128 a[244:247], v3 offset:29696
  v_mfma_f32_16x16x32_bf16 v[82:85], a[224:227], v[176:179], v[82:85]
  v_mfma_f32_16x16x32_bf16 v[138:141], a[224:227], v[180:183], v[138:141]
  s_waitcnt lgkmcnt(4)
  ds_read_b128 a[248:251], v3 offset:30720
  v_mfma_f32_16x16x32_bf16 v[86:89], a[228:231], v[176:179], v[86:89]
  v_mfma_f32_16x16x32_bf16 v[142:145], a[228:231], v[180:183], v[142:145]
  s_waitcnt lgkmcnt(4)
  ds_read_b128 a[252:255], v3 offset:31744
  v_mfma_f32_16x16x32_bf16 v[90:93], a[232:235], v[176:179], v[90:93]
  v_mfma_f32_16x16x32_bf16 v[146:149], a[232:235], v[180:183], v[146:149]
  s_waitcnt lgkmcnt(4)
  ds_read_b128 a[224:227], v3 offset:32768
  v_mfma_f32_16x16x32_bf16 v[94:97], a[236:239], v[176:179], v[94:97]
  v_mfma_f32_16x16x32_bf16 v[150:153], a[236:239], v[180:183], v[150:153]
  s_waitcnt lgkmcnt(4)
  ds_read_b128 a[228:231], v3 offset:33792
  v_mfma_f32_16x16x32_bf16 v[98:101], a[240:243], a[0:3], 0
  v_mfma_f32_16x16x32_bf16 v[154:157], a[240:243], a[80:83], 0
  s_waitcnt lgkmcnt(4)
  ds_read_b128 a[232:235], v3 offset:34816
  v_mfma_f32_16x16x32_bf16 v[102:105], a[244:247], a[0:3], 0
  v_mul_f32 v82, v82, v174
  v_mul_f32 v83, v83, v174
  v_mfma_f32_16x16x32_bf16 v[158:161], a[244:247], a[80:83], 0
  s_waitcnt lgkmcnt(4)
  ds_read_b128 a[236:239], v3 offset:35840
  v_mul_f32 v84, v84, v174
  v_mfma_f32_16x16x32_bf16 v[98:101], a[248:251], a[4:7], v[98:101]
  s_barrier
  v_mul_f32 v85, v85, v174
  v_mfma_f32_16x16x32_bf16 v[154:157], a[248:251], a[84:87], v[154:157]
  s_waitcnt lgkmcnt(4)
  ds_read_b128 a[240:243], v3 offset:36864
  v_mfma_f32_16x16x32_bf16 v[102:105], a[252:255], a[4:7], v[102:105]
  s_add_u32 m0, s21, 61440
  v_exp_f32 v82, v82
  v_mfma_f32_16x16x32_bf16 v[158:161], a[252:255], a[84:87], v[158:161]
  s_waitcnt lgkmcnt(4)
  ds_read_b128 a[244:247], v3 offset:37888
  v_fma_f32 v82, v82, v172, v172
  v_mfma_f32_16x16x32_bf16 v[98:101], a[224:227], a[8:11], v[98:101]
  s_add_u32 s33, s25, 81920
  buffer_load_dwordx4 v2, s[4:7], s33 offen offset:0 lds
  v_mfma_f32_16x16x32_bf16 v[154:157], a[224:227], a[88:91], v[154:157]
  s_waitcnt lgkmcnt(4)
  ds_read_b128 a[248:251], v3 offset:38912
  v_mfma_f32_16x16x32_bf16 v[102:105], a[228:231], a[8:11], v[102:105]
  v_exp_f32 v83, v83
  v_mfma_f32_16x16x32_bf16 v[158:161], a[228:231], a[88:91], v[158:161]
  s_waitcnt lgkmcnt(4)
  ds_read_b128 a[252:255], v3 offset:39936
  v_fma_f32 v83, v83, v172, v172
  v_mfma_f32_16x16x32_bf16 v[98:101], a[232:235], a[12:15], v[98:101]
  buffer_load_dwordx4 v2, s[4:7], s33 offen offset:1024 lds
  v_mfma_f32_16x16x32_bf16 v[154:157], a[232:235], a[92:95], v[154:157]
  s_waitcnt lgkmcnt(4)
  ds_read_b128 a[224:227], v3 offset:40960
  v_mfma_f32_16x16x32_bf16 v[102:105], a[236:239], a[12:15], v[102:105]
  v_exp_f32 v84, v84
  v_mfma_f32_16x16x32_bf16 v[158:161], a[236:239], a[92:95], v[158:161]
  s_waitcnt lgkmcnt(4)
  ds_read_b128 a[228:231], v3 offset:41984
  v_fma_f32 v84, v84, v172, v172
  v_mfma_f32_16x16x32_bf16 v[98:101], a[240:243], a[16:19], v[98:101]
  buffer_load_dwordx4 v2, s[4:7], s33 offen offset:2048 lds
  v_mfma_f32_16x16x32_bf16 v[154:157], a[240:243], a[96:99], v[154:157]
  s_waitcnt lgkmcnt(4)
  ds_read_b128 a[232:235], v3 offset:43008
  v_mfma_f32_16x16x32_bf16 v[102:105], a[244:247], a[16:19], v[102:105]
  v_exp_f32 v85, v85
  v_mfma_f32_16x16x32_bf16 v[158:161], a[244:247], a[96:99], v[158:161]
  s_waitcnt lgkmcnt(4)
  ds_read_b128 a[236:239], v3 offset:44032
  v_fma_f32 v85, v85, v172, v172
  v_mfma_f32_16x16x32_bf16 v[98:101], a[248:251], a[20:23], v[98:101]
  buffer_load_dwordx4 v2, s[4:7], s33 offen offset:3072 lds
  v_mfma_f32_16x16x32_bf16 v[154:157], a[248:251], a[100:103], v[154:157]
  s_waitcnt lgkmcnt(4)
  ds_read_b128 a[240:243], v3 offset:45056
  v_mfma_f32_16x16x32_bf16 v[102:105], a[252:255], a[20:23], v[102:105]
  v_rcp_f32 v82, v82
  v_mfma_f32_16x16x32_bf16 v[158:161], a[252:255], a[100:103], v[158:161]
  s_waitcnt lgkmcnt(4)
  ds_read_b128 a[244:247], v3 offset:46080
  v_mul_f32 v86, v86, v82
  v_mfma_f32_16x16x32_bf16 v[98:101], a[224:227], a[24:27], v[98:101]
  s_add_u32 m0, s21, 65536
  v_rcp_f32 v83, v83
  v_mfma_f32_16x16x32_bf16 v[154:157], a[224:227], a[104:107], v[154:157]
  s_waitcnt lgkmcnt(4)
  ds_read_b128 a[248:251], v3 offset:47104
  v_mul_f32 v87, v87, v83
  v_mfma_f32_16x16x32_bf16 v[102:105], a[228:231], a[24:27], v[102:105]
  s_add_u32 s33, s25, 86016
  buffer_load_dwordx4 v2, s[4:7], s33 offen offset:0 lds
  v_mfma_f32_16x16x32_bf16 v[158:161], a[228:231], a[104:107], v[158:161]
  s_waitcnt lgkmcnt(4)
  ds_read_b128 a[252:255], v3 offset:48128
  v_cvt_pk_bf16_f32 v200, v86, v87
  v_mfma_f32_16x16x32_bf16 v[98:101], a[232:235], a[28:31], v[98:101]
  v_rcp_f32 v84, v84
  v_mfma_f32_16x16x32_bf16 v[154:157], a[232:235], a[108:111], v[154:157]
  s_waitcnt lgkmcnt(4)
  ds_read_b128 a[224:227], v3 offset:49152
  v_mul_f32 v88, v88, v84
  v_mfma_f32_16x16x32_bf16 v[102:105], a[236:239], a[28:31], v[102:105]
  v_rcp_f32 v85, v85
  v_mfma_f32_16x16x32_bf16 v[158:161], a[236:239], a[108:111], v[158:161]
  s_waitcnt lgkmcnt(4)
  ds_read_b128 a[228:231], v3 offset:50176
  v_mul_f32 v89, v89, v85
  v_mfma_f32_16x16x32_bf16 v[98:101], a[240:243], a[32:35], v[98:101]
  v_cvt_pk_bf16_f32 v201, v88, v89
  buffer_load_dword v253, v24, s[4:7], s60 offen sc1
  v_mfma_f32_16x16x32_bf16 v[154:157], a[240:243], a[112:115], v[154:157]
  s_waitcnt lgkmcnt(4)
  ds_read_b128 a[232:235], v3 offset:51200
  v_mul_f32 v138, v138, v175
  v_mfma_f32_16x16x32_bf16 v[102:105], a[244:247], a[32:35], v[102:105]
  v_exp_f32 v138, v138
  v_mfma_f32_16x16x32_bf16 v[158:161], a[244:247], a[112:115], v[158:161]
  s_waitcnt lgkmcnt(4)
  ds_read_b128 a[236:239], v3 offset:52224
  v_mul_f32 v139, v139, v175
  v_mfma_f32_16x16x32_bf16 v[98:101], a[248:251], a[36:39], v[98:101]
  v_exp_f32 v139, v139
  v_mfma_f32_16x16x32_bf16 v[154:157], a[248:251], a[116:119], v[154:157]
  s_waitcnt lgkmcnt(4)
  ds_read_b128 a[240:243], v3 offset:53248
  v_mul_f32 v140, v140, v175
  v_mfma_f32_16x16x32_bf16 v[102:105], a[252:255], a[36:39], v[102:105]
  v_exp_f32 v140, v140
  v_mfma_f32_16x16x32_bf16 v[158:161], a[252:255], a[116:119], v[158:161]
  s_waitcnt lgkmcnt(4)
  ds_read_b128 a[244:247], v3 offset:54272
  v_mul_f32 v141, v141, v175
  v_mfma_f32_16x16x32_bf16 v[98:101], a[224:227], a[40:43], v[98:101]
  v_exp_f32 v141, v141
  v_mfma_f32_16x16x32_bf16 v[154:157], a[224:227], a[120:123], v[154:157]
  s_waitcnt lgkmcnt(4)
  ds_read_b128 a[248:251], v3 offset:55296
  v_fma_f32 v138, v138, v173, v173
  v_mfma_f32_16x16x32_bf16 v[102:105], a[228:231], a[40:43], v[102:105]
  v_rcp_f32 v138, v138
  v_mfma_f32_16x16x32_bf16 v[158:161], a[228:231], a[120:123], v[158:161]
  s_waitcnt lgkmcnt(4)
  ds_read_b128 a[252:255], v3 offset:56320
  v_fma_f32 v139, v139, v173, v173
  v_mfma_f32_16x16x32_bf16 v[98:101], a[232:235], a[44:47], v[98:101]
  s_barrier
  v_fma_f32 v140, v140, v173, v173
  v_mfma_f32_16x16x32_bf16 v[154:157], a[232:235], a[124:127], v[154:157]
  s_waitcnt lgkmcnt(4)
  ds_read_b128 a[224:227], v3 offset:57344
  v_fma_f32 v141, v141, v173, v173
  v_mfma_f32_16x16x32_bf16 v[102:105], a[236:239], a[44:47], v[102:105]
  s_add_u32 m0, s21, 81920
  v_rcp_f32 v139, v139
  v_mfma_f32_16x16x32_bf16 v[158:161], a[236:239], a[124:127], v[158:161]
  s_waitcnt lgkmcnt(4)
  ds_read_b128 a[228:231], v3 offset:58368
  v_mul_f32 v142, v142, v138
  v_mfma_f32_16x16x32_bf16 v[98:101], a[240:243], a[48:51], v[98:101]
  s_add_u32 s33, s25, 102400
  buffer_load_dwordx4 v2, s[4:7], s33 offen offset:0 lds
  v_mfma_f32_16x16x32_bf16 v[154:157], a[240:243], a[128:131], v[154:157]
  s_waitcnt lgkmcnt(4)
  ds_read_b128 a[232:235], v3 offset:59392
  v_mul_f32 v143, v143, v139
  v_mfma_f32_16x16x32_bf16 v[102:105], a[244:247], a[48:51], v[102:105]
  buffer_load_dwordx4 v2, s[4:7], s33 offen offset:1024 lds
  v_mfma_f32_16x16x32_bf16 v[158:161], a[244:247], a[128:131], v[158:161]
  s_waitcnt lgkmcnt(4)
  ds_read_b128 a[236:239], v3 offset:60416
  v_cvt_pk_bf16_f32 v214, v142, v143
  v_mfma_f32_16x16x32_bf16 v[98:101], a[248:251], a[52:55], v[98:101]
  buffer_load_dwordx4 v2, s[4:7], s33 offen offset:2048 lds
  v_mfma_f32_16x16x32_bf16 v[154:157], a[248:251], a[132:135], v[154:157]
  s_waitcnt lgkmcnt(4)
  ds_read_b128 a[240:243], v3 offset:61440
  v_mfma_f32_16x16x32_bf16 v[102:105], a[252:255], a[52:55], v[102:105]
  buffer_load_dwordx4 v2, s[4:7], s33 offen offset:3072 lds
  v_mfma_f32_16x16x32_bf16 v[158:161], a[252:255], a[132:135], v[158:161]
  s_waitcnt lgkmcnt(4)
  ds_read_b128 a[244:247], v3 offset:62464
  v_mfma_f32_16x16x32_bf16 v[98:101], a[224:227], a[56:59], v[98:101]
  s_add_u32 m0, s21, 86016
  v_rcp_f32 v140, v140
  v_mfma_f32_16x16x32_bf16 v[154:157], a[224:227], a[136:139], v[154:157]
  s_waitcnt lgkmcnt(4)
  ds_read_b128 a[248:251], v3 offset:63488
  v_mul_f32 v144, v144, v140
  v_mfma_f32_16x16x32_bf16 v[102:105], a[228:231], a[56:59], v[102:105]
  s_add_u32 s33, s25, 106496
  buffer_load_dwordx4 v2, s[4:7], s33 offen offset:0 lds
  v_mfma_f32_16x16x32_bf16 v[158:161], a[228:231], a[136:139], v[158:161]
  s_waitcnt lgkmcnt(4)
  ds_read_b128 a[252:255], v3 offset:64512
  v_mfma_f32_16x16x32_bf16 v[98:101], a[232:235], a[60:63], v[98:101]
  v_rcp_f32 v141, v141
  v_mfma_f32_16x16x32_bf16 v[154:157], a[232:235], a[140:143], v[154:157]
  s_waitcnt lgkmcnt(4)
  ds_read_b128 a[224:227], v4 offset:0
  v_mul_f32 v145, v145, v141
  v_mfma_f32_16x16x32_bf16 v[102:105], a[236:239], a[60:63], v[102:105]
  v_cvt_pk_bf16_f32 v215, v144, v145
  v_mfma_f32_16x16x32_bf16 v[158:161], a[236:239], a[140:143], v[158:161]
  s_waitcnt lgkmcnt(4)
  ds_read_b128 a[228:231], v4 offset:1024
  v_mfma_f32_16x16x32_bf16 v[98:101], a[240:243], a[64:67], v[98:101]
  s_waitcnt vmcnt(5)
  v_cmp_eq_u32 vcc, 0, v253
  s_nop 1
  s_cbranch_vccz L_ok4e
  s_mov_b32 s37, 200000
L_sp4e:
  buffer_load_dword v253, v24, s[4:7], s60 offen offset:0 sc1
  s_waitcnt vmcnt(0)
  v_cmp_eq_u32 vcc, 0, v253
  s_nop 1
  s_cbranch_vccz L_ok4e
  s_sub_u32 s37, s37, 1
  s_cmp_lg_u32 s37, 0
  s_cbranch_scc1 L_sp4e
L_ok4e:
  v_mfma_f32_16x16x32_bf16 v[154:157], a[240:243], a[144:147], v[154:157]
  s_waitcnt lgkmcnt(4)
  ds_read_b128 a[232:235], v4 offset:2048
  v_mul_f32 v90, v90, v174
  v_mfma_f32_16x16x32_bf16 v[102:105], a[244:247], a[64:67], v[102:105]
  v_exp_f32 v90, v90
  v_mfma_f32_16x16x32_bf16 v[158:161], a[244:247], a[144:147], v[158:161]
  s_waitcnt lgkmcnt(4)
  ds_read_b128 a[236:239], v4 offset:3072
  v_mul_f32 v91, v91, v174
  v_mfma_f32_16x16x32_bf16 v[98:101], a[248:251], a[68:71], v[98:101]
  buffer_load_dwordx4 a[160:163], v2, s[4:7], s30 offen offset:0 sc1
  v_mfma_f32_16x16x32_bf16 v[154:157], a[248:251], a[148:151], v[154:157]
  s_waitcnt lgkmcnt(4)
  ds_read_b128 a[240:243], v4 offset:4096
  v_mul_f32 v92, v92, v174
  v_mfma_f32_16x16x32_bf16 v[102:105], a[252:255], a[68:71], v[102:105]
  buffer_load_dwordx4 a[164:167], v2, s[4:7], s30 offen offset:1024 sc1
  v_mfma_f32_16x16x32_bf16 v[158:161], a[252:255], a[148:151], v[158:161]
  s_waitcnt lgkmcnt(4)
  ds_read_b128 a[244:247], v4 offset:5120
  v_mul_f32 v93, v93, v174
  v_mfma_f32_16x16x32_bf16 v[98:101], a[224:227], a[72:75], v[98:101]
  buffer_load_dwordx4 a[168:171], v2, s[4:7], s30 offen offset:2048 sc1
  v_mfma_f32_16x16x32_bf16 v[154:157], a[224:227], a[152:155], v[154:157]
  s_waitcnt lgkmcnt(4)
  v_exp_f32 v91, v91
  v_mfma_f32_16x16x32_bf16 v[102:105], a[228:231], a[72:75], v[102:105]
  buffer_load_dwordx4 a[172:175], v2, s[4:7], s30 offen offset:3072 sc1
  v_mfma_f32_16x16x32_bf16 v[158:161], a[228:231], a[152:155], v[158:161]
  s_waitcnt lgkmcnt(3)
  v_exp_f32 v92, v92
  v_mfma_f32_16x16x32_bf16 v[98:101], a[232:235], a[76:79], v[98:101]
  s_add_u32 s32, s30, 4096
  buffer_load_dwordx4 a[176:179], v2, s[4:7], s32 offen offset:0 sc1
  v_mfma_f32_16x16x32_bf16 v[154:157], a[232:235], a[156:159], v[154:157]
  s_waitcnt lgkmcnt(2)
  v_exp_f32 v93, v93
  v_mfma_f32_16x16x32_bf16 v[102:105], a[236:239], a[76:79], v[102:105]
  buffer_load_dwordx4 a[180:183], v2, s[4:7], s32 offen offset:1024 sc1
  v_mfma_f32_16x16x32_bf16 v[158:161], a[236:239], a[156:159], v[158:161]
  s_waitcnt lgkmcnt(1)
  v_fma_f32 v90, v90, v172, v172
  v_fma_f32 v91, v91, v172, v172
  v_mfma_f32_16x16x32_bf16 v[98:101], a[240:243], v[176:179], v[98:101]
  buffer_load_dwordx4 a[184:187], v2, s[4:7], s32 offen offset:2048 sc1
  v_mfma_f32_16x16x32_bf16 v[154:157], a[240:243], v[180:183], v[154:157]
  s_waitcnt lgkmcnt(0)
  v_rcp_f32 v90, v90
  v_mfma_f32_16x16x32_bf16 v[102:105], a[244:247], v[176:179], v[102:105]
  buffer_load_dwordx4 a[188:191], v2, s[4:7], s32 offen offset:3072 sc1
  v_mfma_f32_16x16x32_bf16 v[158:161], a[244:247], v[180:183], v[158:161]
  v_rcp_f32 v91, v91
  s_barrier
  v_fma_f32 v92, v92, v172, v172
  v_fma_f32 v93, v93, v172, v172
  v_rcp_f32 v92, v92
  v_rcp_f32 v93, v93
  v_mul_f32 v94, v94, v90
  v_mul_f32 v95, v95, v91
  v_mul_f32 v96, v96, v92
  v_mul_f32 v97, v97, v93
  v_cvt_pk_bf16_f32 v202, v94, v95
  v_cvt_pk_bf16_f32 v203, v96, v97
  buffer_store_dwordx4 v[200:203], v2, s[4:7], s36 offen offset:0 sc1
  v_mul_f32 v146, v146, v175
  v_mul_f32 v147, v147, v175
  v_mul_f32 v148, v148, v175
  v_mul_f32 v149, v149, v175
  v_exp_f32 v146, v146
  v_exp_f32 v147, v147
  v_exp_f32 v148, v148
  v_exp_f32 v149, v149
  v_fma_f32 v146, v146, v173, v173
  v_fma_f32 v147, v147, v173, v173
  v_fma_f32 v148, v148, v173, v173
  v_fma_f32 v149, v149, v173, v173
  v_rcp_f32 v146, v146
  v_rcp_f32 v147, v147
  v_rcp_f32 v148, v148
  v_rcp_f32 v149, v149
  v_mul_f32 v150, v150, v146
  v_mul_f32 v151, v151, v147
  v_mul_f32 v152, v152, v148
  v_mul_f32 v153, v153, v149
  v_cvt_pk_bf16_f32 v216, v150, v151
  v_cvt_pk_bf16_f32 v217, v152, v153
  buffer_store_dwordx4 v[214:217], v2, s[4:7], s61 offen offset:0 sc1
  s_add_u32 s36, s36, s62
  s_add_u32 s61, s61, s62
  s_add_u32 s32, s30, 8192
  buffer_load_dwordx4 a[192:195], v2, s[4:7], s32 offen offset:0 sc1
  buffer_load_dwordx4 a[196:199], v2, s[4:7], s32 offen offset:1024 sc1
  v_mul_f32 v98, v98, v174
  v_mul_f32 v99, v99, v174
  v_mul_f32 v100, v100, v174
  v_mul_f32 v101, v101, v174
  v_mul_f32 v154, v154, v175
  v_mul_f32 v155, v155, v175
  v_mul_f32 v156, v156, v175
  v_mul_f32 v157, v157, v175
  v_exp_f32 v98, v98
  v_exp_f32 v99, v99
  v_exp_f32 v100, v100
  v_exp_f32 v101, v101
  v_exp_f32 v154, v154
  v_exp_f32 v155, v155
  v_exp_f32 v156, v156
  v_exp_f32 v157, v157
  v_fma_f32 v98, v98, v172, v172
  v_fma_f32 v99, v99, v172, v172
  v_fma_f32 v100, v100, v172, v172
  v_fma_f32 v101, v101, v172, v172
  v_fma_f32 v154, v154, v173, v173
  v_fma_f32 v155, v155, v173, v173
  v_fma_f32 v156, v156, v173, v173
  v_fma_f32 v157, v157, v173, v173
  v_rcp_f32 v98, v98
  v_rcp_f32 v99, v99
  v_rcp_f32 v100, v100
  v_rcp_f32 v101, v101
  v_rcp_f32 v154, v154
  v_rcp_f32 v155, v155
  v_rcp_f32 v156, v156
  v_rcp_f32 v157, v157
  v_mul_f32 v102, v102, v98
  v_mul_f32 v103, v103, v99
  v_mul_f32 v104, v104, v100
  v_mul_f32 v105, v105, v101
  v_mul_f32 v158, v158, v154
  v_mul_f32 v159, v159, v155
  v_mul_f32 v160, v160, v156
  v_mul_f32 v161, v161, v157
  v_cvt_pk_bf16_f32 v204, v102, v103
  v_cvt_pk_bf16_f32 v205, v104, v105
  buffer_store_dwordx2 v[204:205], v28, s[4:7], s36 offen sc1
  v_cvt_pk_bf16_f32 v218, v158, v159
  v_cvt_pk_bf16_f32 v219, v160, v161
  buffer_store_dwordx2 v[218:219], v28, s[4:7], s61 offen sc1
  s_barrier
  ds_read_b128 a[224:227], v4 offset:12288
  ds_read_b128 a[228:231], v4 offset:13312
  ds_read_b128 a[232:235], v4 offset:14336
  ds_read_b128 a[236:239], v4 offset:15360
  ds_read_b128 a[240:243], v4 offset:16384
  ds_read_b128 a[244:247], v4 offset:17408
  s_waitcnt vmcnt(13) lgkmcnt(5)
  v_mfma_f32_16x16x32_bf16 v[220:223], a[224:227], a[160:163], 0
  s_waitcnt lgkmcnt(3)
  ds_read_b128 a[248:251], v4 offset:18432
  buffer_load_dwordx4 a[0:3], v2, s[4:7], s32 offen offset:2048 sc1
  v_mfma_f32_16x16x32_bf16 v[224:227], a[228:231], a[160:163], 0
  ds_read_b128 a[252:255], v4 offset:19456
  v_mfma_f32_16x16x32_bf16 v[228:231], a[232:235], a[160:163], 0
  s_waitcnt lgkmcnt(3)
  ds_read_b128 a[224:227], v4 offset:20480
  v_mfma_f32_16x16x32_bf16 v[232:235], a[236:239], a[160:163], 0
  s_add_u32 m0, s21, 102400
  ds_read_b128 a[228:231], v4 offset:21504
  v_mfma_f32_16x16x32_bf16 v[236:239], a[240:243], a[160:163], 0
  s_waitcnt vmcnt(13) lgkmcnt(3)
  ds_read_b128 a[232:235], v4 offset:22528
  v_mfma_f32_16x16x32_bf16 v[220:223], a[244:247], a[164:167], v[220:223]
  s_add_u32 s33, s25, 122880
  ds_read_b128 a[236:239], v4 offset:23552
  buffer_load_dwordx4 v2, s[4:7], s33 offen offset:0 lds
  v_mfma_f32_16x16x32_bf16 v[224:227], a[248:251], a[164:167], v[224:227]
  s_waitcnt lgkmcnt(3)
  ds_read_b128 a[240:243], v4 offset:24576
  v_mfma_f32_16x16x32_bf16 v[228:231], a[252:255], a[164:167], v[228:231]
  ds_read_b128 a[244:247], v4 offset:25600
  buffer_load_dwordx4 a[4:7], v2, s[4:7], s32 offen offset:3072 sc1
  v_mfma_f32_16x16x32_bf16 v[232:235], a[224:227], a[164:167], v[232:235]
  s_waitcnt lgkmcnt(3)
  ds_read_b128 a[248:251], v4 offset:26624
  v_mfma_f32_16x16x32_bf16 v[236:239], a[228:231], a[164:167], v[236:239]
  s_waitcnt vmcnt(14) lgkmcnt(3)
  ds_read_b128 a[252:255], v4 offset:27648
  buffer_load_dwordx4 v2, s[4:7], s33 offen offset:1024 lds
  v_mfma_f32_16x16x32_bf16 v[220:223], a[232:235], a[168:171], v[220:223]
  ds_read_b128 a[224:227], v4 offset:28672
  v_mfma_f32_16x16x32_bf16 v[224:227], a[236:239], a[168:171], v[224:227]
  s_waitcnt lgkmcnt(3)
  ds_read_b128 a[228:231], v4 offset:29696
  v_mfma_f32_16x16x32_bf16 v[228:231], a[240:243], a[168:171], v[228:231]
  s_add_u32 s32, s30, 12288
  ds_read_b128 a[232:235], v4 offset:30720
  buffer_load_dwordx4 a[8:11], v2, s[4:7], s32 offen offset:0 sc1
  v_mfma_f32_16x16x32_bf16 v[232:235], a[244:247], a[168:171], v[232:235]
  s_waitcnt lgkmcnt(3)
  ds_read_b128 a[236:239], v4 offset:31744
  v_mfma_f32_16x16x32_bf16 v[236:239], a[248:251], a[168:171], v[236:239]
  s_barrier
  s_waitcnt vmcnt(15) lgkmcnt(3)
  ds_read_b128 a[240:243], v2 offset:0
  buffer_load_dwordx4 v2, s[4:7], s33 offen offset:2048 lds
  v_mfma_f32_16x16x32_bf16 v[220:223], a[252:255], a[172:175], v[220:223]
  ds_read_b128 a[244:247], v2 offset:1024
  v_mfma_f32_16x16x32_bf16 v[224:227], a[224:227], a[172:175], v[224:227]
  s_waitcnt lgkmcnt(3)
  ds_read_b128 a[248:251], v2 offset:2048
  buffer_load_dwordx4 a[12:15], v2, s[4:7], s32 offen offset:1024 sc1
  v_mfma_f32_16x16x32_bf16 v[228:231], a[228:231], a[172:175], v[228:231]
  ds_read_b128 a[252:255], v2 offset:3072
  v_mfma_f32_16x16x32_bf16 v[232:235], a[232:235], a[172:175], v[232:235]
  s_waitcnt lgkmcnt(3)
  ds_read_b128 a[224:227], v2 offset:4096
  buffer_load_dwordx4 v2, s[4:7], s33 offen offset:3072 lds
  v_mfma_f32_16x16x32_bf16 v[236:239], a[236:239], a[172:175], v[236:239]
  s_waitcnt vmcnt(17) lgkmcnt(3)
  ds_read_b128 a[228:231], v2 offset:5120
  v_mfma_f32_16x16x32_bf16 v[220:223], a[240:243], a[176:179], v[220:223]
  ds_read_b128 a[232:235], v2 offset:6144
  buffer_load_dwordx4 a[16:19], v2, s[4:7], s32 offen offset:2048 sc1
  v_mfma_f32_16x16x32_bf16 v[224:227], a[244:247], a[176:179], v[224:227]
  s_waitcnt lgkmcnt(3)
  ds_read_b128 a[236:239], v2 offset:7168
  v_mfma_f32_16x16x32_bf16 v[228:231], a[248:251], a[176:179], v[228:231]
  s_add_u32 m0, s21, 106496
  ds_read_b128 a[240:243], v2 offset:8192
  v_mfma_f32_16x16x32_bf16 v[232:235], a[252:255], a[176:179], v[232:235]
  s_waitcnt lgkmcnt(3)
  ds_read_b128 a[244:247], v2 offset:9216
  v_mfma_f32_16x16x32_bf16 v[236:239], a[224:227], a[176:179], v[236:239]
  s_waitcnt vmcnt(17) lgkmcnt(3)
  ds_read_b128 a[248:251], v2 offset:10240
  v_mfma_f32_16x16x32_bf16 v[220:223], a[228:231], a[180:183], v[220:223]
  s_add_u32 s33, s25, 126976
  ds_read_b128 a[252:255], v2 offset:11264
  buffer_load_dwordx4 v2, s[4:7], s33 offen offset:0 lds
  v_mfma_f32_16x16x32_bf16 v[224:227], a[232:235], a[180:183], v[224:227]
  s_waitcnt lgkmcnt(3)
  ds_read_b128 a[224:227], v2 offset:12288
  v_mfma_f32_16x16x32_bf16 v[228:231], a[236:239], a[180:183], v[228:231]
  s_waitcnt vmcnt(10)
  ds_read_b128 a[228:231], v2 offset:13312
  buffer_load_dwordx4 a[20:23], v2, s[4:7], s32 offen offset:3072 sc1
  v_mfma_f32_16x16x32_bf16 v[232:235], a[240:243], a[180:183], v[232:235]
  s_waitcnt lgkmcnt(3)
  ds_read_b128 a[232:235], v2 offset:14336
  s_barrier
  v_mfma_f32_16x16x32_bf16 v[236:239], a[244:247], a[180:183], v[236:239]
  s_waitcnt lgkmcnt(3)
  ds_read_b128 a[236:239], v2 offset:15360
  buffer_store_dword v25, v22, s[4:7], s34 offen offset:64 sc1
  v_mfma_f32_16x16x32_bf16 v[220:223], a[248:251], a[184:187], v[220:223]
  s_add_u32 m0, s21, 122880
  ds_read_b128 a[240:243], v2 offset:16384
  v_mfma_f32_16x16x32_bf16 v[224:227], a[252:255], a[184:187], v[224:227]
  s_waitcnt lgkmcnt(3)
  ds_read_b128 a[244:247], v2 offset:17408
  v_mfma_f32_16x16x32_bf16 v[228:231], a[224:227], a[184:187], v[228:231]
  s_add_u32 s33, s25, 143360
  ds_read_b128 a[248:251], v2 offset:18432
  buffer_load_dwordx4 v2, s[4:7], s33 offen offset:0 lds
  v_mfma_f32_16x16x32_bf16 v[232:235], a[228:231], a[184:187], v[232:235]
  s_waitcnt lgkmcnt(3)
  ds_read_b128 a[252:255], v2 offset:19456
  v_mfma_f32_16x16x32_bf16 v[236:239], a[232:235], a[184:187], v[236:239]
  s_barrier
  s_waitcnt lgkmcnt(3)
  ds_read_b128 a[224:227], v2 offset:20480
  v_mfma_f32_16x16x32_bf16 v[220:223], a[236:239], a[188:191], v[220:223]
  s_add_u32 s32, s30, 16384
  ds_read_b128 a[228:231], v2 offset:21504
  buffer_load_dwordx4 a[24:27], v2, s[4:7], s32 offen offset:0 sc1
  v_mfma_f32_16x16x32_bf16 v[224:227], a[240:243], a[188:191], v[224:227]
  s_waitcnt lgkmcnt(3)
  ds_read_b128 a[232:235], v2 offset:22528
  v_mfma_f32_16x16x32_bf16 v[228:231], a[244:247], a[188:191], v[228:231]
  ds_read_b128 a[236:239], v2 offset:23552
  buffer_load_dwordx4 a[28:31], v2, s[4:7], s32 offen offset:1024 sc1
  v_mfma_f32_16x16x32_bf16 v[232:235], a[248:251], a[188:191], v[232:235]
  s_waitcnt lgkmcnt(3)
  ds_read_b128 a[240:243], v2 offset:24576
  v_mfma_f32_16x16x32_bf16 v[236:239], a[252:255], a[188:191], v[236:239]
  s_waitcnt lgkmcnt(3)
  ds_read_b128 a[244:247], v2 offset:25600
  buffer_load_dwordx4 v2, s[4:7], s33 offen offset:1024 lds
  v_mfma_f32_16x16x32_bf16 v[220:223], a[224:227], a[192:195], v[220:223]
  ds_read_b128 a[248:251], v2 offset:26624
  v_mfma_f32_16x16x32_bf16 v[224:227], a[228:231], a[192:195], v[224:227]
  s_waitcnt lgkmcnt(3)
  ds_read_b128 a[252:255], v2 offset:27648
  buffer_load_dwordx4 a[32:35], v2, s[4:7], s32 offen offset:2048 sc1
  v_mfma_f32_16x16x32_bf16 v[228:231], a[232:235], a[192:195], v[228:231]
  ds_read_b128 a[224:227], v2 offset:28672
  v_mfma_f32_16x16x32_bf16 v[232:235], a[236:239], a[192:195], v[232:235]
  s_waitcnt lgkmcnt(3)
  ds_read_b128 a[228:231], v2 offset:29696
  buffer_load_dwordx4 v2, s[4:7], s33 offen offset:2048 lds
  v_mfma_f32_16x16x32_bf16 v[236:239], a[240:243], a[192:195], v[236:239]
  s_waitcnt lgkmcnt(3)
  ds_read_b128 a[232:235], v2 offset:30720
  v_mfma_f32_16x16x32_bf16 v[220:223], a[244:247], a[196:199], v[220:223]
  ds_read_b128 a[236:239], v2 offset:31744
  buffer_load_dwordx4 a[36:39], v2, s[4:7], s32 offen offset:3072 sc1
  v_mfma_f32_16x16x32_bf16 v[224:227], a[248:251], a[196:199], v[224:227]
  s_waitcnt lgkmcnt(3)
  ds_read_b128 a[240:243], v2 offset:32768
  v_mfma_f32_16x16x32_bf16 v[228:231], a[252:255], a[196:199], v[228:231]
  ds_read_b128 a[244:247], v2 offset:33792
  buffer_load_dwordx4 v2, s[4:7], s33 offen offset:3072 lds
  v_mfma_f32_16x16x32_bf16 v[232:235], a[224:227], a[196:199], v[232:235]
  s_waitcnt lgkmcnt(3)
  ds_read_b128 a[248:251], v2 offset:34816
  v_mfma_f32_16x16x32_bf16 v[236:239], a[228:231], a[196:199], v[236:239]
  s_waitcnt vmcnt(19) lgkmcnt(3)
  ds_read_b128 a[252:255], v2 offset:35840
  v_mfma_f32_16x16x32_bf16 v[220:223], a[232:235], a[0:3], v[220:223]
  s_add_u32 m0, s21, 126976
  ds_read_b128 a[224:227], v2 offset:36864
  v_mfma_f32_16x16x32_bf16 v[224:227], a[236:239], a[0:3], v[224:227]
  s_waitcnt lgkmcnt(3)
  ds_read_b128 a[228:231], v2 offset:37888
  v_mfma_f32_16x16x32_bf16 v[228:231], a[240:243], a[0:3], v[228:231]
  s_add_u32 s33, s25, 147456
  ds_read_b128 a[232:235], v2 offset:38912
  buffer_load_dwordx4 v2, s[4:7], s33 offen offset:0 lds
  v_mfma_f32_16x16x32_bf16 v[232:235], a[244:247], a[0:3], v[232:235]
  s_waitcnt lgkmcnt(3)
  ds_read_b128 a[236:239], v2 offset:39936
  v_mfma_f32_16x16x32_bf16 v[236:239], a[248:251], a[0:3], v[236:239]
  s_barrier
  s_waitcnt vmcnt(18) lgkmcnt(3)
  ds_read_b128 a[240:243], v2 offset:40960
  v_mfma_f32_16x16x32_bf16 v[220:223], a[252:255], a[4:7], v[220:223]
  s_add_u32 s32, s30, 20480
  ds_read_b128 a[244:247], v2 offset:41984
  buffer_load_dwordx4 a[40:43], v2, s[4:7], s32 offen offset:0 sc1
  v_mfma_f32_16x16x32_bf16 v[224:227], a[224:227], a[4:7], v[224:227]
  s_waitcnt lgkmcnt(3)
  ds_read_b128 a[248:251], v2 offset:43008
  v_mfma_f32_16x16x32_bf16 v[228:231], a[228:231], a[4:7], v[228:231]
  ds_read_b128 a[252:255], v2 offset:44032
  buffer_load_dwordx4 a[44:47], v2, s[4:7], s32 offen offset:1024 sc1
  v_mfma_f32_16x16x32_bf16 v[232:235], a[232:235], a[4:7], v[232:235]
  s_waitcnt lgkmcnt(3)
  ds_read_b128 a[224:227], v2 offset:45056
  v_mfma_f32_16x16x32_bf16 v[236:239], a[236:239], a[4:7], v[236:239]
  s_waitcnt vmcnt(18) lgkmcnt(3)
  ds_read_b128 a[228:231], v2 offset:46080
  v_mfma_f32_16x16x32_bf16 v[220:223], a[240:243], a[8:11], v[220:223]
  s_add_u32 m0, s21, 143360
  ds_read_b128 a[232:235], v2 offset:47104
  v_mfma_f32_16x16x32_bf16 v[224:227], a[244:247], a[8:11], v[224:227]
  s_waitcnt lgkmcnt(3)
  ds_read_b128 a[236:239], v2 offset:48128
  v_mfma_f32_16x16x32_bf16 v[228:231], a[248:251], a[8:11], v[228:231]
  s_add_u32 s33, s25, 163840
  ds_read_b128 a[240:243], v2 offset:49152
  buffer_load_dwordx4 v2, s[4:7], s33 offen offset:0 lds
  v_mfma_f32_16x16x32_bf16 v[232:235], a[252:255], a[8:11], v[232:235]
  s_waitcnt lgkmcnt(3)
  ds_read_b128 a[244:247], v2 offset:50176
  v_mfma_f32_16x16x32_bf16 v[236:239], a[224:227], a[8:11], v[236:239]
  s_waitcnt vmcnt(17) lgkmcnt(3)
  ds_read_b128 a[248:251], v2 offset:51200
  buffer_load_dwordx4 a[48:51], v2, s[4:7], s32 offen offset:2048 sc1
  v_mfma_f32_16x16x32_bf16 v[220:223], a[228:231], a[12:15], v[220:223]
  ds_read_b128 a[252:255], v2 offset:52224
  v_mfma_f32_16x16x32_bf16 v[224:227], a[232:235], a[12:15], v[224:227]
  s_waitcnt lgkmcnt(3)
  ds_read_b128 a[224:227], v2 offset:53248
  buffer_load_dwordx4 a[52:55], v2, s[4:7], s32 offen offset:3072 sc1
  v_mfma_f32_16x16x32_bf16 v[228:231], a[236:239], a[12:15], v[228:231]
  ds_read_b128 a[228:231], v2 offset:54272
  v_mfma_f32_16x16x32_bf16 v[232:235], a[240:243], a[12:15], v[232:235]
  s_waitcnt lgkmcnt(3)
  ds_read_b128 a[232:235], v2 offset:55296
  buffer_load_dwordx4 v2, s[4:7], s33 offen offset:1024 lds
  v_mfma_f32_16x16x32_bf16 v[236:239], a[244:247], a[12:15], v[236:239]
  s_waitcnt vmcnt(18) lgkmcnt(3)
  ds_read_b128 a[236:239], v2 offset:56320
  v_mfma_f32_16x16x32_bf16 v[220:223], a[248:251], a[16:19], v[220:223]
  s_add_u32 s32, s30, 24576
  ds_read_b128 a[240:243], v2 offset:57344
  buffer_load_dwordx4 a[56:59], v2, s[4:7], s32 offen offset:0 sc1
  v_mfma_f32_16x16x32_bf16 v[224:227], a[252:255], a[16:19], v[224:227]
  s_waitcnt lgkmcnt(3)
  ds_read_b128 a[244:247], v2 offset:58368
  v_mfma_f32_16x16x32_bf16 v[228:231], a[224:227], a[16:19], v[228:231]
  ds_read_b128 a[248:251], v2 offset:59392
  buffer_load_dwordx4 v2, s[4:7], s33 offen offset:2048 lds
  v_mfma_f32_16x16x32_bf16 v[232:235], a[228:231], a[16:19], v[232:235]
  s_waitcnt lgkmcnt(3)
  ds_read_b128 a[252:255], v2 offset:60416
  v_mfma_f32_16x16x32_bf16 v[236:239], a[232:235], a[16:19], v[236:239]
  s_barrier
  s_waitcnt vmcnt(18) lgkmcnt(3)
  ds_read_b128 a[224:227], v2 offset:61440
  buffer_load_dwordx4 v2, s[4:7], s33 offen offset:3072 lds
  v_mfma_f32_16x16x32_bf16 v[220:223], a[236:239], a[20:23], v[220:223]
  ds_read_b128 a[228:231], v2 offset:62464
  v_mfma_f32_16x16x32_bf16 v[224:227], a[240:243], a[20:23], v[224:227]
  s_waitcnt lgkmcnt(3)
  ds_read_b128 a[232:235], v2 offset:63488
  buffer_load_dwordx4 a[60:63], v2, s[4:7], s32 offen offset:1024 sc1
  v_mfma_f32_16x16x32_bf16 v[228:231], a[244:247], a[20:23], v[228:231]
  ds_read_b128 a[236:239], v2 offset:64512
  v_mfma_f32_16x16x32_bf16 v[232:235], a[248:251], a[20:23], v[232:235]
  s_waitcnt lgkmcnt(3)
  ds_read_b128 a[240:243], v3 offset:0
  v_mfma_f32_16x16x32_bf16 v[236:239], a[252:255], a[20:23], v[236:239]
  s_waitcnt vmcnt(17) lgkmcnt(3)
  ds_read_b128 a[244:247], v3 offset:1024
  v_mfma_f32_16x16x32_bf16 v[220:223], a[224:227], a[24:27], v[220:223]
  s_add_u32 m0, s21, 147456
  ds_read_b128 a[248:251], v3 offset:2048
  v_mfma_f32_16x16x32_bf16 v[224:227], a[228:231], a[24:27], v[224:227]
  s_waitcnt lgkmcnt(3)
  ds_read_b128 a[252:255], v3 offset:3072
  v_mfma_f32_16x16x32_bf16 v[228:231], a[232:235], a[24:27], v[228:231]
  s_add_u32 s33, s25, 167936
  ds_read_b128 a[224:227], v3 offset:4096
  buffer_load_dwordx4 v2, s[4:7], s33 offen offset:0 lds
  v_mfma_f32_16x16x32_bf16 v[232:235], a[236:239], a[24:27], v[232:235]
  s_waitcnt lgkmcnt(3)
  ds_read_b128 a[228:231], v3 offset:5120
  v_mfma_f32_16x16x32_bf16 v[236:239], a[240:243], a[24:27], v[236:239]
  s_waitcnt vmcnt(17) lgkmcnt(3)
  ds_read_b128 a[232:235], v3 offset:6144
  buffer_load_dwordx4 a[64:67], v2, s[4:7], s32 offen offset:2048 sc1
  v_mfma_f32_16x16x32_bf16 v[220:223], a[244:247], a[28:31], v[220:223]
  ds_read_b128 a[236:239], v3 offset:7168
  v_mfma_f32_16x16x32_bf16 v[224:227], a[248:251], a[28:31], v[224:227]
  s_waitcnt lgkmcnt(3)
  ds_read_b128 a[240:243], v3 offset:8192
  buffer_load_dwordx4 a[68:71], v2, s[4:7], s32 offen offset:3072 sc1
  v_mfma_f32_16x16x32_bf16 v[228:231], a[252:255], a[28:31], v[228:231]
  ds_read_b128 a[244:247], v3 offset:9216
  v_mfma_f32_16x16x32_bf16 v[232:235], a[224:227], a[28:31], v[232:235]
  s_waitcnt lgkmcnt(3)
  ds_read_b128 a[248:251], v3 offset:10240
  v_mfma_f32_16x16x32_bf16 v[236:239], a[228:231], a[28:31], v[236:239]
  s_waitcnt vmcnt(17) lgkmcnt(3)
  ds_read_b128 a[252:255], v3 offset:11264
  v_mfma_f32_16x16x32_bf16 v[220:223], a[232:235], a[32:35], v[220:223]
  s_add_u32 m0, s21, 0
  ds_read_b128 a[224:227], v3 offset:12288
  v_mfma_f32_16x16x32_bf16 v[224:227], a[236:239], a[32:35], v[224:227]
  s_waitcnt lgkmcnt(3)
  ds_read_b128 a[228:231], v3 offset:13312
  v_mfma_f32_16x16x32_bf16 v[228:231], a[240:243], a[32:35], v[228:231]
  s_add_u32 s33, s25, 184320
  ds_read_b128 a[232:235], v3 offset:14336
  buffer_load_dwordx4 v2, s[4:7], s33 offen offset:0 lds
  v_mfma_f32_16x16x32_bf16 v[232:235], a[244:247], a[32:35], v[232:235]
  s_waitcnt lgkmcnt(3)
  ds_read_b128 a[236:239], v3 offset:15360
  buffer_load_dword v253, v24, s[4:7], s60 offen offset:64 sc1
  v_mfma_f32_16x16x32_bf16 v[236:239], a[248:251], a[32:35], v[236:239]
  s_barrier
  s_waitcnt vmcnt(17) lgkmcnt(3)
  ds_read_b128 a[240:243], v3 offset:16384
  v_mfma_f32_16x16x32_bf16 v[220:223], a[252:255], a[36:39], v[220:223]
  s_add_u32 s32, s30, 28672
  ds_read_b128 a[244:247], v3 offset:17408
  buffer_load_dwordx4 a[72:75], v2, s[4:7], s32 offen offset:0 sc1
  v_mfma_f32_16x16x32_bf16 v[224:227], a[224:227], a[36:39], v[224:227]
  s_waitcnt lgkmcnt(3)
  ds_read_b128 a[248:251], v3 offset:18432
  v_mfma_f32_16x16x32_bf16 v[228:231], a[228:231], a[36:39], v[228:231]
  ds_read_b128 a[252:255], v3 offset:19456
  buffer_load_dwordx4 a[76:79], v2, s[4:7], s32 offen offset:1024 sc1
  v_mfma_f32_16x16x32_bf16 v[232:235], a[232:235], a[36:39], v[232:235]
  s_waitcnt lgkmcnt(3)
  ds_read_b128 a[224:227], v3 offset:20480
  v_mfma_f32_16x16x32_bf16 v[236:239], a[236:239], a[36:39], v[236:239]
  s_waitcnt vmcnt(16) lgkmcnt(3)
  ds_read_b128 a[228:231], v3 offset:21504
  buffer_load_dwordx4 v2, s[4:7], s33 offen offset:1024 lds
  v_mfma_f32_16x16x32_bf16 v[220:223], a[240:243], a[40:43], v[220:223]
  ds_read_b128 a[232:235], v3 offset:22528
  v_mfma_f32_16x16x32_bf16 v[224:227], a[244:247], a[40:43], v[224:227]
  s_waitcnt lgkmcnt(3)
  ds_read_b128 a[236:239], v3 offset:23552
  buffer_load_dwordx4 a[80:83], v2, s[4:7], s32 offen offset:2048 sc1
  v_mfma_f32_16x16x32_bf16 v[228:231], a[248:251], a[40:43], v[228:231]
  ds_read_b128 a[240:243], v3 offset:24576
  v_mfma_f32_16x16x32_bf16 v[232:235], a[252:255], a[40:43], v[232:235]
  s_waitcnt lgkmcnt(3)
  ds_read_b128 a[244:247], v3 offset:25600
  buffer_load_dwordx4 v2, s[4:7], s33 offen offset:2048 lds
  v_mfma_f32_16x16x32_bf16 v[236:239], a[224:227], a[40:43], v[236:239]
  s_waitcnt vmcnt(18) lgkmcnt(3)
  ds_read_b128 a[248:251], v3 offset:26624
  v_mfma_f32_16x16x32_bf16 v[220:223], a[228:231], a[44:47], v[220:223]
  ds_read_b128 a[252:255], v3 offset:27648
  buffer_load_dwordx4 a[84:87], v2, s[4:7], s32 offen offset:3072 sc1
  v_mfma_f32_16x16x32_bf16 v[224:227], a[232:235], a[44:47], v[224:227]
  s_waitcnt lgkmcnt(3)
  ds_read_b128 a[224:227], v3 offset:28672
  v_mfma_f32_16x16x32_bf16 v[228:231], a[236:239], a[44:47], v[228:231]
  ds_read_b128 a[228:231], v3 offset:29696
  buffer_load_dwordx4 v2, s[4:7], s33 offen offset:3072 lds
  v_mfma_f32_16x16x32_bf16 v[232:235], a[240:243], a[44:47], v[232:235]
  s_waitcnt lgkmcnt(3)
  ds_read_b128 a[232:235], v3 offset:30720
  v_mfma_f32_16x16x32_bf16 v[236:239], a[244:247], a[44:47], v[236:239]
  s_waitcnt vmcnt(18) lgkmcnt(3)
  ds_read_b128 a[236:239], v3 offset:31744
  v_mfma_f32_16x16x32_bf16 v[220:223], a[248:251], a[48:51], v[220:223]
  s_add_u32 m0, s21, 4096
  ds_read_b128 a[240:243], v3 offset:32768
  v_mfma_f32_16x16x32_bf16 v[224:227], a[252:255], a[48:51], v[224:227]
  s_waitcnt lgkmcnt(3)
  ds_read_b128 a[244:247], v3 offset:33792
  v_mfma_f32_16x16x32_bf16 v[228:231], a[224:227], a[48:51], v[228:231]
  s_add_u32 s33, s25, 188416
  ds_read_b128 a[248:251], v3 offset:34816
  buffer_load_dwordx4 v2, s[4:7], s33 offen offset:0 lds
  v_mfma_f32_16x16x32_bf16 v[232:235], a[228:231], a[48:51], v[232:235]
  s_waitcnt lgkmcnt(3)
  ds_read_b128 a[252:255], v3 offset:35840
  v_mfma_f32_16x16x32_bf16 v[236:239], a[232:235], a[48:51], v[236:239]
  s_barrier
  s_waitcnt vmcnt(18) lgkmcnt(3)
  ds_read_b128 a[224:227], v3 offset:36864
  v_mfma_f32_16x16x32_bf16 v[220:223], a[236:239], a[52:55], v[220:223]
  s_add_u32 m0, s21, 20480
  ds_read_b128 a[228:231], v3 offset:37888
  v_mfma_f32_16x16x32_bf16 v[224:227], a[240:243], a[52:55], v[224:227]
  s_waitcnt lgkmcnt(3)
  ds_read_b128 a[232:235], v3 offset:38912
  v_mfma_f32_16x16x32_bf16 v[228:231], a[244:247], a[52:55], v[228:231]
  s_add_u32 s33, s25, 204800
  ds_read_b128 a[236:239], v3 offset:39936
  buffer_load_dwordx4 v2, s[4:7], s33 offen offset:0 lds
  v_mfma_f32_16x16x32_bf16 v[232:235], a[248:251], a[52:55], v[232:235]
  s_waitcnt lgkmcnt(3)
  ds_read_b128 a[240:243], v3 offset:40960
  v_mfma_f32_16x16x32_bf16 v[236:239], a[252:255], a[52:55], v[236:239]
  s_waitcnt vmcnt(17) lgkmcnt(3)
  ds_read_b128 a[244:247], v3 offset:41984
  buffer_load_dwordx4 v2, s[4:7], s33 offen offset:1024 lds
  v_mfma_f32_16x16x32_bf16 v[220:223], a[224:227], a[56:59], v[220:223]
  s_waitcnt vmcnt(10)
  ds_read_b128 a[248:251], v3 offset:43008
  v_cmp_eq_u32 vcc, 0, v253
  s_nop 1
  s_cbranch_vccz L_ok4
  s_mov_b32 s37, 200000
L_sp4:
  buffer_load_dword v253, v24, s[4:7], s60 offen offset:64 sc1
  s_waitcnt vmcnt(0)
  v_cmp_eq_u32 vcc, 0, v253
  s_nop 1
  s_cbranch_vccz L_ok4
  s_sub_u32 s37, s37, 1
  s_cmp_lg_u32 s37, 0
  s_cbranch_scc1 L_sp4
L_ok4:
  v_mfma_f32_16x16x32_bf16 v[224:227], a[228:231], a[56:59], v[224:227]
  s_waitcnt lgkmcnt(3)
  ds_read_b128 a[252:255], v3 offset:44032
  buffer_load_dwordx4 v2, s[4:7], s33 offen offset:2048 lds
  v_mfma_f32_16x16x32_bf16 v[228:231], a[232:235], a[56:59], v[228:231]
  ds_read_b128 a[224:227], v3 offset:45056
  v_mfma_f32_16x16x32_bf16 v[232:235], a[236:239], a[56:59], v[232:235]
  s_waitcnt lgkmcnt(3)
  ds_read_b128 a[228:231], v3 offset:46080
  v_mfma_f32_16x16x32_bf16 v[236:239], a[240:243], a[56:59], v[236:239]
  s_waitcnt lgkmcnt(3)
  ds_read_b128 a[232:235], v3 offset:47104
  v_mfma_f32_16x16x32_bf16 v[220:223], a[244:247], a[60:63], v[220:223]
  s_add_u32 s32, s30, 32768
  ds_read_b128 a[236:239], v3 offset:48128
  buffer_load_dwordx4 a[88:91], v2, s[4:7], s32 offen offset:0 sc1
  v_mfma_f32_16x16x32_bf16 v[224:227], a[248:251], a[60:63], v[224:227]
  s_waitcnt lgkmcnt(3)
  ds_read_b128 a[240:243], v3 offset:49152
  v_mfma_f32_16x16x32_bf16 v[228:231], a[252:255], a[60:63], v[228:231]
  ds_read_b128 a[244:247], v3 offset:50176
  buffer_load_dwordx4 a[92:95], v2, s[4:7], s32 offen offset:1024 sc1
  v_mfma_f32_16x16x32_bf16 v[232:235], a[224:227], a[60:63], v[232:235]
  s_waitcnt lgkmcnt(3)
  ds_read_b128 a[248:251], v3 offset:51200
  v_mfma_f32_16x16x32_bf16 v[236:239], a[228:231], a[60:63], v[236:239]
  s_waitcnt lgkmcnt(3)
  ds_read_b128 a[252:255], v3 offset:52224
  buffer_load_dwordx4 a[96:99], v2, s[4:7], s32 offen offset:2048 sc1
  v_mfma_f32_16x16x32_bf16 v[220:223], a[232:235], a[64:67], v[220:223]
  ds_read_b128 a[224:227], v3 offset:53248
  v_mfma_f32_16x16x32_bf16 v[224:227], a[236:239], a[64:67], v[224:227]
  s_waitcnt lgkmcnt(3)
  ds_read_b128 a[228:231], v3 offset:54272
  buffer_load_dwordx4 a[100:103], v2, s[4:7], s32 offen offset:3072 sc1
  v_mfma_f32_16x16x32_bf16 v[228:231], a[240:243], a[64:67], v[228:231]
  ds_read_b128 a[232:235], v3 offset:55296
  v_mfma_f32_16x16x32_bf16 v[232:235], a[244:247], a[64:67], v[232:235]
  s_waitcnt lgkmcnt(3)
  ds_read_b128 a[236:239], v3 offset:56320
  v_mfma_f32_16x16x32_bf16 v[236:239], a[248:251], a[64:67], v[236:239]
  s_barrier
  s_waitcnt lgkmcnt(3)
  ds_read_b128 a[240:243], v3 offset:57344
  v_mfma_f32_16x16x32_bf16 v[220:223], a[252:255], a[68:71], v[220:223]
  s_add_u32 s32, s30, 36864
  ds_read_b128 a[244:247], v3 offset:58368
  buffer_load_dwordx4 a[104:107], v2, s[4:7], s32 offen offset:0 sc1
  v_mfma_f32_16x16x32_bf16 v[224:227], a[224:227], a[68:71], v[224:227]
  s_waitcnt lgkmcnt(3)
  ds_read_b128 a[248:251], v3 offset:59392
  v_mfma_f32_16x16x32_bf16 v[228:231], a[228:231], a[68:71], v[228:231]
  ds_read_b128 a[252:255], v3 offset:60416
  buffer_load_dwordx4 a[108:111], v2, s[4:7], s32 offen offset:1024 sc1
  v_mfma_f32_16x16x32_bf16 v[232:235], a[232:235], a[68:71], v[232:235]
  s_waitcnt lgkmcnt(3)
  ds_read_b128 a[224:227], v3 offset:61440
  v_mfma_f32_16x16x32_bf16 v[236:239], a[236:239], a[68:71], v[236:239]
  s_waitcnt vmcnt(16) lgkmcnt(3)
  ds_read_b128 a[228:231], v3 offset:62464
  buffer_load_dwordx4 v2, s[4:7], s33 offen offset:3072 lds
  v_mfma_f32_16x16x32_bf16 v[220:223], a[240:243], a[72:75], v[220:223]
  ds_read_b128 a[232:235], v3 offset:63488
  v_mfma_f32_16x16x32_bf16 v[224:227], a[244:247], a[72:75], v[224:227]
  s_waitcnt lgkmcnt(3)
  ds_read_b128 a[236:239], v3 offset:64512
  buffer_load_dwordx4 a[112:115], v2, s[4:7], s32 offen offset:2048 sc1
  v_mfma_f32_16x16x32_bf16 v[228:231], a[248:251], a[72:75], v[228:231]
  ds_read_b128 a[240:243], v4 offset:0
  v_mfma_f32_16x16x32_bf16 v[232:235], a[252:255], a[72:75], v[232:235]
  s_waitcnt lgkmcnt(3)
  ds_read_b128 a[244:247], v4 offset:1024
  v_mfma_f32_16x16x32_bf16 v[236:239], a[224:227], a[72:75], v[236:239]
  s_waitcnt vmcnt(17) lgkmcnt(3)
  ds_read_b128 a[248:251], v4 offset:2048
  v_mfma_f32_16x16x32_bf16 v[220:223], a[228:231], a[76:79], v[220:223]
  s_add_u32 m0, s21, 24576
  ds_read_b128 a[252:255], v4 offset:3072
  v_mfma_f32_16x16x32_bf16 v[224:227], a[232:235], a[76:79], v[224:227]
  s_waitcnt lgkmcnt(3)
  ds_read_b128 a[224:227], v4 offset:4096
  v_mfma_f32_16x16x32_bf16 v[228:231], a[236:239], a[76:79], v[228:231]
  s_add_u32 s33, s25, 208896
  ds_read_b128 a[228:231], v4 offset:5120
  buffer_load_dwordx4 v2, s[4:7], s33 offen offset:0 lds
  v_mfma_f32_16x16x32_bf16 v[232:235], a[240:243], a[76:79], v[232:235]
  s_waitcnt lgkmcnt(3)
  ds_read_b128 a[232:235], v4 offset:6144
  v_mfma_f32_16x16x32_bf16 v[236:239], a[244:247], a[76:79], v[236:239]
  s_waitcnt vmcnt(16) lgkmcnt(3)
  ds_read_b128 a[236:239], v4 offset:7168
  buffer_load_dwordx4 a[116:119], v2, s[4:7], s32 offen offset:3072 sc1
  v_mfma_f32_16x16x32_bf16 v[220:223], a[248:251], a[80:83], v[220:223]
  ds_read_b128 a[240:243], v4 offset:8192
  v_mfma_f32_16x16x32_bf16 v[224:227], a[252:255], a[80:83], v[224:227]
  s_waitcnt lgkmcnt(3)
  ds_read_b128 a[244:247], v4 offset:9216
  v_mfma_f32_16x16x32_bf16 v[228:231], a[224:227], a[80:83], v[228:231]
  s_add_u32 s32, s30, 40960
  ds_read_b128 a[248:251], v4 offset:10240
  buffer_load_dwordx4 a[120:123], v2, s[4:7], s32 offen offset:0 sc1
  v_mfma_f32_16x16x32_bf16 v[232:235], a[228:231], a[80:83], v[232:235]
  s_waitcnt lgkmcnt(3)
  ds_read_b128 a[252:255], v4 offset:11264
  v_mfma_f32_16x16x32_bf16 v[236:239], a[232:235], a[80:83], v[236:239]
  s_barrier
  s_waitcnt vmcnt(16) lgkmcnt(3)
  ds_read_b128 a[224:227], v4 offset:12288
  v_mfma_f32_16x16x32_bf16 v[220:223], a[236:239], a[84:87], v[220:223]
  s_add_u32 m0, s21, 40960
  ds_read_b128 a[228:231], v4 offset:13312
  v_mfma_f32_16x16x32_bf16 v[224:227], a[240:243], a[84:87], v[224:227]
  s_waitcnt lgkmcnt(3)
  ds_read_b128 a[232:235], v4 offset:14336
  v_mfma_f32_16x16x32_bf16 v[228:231], a[244:247], a[84:87], v[228:231]
  s_add_u32 s33, s25, 225280
  ds_read_b128 a[236:239], v4 offset:15360
  buffer_load_dwordx4 v2, s[4:7], s33 offen offset:0 lds
  v_mfma_f32_16x16x32_bf16 v[232:235], a[248:251], a[84:87], v[232:235]
  s_waitcnt lgkmcnt(3)
  ds_read_b128 a[240:243], v4 offset:16384
  v_mfma_f32_16x16x32_bf16 v[236:239], a[252:255], a[84:87], v[236:239]
  s_waitcnt vmcnt(11) lgkmcnt(3)
  ds_read_b128 a[244:247], v4 offset:17408
  buffer_load_dwordx4 a[124:127], v2, s[4:7], s32 offen offset:1024 sc1
  v_mfma_f32_16x16x32_bf16 v[220:223], a[224:227], a[88:91], v[220:223]
  ds_read_b128 a[248:251], v4 offset:18432
  v_mfma_f32_16x16x32_bf16 v[224:227], a[228:231], a[88:91], v[224:227]
  s_waitcnt lgkmcnt(3)
  ds_read_b128 a[252:255], v4 offset:19456
  buffer_load_dwordx4 a[128:131], v2, s[4:7], s32 offen offset:2048 sc1
  v_mfma_f32_16x16x32_bf16 v[228:231], a[232:235], a[88:91], v[228:231]
  ds_read_b128 a[224:227], v4 offset:20480
  v_mfma_f32_16x16x32_bf16 v[232:235], a[236:239], a[88:91], v[232:235]
  s_waitcnt lgkmcnt(3)
  ds_read_b128 a[228:231], v4 offset:21504
  buffer_load_dwordx4 v2, s[4:7], s33 offen offset:1024 lds
  v_mfma_f32_16x16x32_bf16 v[236:239], a[240:243], a[88:91], v[236:239]
  s_waitcnt vmcnt(13) lgkmcnt(3)
  ds_read_b128 a[232:235], v4 offset:22528
  v_mfma_f32_16x16x32_bf16 v[220:223], a[244:247], a[92:95], v[220:223]
  ds_read_b128 a[236:239], v4 offset:23552
  buffer_load_dwordx4 v2, s[4:7], s33 offen offset:2048 lds
  v_mfma_f32_16x16x32_bf16 v[224:227], a[248:251], a[92:95], v[224:227]
  s_waitcnt lgkmcnt(3)
  ds_read_b128 a[240:243], v4 offset:24576
  v_mfma_f32_16x16x32_bf16 v[228:231], a[252:255], a[92:95], v[228:231]
  ds_read_b128 a[244:247], v4 offset:25600
  buffer_load_dwordx4 v2, s[4:7], s33 offen offset:3072 lds
  v_mfma_f32_16x16x32_bf16 v[232:235], a[224:227], a[92:95], v[232:235]
  s_waitcnt lgkmcnt(3)
  ds_read_b128 a[248:251], v4 offset:26624
  v_mfma_f32_16x16x32_bf16 v[236:239], a[228:231], a[92:95], v[236:239]
  s_waitcnt vmcnt(14) lgkmcnt(3)
  ds_read_b128 a[252:255], v4 offset:27648
  v_mfma_f32_16x16x32_bf16 v[220:223], a[232:235], a[96:99], v[220:223]
  s_add_u32 m0, s21, 45056
  ds_read_b128 a[224:227], v4 offset:28672
  v_mfma_f32_16x16x32_bf16 v[224:227], a[236:239], a[96:99], v[224:227]
  s_waitcnt lgkmcnt(3)
  ds_read_b128 a[228:231], v4 offset:29696
  v_mfma_f32_16x16x32_bf16 v[228:231], a[240:243], a[96:99], v[228:231]
  s_add_u32 s33, s25, 229376
  ds_read_b128 a[232:235], v4 offset:30720
  buffer_load_dwordx4 v2, s[4:7], s33 offen offset:0 lds
  v_mfma_f32_16x16x32_bf16 v[232:235], a[244:247], a[96:99], v[232:235]
  s_waitcnt lgkmcnt(3)
  ds_read_b128 a[236:239], v4 offset:31744
  v_mfma_f32_16x16x32_bf16 v[236:239], a[248:251], a[96:99], v[236:239]
  s_barrier
  s_waitcnt vmcnt(14) lgkmcnt(3)
  ds_read_b128 a[240:243], v2 offset:0
  buffer_load_dwordx4 a[132:135], v2, s[4:7], s32 offen offset:3072 sc1
  v_mfma_f32_16x16x32_bf16 v[220:223], a[252:255], a[100:103], v[220:223]
  ds_read_b128 a[244:247], v2 offset:1024
  v_mfma_f32_16x16x32_bf16 v[224:227], a[224:227], a[100:103], v[224:227]
  s_waitcnt lgkmcnt(3)
  ds_read_b128 a[248:251], v2 offset:2048
  v_mfma_f32_16x16x32_bf16 v[228:231], a[228:231], a[100:103], v[228:231]
  s_add_u32 s32, s30, 45056
  ds_read_b128 a[252:255], v2 offset:3072
  buffer_load_dwordx4 a[136:139], v2, s[4:7], s32 offen offset:0 sc1
  v_mfma_f32_16x16x32_bf16 v[232:235], a[232:235], a[100:103], v[232:235]
  s_waitcnt lgkmcnt(3)
  ds_read_b128 a[224:227], v2 offset:4096
  v_mfma_f32_16x16x32_bf16 v[236:239], a[236:239], a[100:103], v[236:239]
  s_waitcnt vmcnt(15) lgkmcnt(3)
  ds_read_b128 a[228:231], v2 offset:5120
  buffer_load_dwordx4 a[140:143], v2, s[4:7], s32 offen offset:1024 sc1
  v_mfma_f32_16x16x32_bf16 v[220:223], a[240:243], a[104:107], v[220:223]
  ds_read_b128 a[232:235], v2 offset:6144
  v_mfma_f32_16x16x32_bf16 v[224:227], a[244:247], a[104:107], v[224:227]
  s_waitcnt lgkmcnt(3)
  ds_read_b128 a[236:239], v2 offset:7168
  buffer_load_dwordx4 a[144:147], v2, s[4:7], s32 offen offset:2048 sc1
  v_mfma_f32_16x16x32_bf16 v[228:231], a[248:251], a[104:107], v[228:231]
  ds_read_b128 a[240:243], v2 offset:8192
  v_mfma_f32_16x16x32_bf16 v[232:235], a[252:255], a[104:107], v[232:235]
  s_waitcnt lgkmcnt(3)
  ds_read_b128 a[244:247], v2 offset:9216
  v_mfma_f32_16x16x32_bf16 v[236:239], a[224:227], a[104:107], v[236:239]
  s_waitcnt vmcnt(16) lgkmcnt(3)
  ds_read_b128 a[248:251], v2 offset:10240
  v_mfma_f32_16x16x32_bf16 v[220:223], a[228:231], a[108:111], v[220:223]
  s_add_u32 m0, s21, 61440
  ds_read_b128 a[252:255], v2 offset:11264
  v_mfma_f32_16x16x32_bf16 v[224:227], a[232:235], a[108:111], v[224:227]
  s_waitcnt lgkmcnt(3)
  ds_read_b128 a[224:227], v2 offset:12288
  v_mfma_f32_16x16x32_bf16 v[228:231], a[236:239], a[108:111], v[228:231]
  s_add_u32 s33, s25, 245760
  ds_read_b128 a[228:231], v2 offset:13312
  buffer_load_dwordx4 v2, s[4:7], s33 offen offset:0 lds
  v_mfma_f32_16x16x32_bf16 v[232:235], a[240:243], a[108:111], v[232:235]
  s_waitcnt lgkmcnt(3)
  ds_read_b128 a[232:235], v2 offset:14336
  v_mfma_f32_16x16x32_bf16 v[236:239], a[244:247], a[108:111], v[236:239]
  s_waitcnt vmcnt(15) lgkmcnt(3)
  ds_read_b128 a[236:239], v2 offset:15360
  buffer_load_dwordx4 v2, s[4:7], s33 offen offset:1024 lds
  v_mfma_f32_16x16x32_bf16 v[220:223], a[248:251], a[112:115], v[220:223]
  ds_read_b128 a[240:243], v2 offset:16384
  v_mfma_f32_16x16x32_bf16 v[224:227], a[252:255], a[112:115], v[224:227]
  s_waitcnt lgkmcnt(3)
  ds_read_b128 a[244:247], v2 offset:17408
  buffer_load_dwordx4 v2, s[4:7], s33 offen offset:2048 lds
  v_mfma_f32_16x16x32_bf16 v[228:231], a[224:227], a[112:115], v[228:231]
  ds_read_b128 a[248:251], v2 offset:18432
  v_mfma_f32_16x16x32_bf16 v[232:235], a[228:231], a[112:115], v[232:235]
  s_waitcnt lgkmcnt(3)
  ds_read_b128 a[252:255], v2 offset:19456
  buffer_load_dwordx4 v2, s[4:7], s33 offen offset:3072 lds
  v_mfma_f32_16x16x32_bf16 v[236:239], a[232:235], a[112:115], v[236:239]
  s_waitcnt vmcnt(17)
  s_barrier
  s_waitcnt vmcnt(16) lgkmcnt(3)
  ds_read_b128 a[224:227], v2 offset:20480
  v_mfma_f32_16x16x32_bf16 v[220:223], a[236:239], a[116:119], v[220:223]
  s_add_u32 m0, s21, 65536
  ds_read_b128 a[228:231], v2 offset:21504
  v_mfma_f32_16x16x32_bf16 v[224:227], a[240:243], a[116:119], v[224:227]
  s_waitcnt lgkmcnt(3)
  ds_read_b128 a[232:235], v2 offset:22528
  v_mfma_f32_16x16x32_bf16 v[228:231], a[244:247], a[116:119], v[228:231]
  s_add_u32 s33, s25, 249856
  ds_read_b128 a[236:239], v2 offset:23552
  buffer_load_dwordx4 v2, s[4:7], s33 offen offset:0 lds
  v_mfma_f32_16x16x32_bf16 v[232:235], a[248:251], a[116:119], v[232:235]
  s_waitcnt lgkmcnt(3)
  ds_read_b128 a[240:243], v2 offset:24576
  v_mfma_f32_16x16x32_bf16 v[236:239], a[252:255], a[116:119], v[236:239]
  s_waitcnt vmcnt(16) lgkmcnt(3)
  ds_read_b128 a[244:247], v2 offset:25600
  buffer_load_dwordx4 a[148:151], v2, s[4:7], s32 offen offset:3072 sc1
  v_mfma_f32_16x16x32_bf16 v[220:223], a[224:227], a[120:123], v[220:223]
  ds_read_b128 a[248:251], v2 offset:26624
  v_mfma_f32_16x16x32_bf16 v[224:227], a[228:231], a[120:123], v[224:227]
  s_waitcnt lgkmcnt(3)
  ds_read_b128 a[252:255], v2 offset:27648
  v_mfma_f32_16x16x32_bf16 v[228:231], a[232:235], a[120:123], v[228:231]
  s_add_u32 s32, s30, 49152
  ds_read_b128 a[224:227], v2 offset:28672
  buffer_load_dwordx4 a[152:155], v2, s[4:7], s32 offen offset:0 sc1
  v_mfma_f32_16x16x32_bf16 v[232:235], a[236:239], a[120:123], v[232:235]
  s_waitcnt lgkmcnt(3)
  ds_read_b128 a[228:231], v2 offset:29696
  v_mfma_f32_16x16x32_bf16 v[236:239], a[240:243], a[120:123], v[236:239]
  s_waitcnt vmcnt(16) lgkmcnt(3)
  ds_read_b128 a[232:235], v2 offset:30720
  buffer_load_dwordx4 a[156:159], v2, s[4:7], s32 offen offset:1024 sc1
  v_mfma_f32_16x16x32_bf16 v[220:223], a[244:247], a[124:127], v[220:223]
  ds_read_b128 a[236:239], v2 offset:31744
  v_mfma_f32_16x16x32_bf16 v[224:227], a[248:251], a[124:127], v[224:227]
  s_waitcnt lgkmcnt(3)
  ds_read_b128 a[240:243], v2 offset:32768
  buffer_load_dwordx4 a[160:163], v2, s[4:7], s32 offen offset:2048 sc1
  v_mfma_f32_16x16x32_bf16 v[228:231], a[252:255], a[124:127], v[228:231]
  ds_read_b128 a[244:247], v2 offset:33792
  v_mfma_f32_16x16x32_bf16 v[232:235], a[224:227], a[124:127], v[232:235]
  s_waitcnt lgkmcnt(3)
  ds_read_b128 a[248:251], v2 offset:34816
  v_mfma_f32_16x16x32_bf16 v[236:239], a[228:231], a[124:127], v[236:239]
  s_waitcnt vmcnt(17) lgkmcnt(3)
  ds_read_b128 a[252:255], v2 offset:35840
  v_mfma_f32_16x16x32_bf16 v[220:223], a[232:235], a[128:131], v[220:223]
  s_mul_i32 s33, s12, 3072
  ds_read_b128 a[224:227], v2 offset:36864
  v_mfma_f32_16x16x32_bf16 v[224:227], a[236:239], a[128:131], v[224:227]
  s_waitcnt lgkmcnt(3)
  ds_read_b128 a[228:231], v2 offset:37888
  v_mfma_f32_16x16x32_bf16 v[228:231], a[240:243], a[128:131], v[228:231]
  s_add_u32 m0, s33, 81920
  ds_read_b128 a[232:235], v2 offset:38912
  v_mfma_f32_16x16x32_bf16 v[232:235], a[244:247], a[128:131], v[232:235]
  s_waitcnt lgkmcnt(3)
  ds_read_b128 a[236:239], v2 offset:39936
  v_mfma_f32_16x16x32_bf16 v[236:239], a[248:251], a[128:131], v[236:239]
  s_waitcnt vmcnt(13)
  s_barrier
  s_waitcnt vmcnt(12) lgkmcnt(3)
  ds_read_b128 a[240:243], v2 offset:40960
  v_mfma_f32_16x16x32_bf16 v[220:223], a[252:255], a[132:135], v[220:223]
  s_sub_u32 s33, s33, s21
  ds_read_b128 a[244:247], v2 offset:41984
  v_mfma_f32_16x16x32_bf16 v[224:227], a[224:227], a[132:135], v[224:227]
  s_waitcnt lgkmcnt(3)
  ds_read_b128 a[248:251], v2 offset:43008
  v_mfma_f32_16x16x32_bf16 v[228:231], a[228:231], a[132:135], v[228:231]
  s_add_u32 s33, s33, s25
  ds_read_b128 a[252:255], v2 offset:44032
  v_mfma_f32_16x16x32_bf16 v[232:235], a[232:235], a[132:135], v[232:235]
  s_waitcnt lgkmcnt(3)
  ds_read_b128 a[224:227], v2 offset:45056
  v_mfma_f32_16x16x32_bf16 v[236:239], a[236:239], a[132:135], v[236:239]
  s_waitcnt vmcnt(11) lgkmcnt(3)
  ds_read_b128 a[228:231], v2 offset:46080
  v_mfma_f32_16x16x32_bf16 v[220:223], a[240:243], a[136:139], v[220:223]
  s_add_u32 s33, s33, 266240
  ds_read_b128 a[232:235], v2 offset:47104
  buffer_load_dwordx4 v2, s[4:7], s33 offen offset:0 lds
  v_mfma_f32_16x16x32_bf16 v[224:227], a[244:247], a[136:139], v[224:227]
  s_waitcnt lgkmcnt(3)
  ds_read_b128 a[236:239], v2 offset:48128
  v_mfma_f32_16x16x32_bf16 v[228:231], a[248:251], a[136:139], v[228:231]
  ds_read_b128 a[240:243], v2 offset:49152
  buffer_load_dwordx4 v2, s[4:7], s33 offen offset:1024 lds
  v_mfma_f32_16x16x32_bf16 v[232:235], a[252:255], a[136:139], v[232:235]
  s_waitcnt lgkmcnt(3)
  ds_read_b128 a[244:247], v2 offset:50176
  v_mfma_f32_16x16x32_bf16 v[236:239], a[224:227], a[136:139], v[236:239]
  s_waitcnt vmcnt(12) lgkmcnt(3)
  ds_read_b128 a[248:251], v2 offset:51200
  buffer_load_dwordx4 v2, s[4:7], s33 offen offset:2048 lds
  v_mfma_f32_16x16x32_bf16 v[220:223], a[228:231], a[140:143], v[220:223]
  ds_read_b128 a[252:255], v2 offset:52224
  v_mfma_f32_16x16x32_bf16 v[224:227], a[232:235], a[140:143], v[224:227]
  s_waitcnt lgkmcnt(3)
  ds_read_b128 a[224:227], v2 offset:53248
  buffer_load_dwordx4 a[164:167], v2, s[4:7], s32 offen offset:3072 sc1
  v_mfma_f32_16x16x32_bf16 v[228:231], a[236:239], a[140:143], v[228:231]
  ds_read_b128 a[228:231], v2 offset:54272
  v_mfma_f32_16x16x32_bf16 v[232:235], a[240:243], a[140:143], v[232:235]
  s_waitcnt lgkmcnt(3)
  ds_read_b128 a[232:235], v2 offset:55296
  v_mfma_f32_16x16x32_bf16 v[236:239], a[244:247], a[140:143], v[236:239]
  s_waitcnt vmcnt(13) lgkmcnt(3)
  ds_read_b128 a[236:239], v2 offset:56320
  v_mfma_f32_16x16x32_bf16 v[220:223], a[248:251], a[144:147], v[220:223]
  s_add_u32 s32, s30, 53248
  ds_read_b128 a[240:243], v2 offset:57344
  buffer_load_dwordx4 a[168:171], v2, s[4:7], s32 offen offset:0 sc1
  v_mfma_f32_16x16x32_bf16 v[224:227], a[252:255], a[144:147], v[224:227]
  s_waitcnt lgkmcnt(3)
  ds_read_b128 a[244:247], v2 offset:58368
  v_mfma_f32_16x16x32_bf16 v[228:231], a[224:227], a[144:147], v[228:231]
  ds_read_b128 a[248:251], v2 offset:59392
  buffer_load_dwordx4 a[172:175], v2, s[4:7], s32 offen offset:1024 sc1
  v_mfma_f32_16x16x32_bf16 v[232:235], a[228:231], a[144:147], v[232:235]
  s_waitcnt lgkmcnt(3)
  ds_read_b128 a[252:255], v2 offset:60416
  v_mfma_f32_16x16x32_bf16 v[236:239], a[232:235], a[144:147], v[236:239]
  s_waitcnt vmcnt(10)
  s_barrier
  s_waitcnt vmcnt(9) lgkmcnt(3)
  ds_read_b128 a[224:227], v2 offset:61440
  v_mfma_f32_16x16x32_bf16 v[220:223], a[236:239], a[148:151], v[220:223]
  s_add_u32 m0, s21, 122880
  ds_read_b128 a[228:231], v2 offset:62464
  v_mfma_f32_16x16x32_bf16 v[224:227], a[240:243], a[148:151], v[224:227]
  s_waitcnt lgkmcnt(3)
  ds_read_b128 a[232:235], v2 offset:63488
  v_mfma_f32_16x16x32_bf16 v[228:231], a[244:247], a[148:151], v[228:231]
  s_add_u32 s33, s22, 0
  ds_read_b128 a[236:239], v2 offset:64512
  buffer_load_dwordx4 v2, s[4:7], s33 offen offset:0 lds
  v_mfma_f32_16x16x32_bf16 v[232:235], a[248:251], a[148:151], v[232:235]
  s_waitcnt lgkmcnt(3)
  ds_read_b128 a[240:243], v3 offset:0
  v_mfma_f32_16x16x32_bf16 v[236:239], a[252:255], a[148:151], v[236:239]
  s_waitcnt vmcnt(9) lgkmcnt(3)
  ds_read_b128 a[244:247], v3 offset:1024
  buffer_load_dwordx4 v2, s[4:7], s33 offen offset:1024 lds
  v_mfma_f32_16x16x32_bf16 v[220:223], a[224:227], a[152:155], v[220:223]
  ds_read_b128 a[248:251], v3 offset:2048
  v_mfma_f32_16x16x32_bf16 v[224:227], a[228:231], a[152:155], v[224:227]
  s_waitcnt lgkmcnt(3)
  ds_read_b128 a[252:255], v3 offset:3072
  buffer_load_dwordx4 v2, s[4:7], s33 offen offset:2048 lds
  v_mfma_f32_16x16x32_bf16 v[228:231], a[232:235], a[152:155], v[228:231]
  ds_read_b128 a[224:227], v3 offset:4096
  v_mfma_f32_16x16x32_bf16 v[232:235], a[236:239], a[152:155], v[232:235]
  s_waitcnt lgkmcnt(3)
  ds_read_b128 a[228:231], v3 offset:5120
  buffer_load_dwordx4 v2, s[4:7], s33 offen offset:3072 lds
  v_mfma_f32_16x16x32_bf16 v[236:239], a[240:243], a[152:155], v[236:239]
  s_waitcnt vmcnt(11) lgkmcnt(3)
  ds_read_b128 a[232:235], v3 offset:6144
  v_mfma_f32_16x16x32_bf16 v[220:223], a[244:247], a[156:159], v[220:223]
  s_add_u32 m0, s21, 126976
  ds_read_b128 a[236:239], v3 offset:7168
  v_mfma_f32_16x16x32_bf16 v[224:227], a[248:251], a[156:159], v[224:227]
  s_waitcnt lgkmcnt(3)
  ds_read_b128 a[240:243], v3 offset:8192
  v_mfma_f32_16x16x32_bf16 v[228:231], a[252:255], a[156:159], v[228:231]
  s_add_u32 s33, s22, 4096
  ds_read_b128 a[244:247], v3 offset:9216
  buffer_load_dwordx4 v2, s[4:7], s33 offen offset:0 lds
  v_mfma_f32_16x16x32_bf16 v[232:235], a[224:227], a[156:159], v[232:235]
  s_waitcnt lgkmcnt(3)
  ds_read_b128 a[248:251], v3 offset:10240
  v_mfma_f32_16x16x32_bf16 v[236:239], a[228:231], a[156:159], v[236:239]
  s_waitcnt vmcnt(11) lgkmcnt(3)
  ds_read_b128 a[252:255], v3 offset:11264
  v_mfma_f32_16x16x32_bf16 v[220:223], a[232:235], a[160:163], v[220:223]
  s_add_u32 m0, s21, 143360
  ds_read_b128 a[224:227], v3 offset:12288
  v_mfma_f32_16x16x32_bf16 v[224:227], a[236:239], a[160:163], v[224:227]
  s_waitcnt lgkmcnt(3)
  ds_read_b128 a[228:231], v3 offset:13312
  v_mfma_f32_16x16x32_bf16 v[228:231], a[240:243], a[160:163], v[228:231]
  s_add_u32 s33, s22, 20480
  ds_read_b128 a[232:235], v3 offset:14336
  buffer_load_dwordx4 v2, s[4:7], s33 offen offset:0 lds
  v_mfma_f32_16x16x32_bf16 v[232:235], a[244:247], a[160:163], v[232:235]
  s_waitcnt lgkmcnt(3)
  ds_read_b128 a[236:239], v3 offset:15360
  v_mfma_f32_16x16x32_bf16 v[236:239], a[248:251], a[160:163], v[236:239]
  s_waitcnt vmcnt(9)
  s_barrier
  s_waitcnt vmcnt(8) lgkmcnt(3)
  ds_read_b128 a[240:243], v3 offset:16384
  buffer_load_dwordx4 v2, s[4:7], s33 offen offset:1024 lds
  v_mfma_f32_16x16x32_bf16 v[220:223], a[252:255], a[164:167], v[220:223]
  ds_read_b128 a[244:247], v3 offset:17408
  v_mfma_f32_16x16x32_bf16 v[224:227], a[224:227], a[164:167], v[224:227]
  s_waitcnt lgkmcnt(3)
  ds_read_b128 a[248:251], v3 offset:18432
  buffer_load_dwordx4 v2, s[4:7], s33 offen offset:2048 lds
  v_mfma_f32_16x16x32_bf16 v[228:231], a[228:231], a[164:167], v[228:231]
  ds_read_b128 a[252:255], v3 offset:19456
  v_mfma_f32_16x16x32_bf16 v[232:235], a[232:235], a[164:167], v[232:235]
  s_waitcnt lgkmcnt(3)
  ds_read_b128 a[224:227], v3 offset:20480
  buffer_load_dwordx4 v2, s[4:7], s33 offen offset:3072 lds
  v_mfma_f32_16x16x32_bf16 v[236:239], a[236:239], a[164:167], v[236:239]
  s_waitcnt vmcnt(10) lgkmcnt(3)
  ds_read_b128 a[228:231], v3 offset:21504
  v_mfma_f32_16x16x32_bf16 v[220:223], a[240:243], a[168:171], v[220:223]
  s_add_u32 m0, s21, 147456
  ds_read_b128 a[232:235], v3 offset:22528
  v_mfma_f32_16x16x32_bf16 v[224:227], a[244:247], a[168:171], v[224:227]
  s_waitcnt lgkmcnt(3)
  ds_read_b128 a[236:239], v3 offset:23552
  v_mfma_f32_16x16x32_bf16 v[228:231], a[248:251], a[168:171], v[228:231]
  s_add_u32 s33, s22, 24576
  ds_read_b128 a[240:243], v3 offset:24576
  buffer_load_dwordx4 v2, s[4:7], s33 offen offset:0 lds
  v_mfma_f32_16x16x32_bf16 v[232:235], a[252:255], a[168:171], v[232:235]
  s_waitcnt lgkmcnt(3)
  ds_read_b128 a[244:247], v3 offset:25600
  v_mfma_f32_16x16x32_bf16 v[236:239], a[224:227], a[168:171], v[236:239]
  s_waitcnt vmcnt(10) lgkmcnt(3)
  v_mfma_f32_16x16x32_bf16 v[220:223], a[228:231], a[172:175], v[220:223]
  s_add_u32 m0, s21, 0
  v_mfma_f32_16x16x32_bf16 v[224:227], a[232:235], a[172:175], v[224:227]
  s_waitcnt lgkmcnt(1)
  v_mfma_f32_16x16x32_bf16 v[228:231], a[236:239], a[172:175], v[228:231]
  s_add_u32 s33, s22, 40960
  buffer_load_dwordx4 v2, s[4:7], s33 offen offset:0 lds
  v_mfma_f32_16x16x32_bf16 v[232:235], a[240:243], a[172:175], v[232:235]
  s_waitcnt lgkmcnt(0)
  v_mfma_f32_16x16x32_bf16 v[236:239], a[244:247], a[172:175], v[236:239]
  buffer_load_dwordx4 v2, s[4:7], s33 offen offset:1024 lds
  s_barrier
  s_cmp_lg_u32 s20, 0
  s_cbranch_scc1 L_final
  s_mul_i32 s36, s16, 20480
  s_mul_i32 s34, s17, 2560
  s_add_u32 s36, s36, s34
  s_add_u32 s36, s36, s20
  s_add_u32 s36, s36, 26030080
  s_lshl_b32 s35, s16, 10
  s_lshl_b32 s34, s17, 7
  s_add_u32 s35, s35, s34
  s_add_u32 s35, s35, s20
  s_add_u32 s35, s35, 40972288
  v_mov_b32 v70, 0
  v_mov_b32 v71, 0
  v_lshlrev_b32 v74, 16, v32
  v_and_b32 v75, 0xffff0000, v32
  v_lshlrev_b32 v76, 16, v33
  v_and_b32 v77, 0xffff0000, v33
  v_lshlrev_b32 v78, 16, v34
  v_and_b32 v79, 0xffff0000, v34
  v_lshlrev_b32 v80, 16, v35
  v_and_b32 v81, 0xffff0000, v35
  v_pk_add_f32 v[74:75], v[74:75], v[220:221]
  v_pk_add_f32 v[76:77], v[76:77], v[222:223]
  v_pk_add_f32 v[78:79], v[78:79], v[224:225]
  v_pk_add_f32 v[80:81], v[80:81], v[226:227]
  v_cvt_pk_bf16_f32 v32, v74, v75
  v_cvt_pk_bf16_f32 v33, v76, v77
  v_cvt_pk_bf16_f32 v34, v78, v79
  v_cvt_pk_bf16_f32 v35, v80, v81
  buffer_store_dwordx4 v[32:35], v2, s[4:7], s36 offen offset:0 sc1
  v_lshlrev_b32 v74, 16, v36
  v_and_b32 v75, 0xffff0000, v36
  v_lshlrev_b32 v76, 16, v37
  v_and_b32 v77, 0xffff0000, v37
  v_lshlrev_b32 v78, 16, v38
  v_and_b32 v79, 0xffff0000, v38
  v_lshlrev_b32 v80, 16, v39
  v_and_b32 v81, 0xffff0000, v39
  v_pk_add_f32 v[74:75], v[74:75], v[228:229]
  v_pk_add_f32 v[76:77], v[76:77], v[230:231]
  v_pk_add_f32 v[78:79], v[78:79], v[232:233]
  v_pk_add_f32 v[80:81], v[80:81], v[234:235]
  v_cvt_pk_bf16_f32 v36, v74, v75
  v_cvt_pk_bf16_f32 v37, v76, v77
  v_cvt_pk_bf16_f32 v38, v78, v79
  v_cvt_pk_bf16_f32 v39, v80, v81
  buffer_store_dwordx4 v[36:39], v2, s[4:7], s36 offen offset:1024 sc1
  v_lshlrev_b32 v74, 16, v40
  v_and_b32 v75, 0xffff0000, v40
  v_lshlrev_b32 v76, 16, v41
  v_and_b32 v77, 0xffff0000, v41
  v_pk_add_f32 v[74:75], v[74:75], v[236:237]
  v_pk_add_f32 v[76:77], v[76:77], v[238:239]
  v_cvt_pk_bf16_f32 v40, v74, v75
  v_cvt_pk_bf16_f32 v41, v76, v77
  buffer_store_dwordx2 v[40:41], v8, s[4:7], s36 offen offset:2048 sc1
  v_dot2_f32_bf16 v70, v32, v46, v70
  v_dot2_f32_bf16 v71, v32, v32, v71
  v_dot2_f32_bf16 v70, v33, v46, v70
  v_dot2_f32_bf16 v71, v33, v33, v71
  v_dot2_f32_bf16 v70, v34, v46, v70
  v_dot2_f32_bf16 v71, v34, v34, v71
  v_dot2_f32_bf16 v70, v35, v46, v70
  v_dot2_f32_bf16 v71, v35, v35, v71
  v_dot2_f32_bf16 v70, v36, v46, v70
  v_dot2_f32_bf16 v71, v36, v36, v71
  v_dot2_f32_bf16 v70, v37, v46, v70
  v_dot2_f32_bf16 v71, v37, v37, v71
  v_dot2_f32_bf16 v70, v38, v46, v70
  v_dot2_f32_bf16 v71, v38, v38, v71
  v_dot2_f32_bf16 v70, v39, v46, v70
  v_dot2_f32_bf16 v71, v39, v39, v71
  v_dot2_f32_bf16 v70, v40, v46, v70
  v_dot2_f32_bf16 v71, v40, v40, v71
  v_dot2_f32_bf16 v70, v41, v46, v70
  v_dot2_f32_bf16 v71, v41, v41, v71
  s_nop 1
  v_mov_b32 v72, v70
  v_mov_b32 v73, v71
  s_nop 0
  v_permlane32_swap_b32 v70, v72
  v_permlane32_swap_b32 v71, v73
  v_add_f32 v70, v70, v72
  v_add_f32 v71, v71, v73
  v_mov_b32 v72, v70
  v_mov_b32 v73, v71
  s_nop 0
  v_permlane16_swap_b32 v70, v72
  v_permlane16_swap_b32 v71, v73
  v_add_f32 v70, v70, v72
  v_add_f32 v71, v71, v73
  buffer_store_dwordx2 v[70:71], v10, s[4:7], s35 offen sc1
  s_lshr_b32 s34, s27, 4
  s_lshl_b32 s34, s34, 11
  s_and_b32 s35, s27, 15
  s_lshl_b32 s35, s35, 2
  s_add_u32 s34, s34, s35
  s_add_u32 s34, s34, s20
  s_add_u32 s34, s34, 41291776
  s_waitcnt vmcnt(0)
  s_barrier
  buffer_store_dword v25, v22, s[4:7], s34 offen offset:0 sc1
  buffer_load_dwordx4 v2, s[4:7], s33 offen offset:2048 lds
  buffer_load_dwordx4 v2, s[4:7], s33 offen offset:3072 lds
  s_add_u32 m0, s21, 4096
  s_add_u32 s33, s22, 45056
  buffer_load_dwordx4 v2, s[4:7], s33 offen offset:0 lds
  s_add_u32 m0, s21, 20480
  s_add_u32 s33, s22, 61440
  buffer_load_dwordx4 v2, s[4:7], s33 offen offset:0 lds
  buffer_load_dwordx4 v2, s[4:7], s33 offen offset:1024 lds
  buffer_load_dwordx4 v2, s[4:7], s33 offen offset:2048 lds
  buffer_load_dwordx4 v2, s[4:7], s33 offen offset:3072 lds
  s_add_u32 m0, s21, 24576
  s_add_u32 s33, s22, 65536
  buffer_load_dwordx4 v2, s[4:7], s33 offen offset:0 lds
  s_add_u32 m0, s21, 40960
  s_add_u32 s33, s22, 81920
  buffer_load_dwordx4 v2, s[4:7], s33 offen offset:0 lds
  buffer_load_dwordx4 v2, s[4:7], s33 offen offset:1024 lds
  buffer_load_dwordx4 v2, s[4:7], s33 offen offset:2048 lds
  buffer_load_dwordx4 v2, s[4:7], s33 offen offset:3072 lds
  s_add_u32 m0, s21, 45056
  s_add_u32 s33, s22, 86016
  buffer_load_dwordx4 v2, s[4:7], s33 offen offset:0 lds
  s_add_u32 m0, s21, 61440
  s_add_u32 s33, s22, 102400
  buffer_load_dwordx4 v2, s[4:7], s33 offen offset:0 lds
  buffer_load_dwordx4 v2, s[4:7], s33 offen offset:1024 lds
  buffer_load_dwordx4 v2, s[4:7], s33 offen offset:2048 lds
  buffer_load_dwordx4 v2, s[4:7], s33 offen offset:3072 lds
  s_add_u32 m0, s21, 65536
  s_add_u32 s33, s22, 106496
  buffer_load_dwordx4 v2, s[4:7], s33 offen offset:0 lds
  s_add_u32 m0, s21, 81920
  s_add_u32 s33, s22, 122880
  buffer_load_dwordx4 v2, s[4:7], s33 offen offset:0 lds
  buffer_load_dwordx4 v2, s[4:7], s33 offen offset:1024 lds
  buffer_load_dwordx4 v2, s[4:7], s33 offen offset:2048 lds
  buffer_load_dwordx4 v2, s[4:7], s33 offen offset:3072 lds
  s_add_u32 m0, s21, 86016
  s_add_u32 s33, s22, 126976
  buffer_load_dwordx4 v2, s[4:7], s33 offen offset:0 lds
  s_add_u32 m0, s21, 102400
  s_add_u32 s33, s22, 143360
  buffer_load_dwordx4 v2, s[4:7], s33 offen offset:0 lds
  buffer_load_dwordx4 v2, s[4:7], s33 offen offset:1024 lds
  buffer_load_dwordx4 v2, s[4:7], s33 offen offset:2048 lds
  buffer_load_dwordx4 v2, s[4:7], s33 offen offset:3072 lds
  s_add_u32 m0, s21, 106496
  s_add_u32 s33, s22, 147456
  buffer_load_dwordx4 v2, s[4:7], s33 offen offset:0 lds
  s_mov_b32 s20, 15409152
  s_branch L_layer
L_final:
  s_mul_i32 s36, s16, 20480
  s_mul_i32 s34, s17, 2560
  s_add_u32 s36, s36, s34
  s_add_u32 s36, s36, s20
  s_add_u32 s36, s36, 0
  s_lshl_b32 s35, s16, 10
  s_lshl_b32 s34, s17, 7
  s_add_u32 s35, s35, s34
  s_add_u32 s35, s35, s20
  s_add_u32 s35, s35, 0
  v_mov_b32 v70, 0
  v_mov_b32 v71, 0
  v_lshlrev_b32 v74, 16, v32
  v_and_b32 v75, 0xffff0000, v32
  v_lshlrev_b32 v76, 16, v33
  v_and_b32 v77, 0xffff0000, v33
  v_lshlrev_b32 v78, 16, v34
  v_and_b32 v79, 0xffff0000, v34
  v_lshlrev_b32 v80, 16, v35
  v_and_b32 v81, 0xffff0000, v35
  v_pk_add_f32 v[74:75], v[74:75], v[220:221]
  v_pk_add_f32 v[76:77], v[76:77], v[222:223]
  v_pk_add_f32 v[78:79], v[78:79], v[224:225]
  v_pk_add_f32 v[80:81], v[80:81], v[226:227]
  v_cvt_pk_bf16_f32 v32, v74, v75
  v_cvt_pk_bf16_f32 v33, v76, v77
  v_cvt_pk_bf16_f32 v34, v78, v79
  v_cvt_pk_bf16_f32 v35, v80, v81
  v_lshlrev_b32 v74, 16, v36
  v_and_b32 v75, 0xffff0000, v36
  v_lshlrev_b32 v76, 16, v37
  v_and_b32 v77, 0xffff0000, v37
  v_lshlrev_b32 v78, 16, v38
  v_and_b32 v79, 0xffff0000, v38
  v_lshlrev_b32 v80, 16, v39
  v_and_b32 v81, 0xffff0000, v39
  v_pk_add_f32 v[74:75], v[74:75], v[228:229]
  v_pk_add_f32 v[76:77], v[76:77], v[230:231]
  v_pk_add_f32 v[78:79], v[78:79], v[232:233]
  v_pk_add_f32 v[80:81], v[80:81], v[234:235]
  v_cvt_pk_bf16_f32 v36, v74, v75
  v_cvt_pk_bf16_f32 v37, v76, v77
  v_cvt_pk_bf16_f32 v38, v78, v79
  v_cvt_pk_bf16_f32 v39, v80, v81
  v_lshlrev_b32 v74, 16, v40
  v_and_b32 v75, 0xffff0000, v40
  v_lshlrev_b32 v76, 16, v41
  v_and_b32 v77, 0xffff0000, v41
  v_pk_add_f32 v[74:75], v[74:75], v[236:237]
  v_pk_add_f32 v[76:77], v[76:77], v[238:239]
  v_cvt_pk_bf16_f32 v40, v74, v75
  v_cvt_pk_bf16_f32 v41, v76, v77
  s_mul_i32 s34, s16, 20480
  s_mul_i32 s35, s17, 160
  s_add_u32 s34, s34, s35
  buffer_store_dwordx4 v[32:35], v29, s[8:11], s34 offen
  buffer_store_dwordx4 v[36:39], v29, s[8:11], s34 offen offset:64
  buffer_store_dwordx2 v[40:41], v30, s[8:11], s34 offen offset:128
  s_waitcnt vmcnt(0)
  s_endpgm
L_exit:
  s_endpgm
.section .rodata,"a"
.p2align 6
.amdhsa_kernel interleave_layers__linear_attn_block__glu_gated_glu__prompt_kernel
  .amdhsa_next_free_vgpr 512
  .amdhsa_next_free_sgpr 64
  .amdhsa_accum_offset 256
  .amdhsa_group_segment_fixed_size 0
  .amdhsa_kernarg_size 80
  .amdhsa_user_sgpr_count 2
  .amdhsa_user_sgpr_kernarg_segment_ptr 1
  .amdhsa_system_sgpr_workgroup_id_x 1
  .amdhsa_float_denorm_mode_32 3
.end_amdhsa_kernel
.text
```
